```python
import torch

def _softmax(x, axis=-1):
    return torch.softmax(x, dim=axis)
def _gelu(x):
    return torch.nn.functional.gelu(x, approximate="tanh")
def _silu(x):
    return torch.nn.functional.silu(x)
def _sigmoid(x):
    return torch.sigmoid(x)
def _layernorm(x, axis=-1, eps=1e-5):
    m = x.mean(dim=axis, keepdim=True)
    v = x.var(dim=axis, keepdim=True, unbiased=False)
    return (x - m) / torch.sqrt(v + eps)
def _scatter_add(tgt, idx, src, axis=0):
    return tgt.clone().index_add_(axis, idx, src)
def _segment_sum(src, seg, n):
    out = torch.zeros((n,) + src.shape[1:], dtype=src.dtype)
    return out.index_add_(0, seg, src)
def _pad(x, pw):
    flat = tuple(v for pair in reversed(pw) for v in pair)
    return torch.nn.functional.pad(x, flat)

kernel_name = 'parallel_sum__linear_kernel_hedgehog__moe_arch_mod__prompt'

def setup_inputs():

    _w = (lambda a: (lambda t: t.to(torch.bfloat16) if t.is_floating_point() else t)(torch.as_tensor(a)))
    def _A_setup():
        B, S, D, H = 1, 2048, 640, 32
        Dh = D // H
        return {
            "x": _w((lambda *s: torch.randn(*s, dtype=torch.bfloat16) * 0.05)(B, S, D)),
            "wqkv": _w((lambda *s: torch.randn(*s, dtype=torch.bfloat16) * 0.4)(D, 3 * D)),
            "w_phi": _w((lambda *s: torch.randn(*s, dtype=torch.bfloat16) * 0.4)(H, Dh, Dh) * (Dh ** -0.5)),
            "wo": _w((lambda *s: torch.randn(*s, dtype=torch.bfloat16) * 0.1)(D, D)),
        }
    _A_in = _A_setup()

    def _B_setup():
        B, S, D, F, C = 1, 2048, 640, 1536, 2
        return {
            "x": _w((lambda *s: torch.randn(*s, dtype=torch.bfloat16) * 0.05)(B, S, D)),
            "w_r": _w((lambda *s: torch.randn(*s, dtype=torch.bfloat16) * 0.05)(D)),
            "w_gate": _w((lambda *s: torch.randn(*s, dtype=torch.bfloat16) * 0.05)(D, F)),
            "w_up": _w((lambda *s: torch.randn(*s, dtype=torch.bfloat16) * 0.05)(D, F)),
            "w_down": _w((lambda *s: torch.randn(*s, dtype=torch.bfloat16) * 0.05)(F, D)),
        }
    _B_in = _B_setup()

    return {
        "A_x": _A_in["x"],
        "A_wqkv": _A_in["wqkv"],
        "A_w_phi": _A_in["w_phi"],
        "A_wo": _A_in["wo"],
        "B_x": _B_in["x"],
        "B_w_r": _B_in["w_r"],
        "B_w_gate": _B_in["w_gate"],
        "B_w_up": _B_in["w_up"],
        "B_w_down": _B_in["w_down"],
    }

def reference(A_x, A_wqkv, A_w_phi, A_wo, B_x, B_w_r, B_w_gate, B_w_up, B_w_down):
    def _A_ref(x, wqkv, w_phi, wo):
        B, S, D = x.shape
        H = 32; Dh = D // H
        qkv = (lambda x, *d: x.permute(*d))((x @ wqkv).reshape(B, S, 3, H, Dh), 2, 0, 3, 1, 4)
        q, k, v = qkv[0], qkv[1], qkv[2]
        pq = torch.einsum("bhsd,hdf->bhsf", q, w_phi)
        pk = torch.einsum("bhsd,hdf->bhsf", k, w_phi)
        phi_q = torch.concatenate([_softmax(pq, axis=-1), _softmax(-pq, axis=-1)], axis=-1)
        phi_k = torch.concatenate([_softmax(pk, axis=-1), _softmax(-pk, axis=-1)], axis=-1)
        kv = torch.einsum("bhsf,bhsd->bhfd", phi_k, v)
        z  = torch.einsum("bhsf->bhf", phi_k)
        num = torch.einsum("bhqf,bhfd->bhqd", phi_q, kv)
        den = torch.einsum("bhqf,bhf->bhq", phi_q, z)[..., None] + 1e-6
        o = num / den
        return (lambda x, *d: x.permute(*d))(o, 0, 2, 1, 3).reshape(B, S, D) @ wo

    def _B_ref(x, w_r, w_gate, w_up, w_down):
        B, S, D = x.shape
        C = 2
        r = x @ w_r
        idx = torch.argsort(-r, axis=-1)[:, :C]
        idx_e = (lambda x, n, axis: torch.repeat_interleave(x, n, dim=axis))(idx.reshape(B, C, 1), D, axis=2)
        x_sel = (lambda x, i, axis: torch.take_along_dim(x, i, dim=axis))(x, idx_e, axis=1)
        g = _silu(x_sel @ w_gate)
        u = x_sel @ w_up
        y = (g * u) @ w_down
        r_sel = _sigmoid((lambda x, i, axis: torch.take_along_dim(x, i, dim=axis))(r, idx, axis=1))
        y = y * r_sel.reshape(B, C, 1)
        b_off = (torch.arange(B) * S).reshape(B, 1)
        flat_idx = (idx + b_off).reshape(B * C)
        zero = (x * 0.0).reshape(B * S, D)
        upd = _scatter_add(zero, flat_idx, y.reshape(B * C, D), axis=0)
        return x + upd.reshape(B, S, D)

    x = A_x
    xn = _layernorm(x, axis=-1)
    return x + _A_ref(xn, A_wqkv, A_w_phi, A_wo) + _B_ref(xn, B_w_r, B_w_gate, B_w_up, B_w_down)
```

```asm
; @launch grid=(256,1,1) block=(256,1,1) lds=163840
.amdgcn_target "amdgcn-amd-amdhsa--gfx950"
.text
.globl parallel_sum__linear_kernel_hedgehog__moe_arch_mod__prompt_kernel
.p2align 8
.type parallel_sum__linear_kernel_hedgehog__moe_arch_mod__prompt_kernel,@function
parallel_sum__linear_kernel_hedgehog__moe_arch_mod__prompt_kernel:
    s_cmp_ge_u32 s2, 256
    s_cbranch_scc1 L_end
    s_load_dwordx16 s[32:47], s[0:1], 0
    s_load_dwordx8 s[48:55], s[0:1], 64
    s_getpc_b64 s[80:81]
    s_lshr_b32 s87, s2, 3
    s_lshl_b32 s87, s87, 7
    v_lshrrev_b32_e64 v13, 5, v0
    v_lshl_add_u32 v13, v13, 12, s87
    global_load_dword v13, v13, s[80:81]
    v_lshrrev_b32 v5, 6, v0
    v_and_b32 v1, 63, v0
    v_readfirstlane_b32 s83, v5
    v_lshlrev_b32 v2, 4, v1
    s_bfe_u32 s86, s2, 0x10002
    s_and_b32 s87, s2, 3
    s_lshl1_add_u32 s86, s87, s86
    s_lshr_b32 s87, s2, 3
    s_min_u32 s88, s87, 29
    s_mul_i32 s95, s88, 26
    s_lshr_b32 s95, s95, 8
    s_mul_i32 s89, s95, 10
    s_sub_u32 s88, s88, s89
    s_lshr_b32 s90, s86, 2
    s_mul_i32 s90, s90, 5
    s_lshr_b32 s89, s88, 1
    s_add_u32 s90, s90, s89
    s_and_b32 s88, s88, 1
    s_brev_b32 s89, s86
    s_lshr_b32 s89, s89, 30
    s_lshl1_add_u32 s88, s89, s88
    s_mul_i32 s91, s88, 160
    s_and_b32 s89, s83, 1
    s_lshl1_add_u32 s90, s90, s89
    s_mul_i32 s94, s89, 6400
    s_lshr_b32 s89, s83, 1
    s_lshl1_add_u32 s90, s90, s89
    s_mul_i32 s90, s90, 61440
    s_mul_i32 s88, s95, 1280
    s_add_u32 s90, s90, s88
    s_add_u32 s90, s90, s91
    s_mul_i32 s91, s91, 20
    s_lshl_b32 s92, s83, 10
    s_add_u32 s91, s91, s92
    s_add_u32 s94, s94, 16384
    s_mul_i32 s88, s89, 3200
    s_add_u32 m0, s94, s88
    v_mul_u32_u24 v6, 6554, v1
    v_lshrrev_b32_e64 v6, 16, v6
    v_mul_u32_u24 v6, 3680, v6
    v_add_u32 v14, v6, v2
    v_add_u32 v5, 64, v1
    v_mul_u32_u24 v6, 6554, v5
    v_lshrrev_b32_e64 v6, 16, v6
    v_mul_u32_u24 v6, 3680, v6
    v_add_u32_e64 v15, v6, v2
    v_add_u32 v5, 128, v1
    v_mul_u32_u24 v6, 6554, v5
    v_lshrrev_b32_e64 v6, 16, v6
    v_mul_u32_u24 v6, 3680, v6
    v_add_u32_e64 v16, v6, v2
    s_mov_b32 s80, 0xffffffff
    s_mov_b32 s81, 0x0
    v_cmp_gt_u32 vcc, 200, v0
    v_mov_b32 v9, 16777216
    v_cndmask_b32 v16, v9, v16, s[80:81]
    v_cndmask_b32_e64 v7, v9, v2, vcc
    s_mov_b32 s66, 2457600
    s_mov_b32 s67, 0x20000
    s_mov_b32 s70, 25600
    s_mov_b32 s71, 0x20000
    s_mov_b32 s6, 2621440
    s_mov_b32 s7, 0x20000
    s_mov_b32 s30, 8781824
    s_mov_b32 s31, 0x20000
    s_waitcnt lgkmcnt(0)
    s_mov_b64 s[64:65], s[34:35]
    s_mov_b64 s[68:69], s[36:37]
    buffer_load_dwordx4 v14, s[64:67], s90 offen offset:0 lds
    buffer_load_dwordx4 v15, s[64:67], s90 offen offset:1024 lds
    buffer_load_dwordx4 v16, s[64:67], s90 offen offset:2048 lds
    s_add_u32 m0, s92, 29184
    s_mov_b64 s[28:29], s[54:55]
    buffer_load_dwordx4 v7, s[68:71], s91 offen lds
    s_lshl_b32 s92, s83, 12
    s_mul_i32 s90, s89, 80
    s_add_u32 s90, s90, s94
    s_mul_i32 s91, s89, 1600
    s_add_u32 s91, s91, 29184
    s_mov_b64 s[4:5], s[32:33]
    s_mov_b64 s[76:77], s[42:43]
    s_mov_b64 s[8:9], s[38:39]
    s_mov_b64 s[12:13], s[44:45]
    s_mov_b64 s[16:17], s[46:47]
    s_mov_b64 s[20:21], s[48:49]
    s_mov_b64 s[24:25], s[50:51]
    s_getpc_b64 s[80:81]
L_pc:
    s_lshl2_add_u32 s88, s2, s83
    s_mul_i32 s88, s88, 192
    s_add_u32 s88, s88, L_table-L_pc
    v_min_u32 v12, 47, v1
    v_lshl_add_u32 v12, v12, 2, s88
    s_lshr_b32 s3, s86, 1
    s_lshr_b32 s88, s87, 3
    s_lshl2_add_u32 s3, s3, s88
    s_and_b32 s82, s86, 1
    s_and_b32 s89, s87, 7
    s_lshl3_add_u32 s82, s82, s89
    s_lshr_b32 s85, s82, 0
    s_and_b32 s84, s85, 3
    s_lshl_b32 s84, s84, 8
    v_and_b32 v3, 15, v1
    v_lshrrev_b32_e64 v4, 4, v1
    s_and_b32 s85, s85, 1
    s_lshl_b32 s85, s85, 7
    s_mov_b32 s78, 1280
    s_mov_b32 s79, 0x20000
    s_mul_i32 s88, s83, 320
    v_add_u32_e64 v7, s88, v2
    v_cmp_gt_u32 vcc, 1024, v7
    v_xor_b32 v6, s84, v7
    v_xor_b32 v5, s85, v7
    s_add_u32 m0, s88, 158720
    v_cndmask_b32_e64 v5, v5, v6, vcc
    s_mov_b64 exec, 0xfffff
    buffer_load_dwordx4 v5, s[76:79], 0 offen lds
    s_mov_b64 exec, -1
    global_load_dword v12, v12, s[80:81]
    buffer_load_dwordx2 v[10:11], off, s[28:31], 0 sc1
    s_lshl_b32 m0, s83, 1
    s_cmp_eq_u32 s83, 3
    s_cselect_b32 s88, 5, 0
    s_movrels_b64 s[80:81], s[44:45]
    s_add_u32 s88, s88, 15
    s_lshl_b32 s88, s88, 17
    s_sub_u32 s88, s88, 128
    v_mul_u32_u24 v15, s88, v1
    v_lshlrev_b32_e64 v16, 21, v1
    s_mov_b32 s88, 0x290000
    s_mov_b32 s89, 5029888
    v_writelane_b32 v16, s89, 2
    s_mov_b32 s89, 6029312
    v_writelane_b32 v16, s89, 3
    s_mov_b64 exec, 3
    global_load_dword v15, v15, s[80:81]
    s_mov_b64 exec, 15
    buffer_load_dword v16, v16, s[28:31], s88 offen
    s_mov_b64 exec, -1
    s_and_b32 s88, s82, 7
    s_lshl3_add_u32 s88, s3, s88
    s_lshl2_add_u32 s88, s88, s83
    s_mul_i32 s88, s88, 5120
    v_lshrrev_b32 v6, 1, v1
    v_lshlrev_b32 v6, 10, v6
    v_lshl_add_u32 v14, v1, 7, v6
    s_mov_b64 exec, 0xff
    buffer_load_dword v14, v14, s[4:7], s88 offen offset:1024
    s_mov_b64 exec, -1
    v_mov_b32 v24, -1
    v_mov_b32 v25, -1
    v_mov_b32 v26, -1
    v_mov_b32 v27, -1
    s_lshl1_add_u32 s88, s87, s83
    s_lshr_b32 s89, s87, 1
    s_add_u32 s89, s89, 64
    s_cmp_lt_u32 s83, 2
    s_cselect_b32 s88, s88, s89
    s_add_u32 s89, s86, s87
    s_and_b32 s89, s89, 7
    s_mul_i32 s89, s89, 80
    s_add_u32 s89, s89, s88
    s_lshr_b32 s89, s89, 2
    s_mul_i32 s89, s89, 5120
    s_and_b32 s88, s88, 3
    s_lshl_b32 s88, s88, 8
    s_add_u32 s89, s89, s88
    s_add_u32 s89, s89, 7864320
    s_and_b32 s88, s87, 1
    s_add_u32 s88, s88, s83
    s_cmp_lt_u32 s88, 3
    s_cselect_b32 s89, s89, 16777216
    v_lshlrev_b32_e64 v5, 4, v3
    v_lshl_add_u32 v5, v4, 10, v5
    buffer_store_dwordx4 v[24:27], v5, s[28:31], s89 offen sc1
    s_add_u32 s89, s89, 4096
    s_mov_b64 exec, 0xffff
    buffer_store_dwordx4 v[24:27], v5, s[28:31], s89 offen sc1
    s_mov_b64 exec, -1
    s_nop 0
    v_mov_b32_e64 v24, 0
    v_mov_b32 v28, 0x3f803f80
    v_mov_b32_e64 v25, 0
    v_mov_b32 v29, 0x3f803f80
    v_mov_b32_e64 v26, 0
    v_mov_b32 v30, 0x3f803f80
    v_mov_b32_e64 v27, 0
    v_mov_b32 v31, 0x3f803f80
    v_add_u32_e64 v5, s92, v2
    ds_write_b128 v5, v[24:27] offset:0
    v_subrev_u32 v6, 20, v1
    v_min_u32 v6, v6, v1
    v_lshlrev_b32_e64 v6, 1, v6
    v_mad_u32_u24 v6, v1, 40, v6
    ds_write_b128 v5, v[24:27] offset:1024
    v_add_u32_e64 v6, s92, v6
    s_mov_b32 exec_hi, 0xff
    ds_write_b16 v6, v28 offset:0
    s_mov_b64 exec, 0xfffff
    v_add_u32 v7, 158720, v7
    ds_write_b128 v7, v[28:31] offset:2176
    s_mov_b64 exec, -1
    s_cmp_eq_u32 s95, 2
    s_cselect_b32 s87, s92, s91
    v_lshrrev_b32 v7, 2, v3
    v_and_b32_e64 v8, 3, v1
    v_lshl_add_u32 v6, v4, 3, v7
    v_lshlrev_b32_e64 v32, 3, v8
    v_mad_u32_u24 v32, v6, 40, v32
    v_add_u32 v32, s87, v32
    v_min_u32 v6, 1, v8
    v_mul_u32_u24 v6, 40, v6
    v_sub_u32 v33, v32, v6
    s_add_u32 s86, s92, 1600
    v_mov_b32_e64 v34, s86
    v_lshl_add_u32 v6, v7, 3, v8
    v_lshrrev_b32_e64 v5, 3, v3
    v_lshl_add_u32 v6, v5, 2, v6
    v_mul_u32_u24 v6, 160, v6
    v_add_u32_e64 v37, s90, v6
    v_lshl_add_u32 v36, v4, 4, v37
    s_mov_b32 vcc_lo, 0xffffffff
    s_mov_b32 vcc_hi, 0xffff
    v_cndmask_b32 v35, v34, v32, vcc
    s_mov_b32 vcc_hi, 0x0
    v_cndmask_b32 v38, v34, v32, vcc
    s_mov_b32 vcc_lo, 0x11111111
    s_mov_b32 vcc_hi, 0xeeee1111
    v_cndmask_b32_e64 v39, v34, v33, vcc
    s_mov_b32 vcc_hi, 0xeeeeeeee
    v_cndmask_b32_e64 v40, v34, v33, vcc
    s_mov_b32 vcc_lo, 0xeeee
    s_mov_b32 vcc_hi, 0x0
    v_add_u32 v41, 1312, v33
    v_cndmask_b32_e64 v41, v34, v41, vcc
    s_mov_b32 vcc_lo, 0x0
    s_mov_b32 vcc_hi, 0x33330000
    v_cndmask_b32_e64 v42, v34, v32, vcc
    s_mov_b32 vcc_hi, 0x33333333
    v_cndmask_b32_e64 v43, v34, v32, vcc
    s_mov_b32 vcc_lo, 0x3333
    s_mov_b32 vcc_hi, 0x0
    v_add_u32 v44, 1304, v32
    v_cndmask_b32 v44, v34, v44, vcc
    v_cmp_gt_u32 vcc, 8, v3
    v_lshlrev_b32 v6, 4, v8
    v_lshl_add_u32 v6, v7, 8, v6
    v_lshl_add_u32 v32, v4, 6, v6
    v_xor_b32 v34, 128, v32
    v_cndmask_b32 v34, v9, v34, vcc
    v_min_u32 v6, 1, v7
    v_lshlrev_b32 v6, 7, v6
    v_xor_b32 v33, v6, v32
    v_lshlrev_b32 v45, 1, v1
    v_lshrrev_b32 v5, 3, v1
    v_and_b32 v6, 7, v1
    v_lshrrev_b32 v17, 1, v5
    v_xor_b32_e64 v6, v6, v17
    v_mul_u32_u24 v5, 1280, v5
    v_lshl_add_u32 v17, v6, 4, v5
    v_xor_b32_e64 v18, 64, v17
    v_add_u32 v18, 9216, v18
    v_add_u32 v19, 18432, v17
    v_add_u32 v20, 18432, v18
    s_lshl2_add_u32 s93, s3, s83
    s_mul_i32 s93, s93, 40960
    s_mul_i32 s94, s83, 20480
    s_add_u32 s94, s94, 71680
    s_add_u32 m0, s94, 0
    s_xor_b32 s86, s84, 0
    s_add_u32 s86, s86, s93
    buffer_load_dwordx4 v17, s[4:7], s86 offen offset:0 lds
    buffer_load_dwordx4 v18, s[4:7], s86 offen offset:1024 lds
    buffer_load_dwordx4 v19, s[4:7], s86 offen offset:2048 lds
    buffer_load_dwordx4 v20, s[4:7], s86 offen offset:3072 lds
    v_cmp_gt_u32_e64 vcc, 40, v1
    v_mul_u32_u24 v6, 6554, v1
    v_lshrrev_b32_e64 v6, 16, v6
    v_mul_u32_u24 v6, 1120, v6
    v_add_u32_e64 v6, v6, v2
    s_add_u32 m0, s92, 2048
    v_cndmask_b32_e64 v47, v9, v6, vcc
    s_mov_b32 s10, 819200
    s_mov_b32 s11, 0x20000
    v_min_u32_e64 v52, 7, v1
    v_mul_u32_u24 v52, 1280, v52
    s_mov_b32 s26, 2621440
    s_mov_b32 s27, 0x20000
    s_waitcnt vmcnt(11) lgkmcnt(0)
    s_barrier
    ds_read_b128 v[100:103], v36 offset:0
    ds_read_b128 v[108:111], v36 offset:640
    ds_read_b64_tr_b16 v[116:117], v35 offset:0
    ds_read_b64_tr_b16 v[118:119], v38 offset:160
    ds_read_b64_tr_b16 v[120:121], v39 offset:32
    ds_read_b64_tr_b16 v[122:123], v40 offset:192
    ds_read_b128 v[104:107], v37 offset:64
    ds_read_b128 v[112:115], v37 offset:704
    ds_read_b64_tr_b16 v[124:125], v41 offset:0
    ds_read_b64_tr_b16 v[126:127], v41 offset:160
    ds_read_b64_tr_b16 v[128:129], v42 offset:24
    ds_read_b64_tr_b16 v[130:131], v43 offset:184
    ds_read_b64_tr_b16 v[132:133], v44 offset:0
    ds_read_b64_tr_b16 v[134:135], v44 offset:160
    s_waitcnt lgkmcnt(10)
    v_mfma_f32_16x16x32_bf16 v[136:139], v[100:103], v[116:119], 0
    v_mfma_f32_16x16x32_bf16 v[148:151], v[108:111], v[116:119], 0
    s_waitcnt lgkmcnt(8)
    v_mfma_f32_16x16x32_bf16 v[140:143], v[100:103], v[120:123], 0
    s_waitcnt vmcnt(10)
    v_readlane_b32 s67, v12, 35
    v_readlane_b32 s68, v12, 36
    v_mfma_f32_16x16x32_bf16 v[152:155], v[108:111], v[120:123], 0
    s_waitcnt lgkmcnt(4)
    v_readlane_b32 s32, v12, 0
    v_readlane_b32 s33, v12, 1
    v_mfma_f32_16x16x32_bf16 v[140:143], v[104:107], v[124:127], v[140:143]
    buffer_load_dwordx4 v47, s[8:11], s67 offen lds
    v_mfma_f32_16x16x32_bf16 v[152:155], v[112:115], v[124:127], v[152:155]
    s_waitcnt lgkmcnt(2)
    v_mfma_f32_16x16x32_bf16 v[144:147], v[100:103], v[128:131], 0
    buffer_load_dwordx4 v47, s[8:11], s68 offen offset:1024 lds
    v_mfma_f32_16x16x32_bf16 v[156:159], v[108:111], v[128:131], 0
    s_waitcnt lgkmcnt(0)
    v_mfma_f32_16x16x32_bf16 v[144:147], v[104:107], v[132:135], v[144:147]
    v_mfma_f32_16x16x32_bf16 v[156:159], v[112:115], v[132:135], v[156:159]
    v_cvt_pk_bf16_f32 v160, v136, v137
    v_cvt_pk_bf16_f32 v161, v138, v139
    v_cvt_pk_bf16_f32 v162, v148, v149
    v_cvt_pk_bf16_f32 v163, v150, v151
    buffer_store_dwordx4 v[160:163], v32, s[28:31], s32 offen offset:0 sc1
    v_cvt_pk_bf16_f32 v164, v140, v141
    v_cvt_pk_bf16_f32 v165, v142, v143
    v_cvt_pk_bf16_f32 v166, v152, v153
    v_cvt_pk_bf16_f32 v167, v154, v155
    v_mfma_f32_16x16x32_bf16 v[100:103], v[28:31], v[160:163], 0
    buffer_store_dwordx4 v[164:167], v33, s[28:31], s32 offen offset:1024 sc1
    v_cvt_pk_bf16_f32 v168, v144, v145
    v_cvt_pk_bf16_f32 v169, v146, v147
    v_cvt_pk_bf16_f32 v170, v156, v157
    v_cvt_pk_bf16_f32 v171, v158, v159
    v_mfma_f32_16x16x32_bf16 v[104:107], v[28:31], v[164:167], 0
    buffer_store_dwordx4 v[168:171], v34, s[28:31], s32 offen offset:2048 sc1
    v_mfma_f32_16x16x32_bf16 v[108:111], v[28:31], v[168:171], 0
    s_mov_b32 s80, 0xffff0000
    s_mov_b32 s81, 0x0
    v_cmp_eq_u32_e64 vcc, 2, v4
    s_nop 2
    v_cndmask_b32 v5, v100, v104, s[80:81]
    s_nop 0
    v_cndmask_b32 v5, v5, v108, vcc
    v_lshlrev_b32_e64 v112, 2, v0
    ds_write_b32 v112, v5 offset:33280
    v_xor_b32 v112, 256, v112
    s_waitcnt lgkmcnt(0)
    s_barrier
    ds_read_b32 v113, v112 offset:33280
    s_bitcmp1_b32 s83, 0
    s_cselect_b64 vcc, -1, 0
    s_waitcnt lgkmcnt(0)
    v_add_f32 v5, v5, v113
    v_cvt_pk_bf16_f32 v113, 0, v5
    v_sub_f32 v114, v5, v113
    v_cndmask_b32 v5, v5, v114, vcc
    v_cvt_pk_bf16_f32 v5, v5, v5
    buffer_store_short v5, v45, s[28:31], s33 offen sc1
    s_add_u32 m0, s94, 4096
    s_xor_b32 s86, s84, 128
    s_add_u32 s86, s86, s93
    buffer_load_dwordx4 v17, s[4:7], s86 offen offset:0 lds
    buffer_load_dwordx4 v18, s[4:7], s86 offen offset:1024 lds
    buffer_load_dwordx4 v19, s[4:7], s86 offen offset:2048 lds
    buffer_load_dwordx4 v20, s[4:7], s86 offen offset:3072 lds
    v_and_b32 v6, 1, v1
    v_xor_b32_e64 v6, 1, v6
    v_mul_u32_u24 v6, 2176, v6
    v_lshl_add_u32 v6, v4, 4, v6
    v_add_u32 v21, 158720, v6
    ds_read_b128 v[100:103], v21 offset:0
    ds_read_b128 v[104:107], v21 offset:64
    ds_read_b128 v[108:111], v21 offset:128
    ds_read_b128 v[112:115], v21 offset:192
    s_waitcnt lgkmcnt(2)
    v_mfma_f32_16x16x32_bf16 v[184:187], v[100:103], v[28:31], 0
    ds_read_b128 v[32:35], v21 offset:256
    v_readlane_b32 s34, v12, 2
    v_mfma_f32_16x16x32_bf16 v[184:187], v[104:107], v[28:31], v[184:187]
    ds_read_b128 v[36:39], v21 offset:320
    s_waitcnt lgkmcnt(2)
    v_mfma_f32_16x16x32_bf16 v[184:187], v[108:111], v[28:31], v[184:187]
    ds_read_b128 v[40:43], v21 offset:384
    v_readlane_b32 s35, v12, 3
    v_mfma_f32_16x16x32_bf16 v[184:187], v[112:115], v[28:31], v[184:187]
    ds_read_b128 v[132:135], v21 offset:448
    s_waitcnt lgkmcnt(2)
    v_mfma_f32_16x16x32_bf16 v[184:187], v[32:35], v[28:31], v[184:187]
    ds_read_b128 v[136:139], v21 offset:512
    v_readlane_b32 s36, v12, 4
    v_mfma_f32_16x16x32_bf16 v[184:187], v[36:39], v[28:31], v[184:187]
    ds_read_b128 v[140:143], v21 offset:576
    s_waitcnt lgkmcnt(2)
    v_mfma_f32_16x16x32_bf16 v[184:187], v[40:43], v[28:31], v[184:187]
    ds_read_b128 v[144:147], v21 offset:640
    v_readlane_b32 s37, v12, 5
    v_mfma_f32_16x16x32_bf16 v[184:187], v[132:135], v[28:31], v[184:187]
    ds_read_b128 v[148:151], v21 offset:704
    s_waitcnt lgkmcnt(2)
    v_mfma_f32_16x16x32_bf16 v[184:187], v[136:139], v[28:31], v[184:187]
    ds_read_b128 v[152:155], v21 offset:768
    v_readlane_b32 s38, v12, 6
    v_mfma_f32_16x16x32_bf16 v[184:187], v[140:143], v[28:31], v[184:187]
    ds_read_b128 v[156:159], v21 offset:832
    s_waitcnt lgkmcnt(2)
    v_mfma_f32_16x16x32_bf16 v[184:187], v[144:147], v[28:31], v[184:187]
    ds_read_b128 v[160:163], v21 offset:896
    v_readlane_b32 s39, v12, 7
    v_mfma_f32_16x16x32_bf16 v[184:187], v[148:151], v[28:31], v[184:187]
    ds_read_b128 v[164:167], v21 offset:960
    s_waitcnt lgkmcnt(2)
    v_mfma_f32_16x16x32_bf16 v[184:187], v[152:155], v[28:31], v[184:187]
    ds_read_b128 v[168:171], v21 offset:1024
    v_readlane_b32 s40, v12, 8
    v_mfma_f32_16x16x32_bf16 v[184:187], v[156:159], v[28:31], v[184:187]
    ds_read_b128 v[172:175], v21 offset:1088
    s_waitcnt lgkmcnt(2)
    v_mfma_f32_16x16x32_bf16 v[184:187], v[160:163], v[28:31], v[184:187]
    ds_read_b128 v[176:179], v21 offset:1152
    v_readlane_b32 s41, v12, 9
    v_mfma_f32_16x16x32_bf16 v[184:187], v[164:167], v[28:31], v[184:187]
    ds_read_b128 v[180:183], v21 offset:1216
    s_waitcnt lgkmcnt(2)
    v_mfma_f32_16x16x32_bf16 v[184:187], v[168:171], v[28:31], v[184:187]
    v_readlane_b32 s42, v12, 10
    v_readlane_b32 s43, v12, 11
    v_mfma_f32_16x16x32_bf16 v[184:187], v[172:175], v[28:31], v[184:187]
    s_waitcnt lgkmcnt(0)
    v_readlane_b32 s44, v12, 12
    v_readlane_b32 s45, v12, 13
    v_mfma_f32_16x16x32_bf16 v[184:187], v[176:179], v[28:31], v[184:187]
    v_readlane_b32 s46, v12, 14
    v_readlane_b32 s47, v12, 15
    v_mfma_f32_16x16x32_bf16 v[184:187], v[180:183], v[28:31], v[184:187]
    v_readlane_b32 s48, v12, 16
    v_readlane_b32 s49, v12, 17
    v_readlane_b32 s50, v12, 18
    v_readlane_b32 s51, v12, 19
    v_readlane_b32 s52, v12, 20
    v_readlane_b32 s53, v12, 21
    v_readlane_b32 s54, v12, 22
    v_readlane_b32 s55, v12, 23
    v_readlane_b32 s56, v12, 24
    v_readlane_b32 s57, v12, 25
    v_readlane_b32 s58, v12, 26
    v_readlane_b32 s59, v12, 27
    v_readlane_b32 s60, v12, 28
    v_readlane_b32 s61, v12, 29
    v_readlane_b32 s62, v12, 30
    v_readlane_b32 s63, v12, 31
    v_readlane_b32 s64, v12, 32
    v_readlane_b32 s65, v12, 33
    v_readlane_b32 s66, v12, 34
    v_readlane_b32 s69, v12, 37
    v_readlane_b32 s70, v12, 38
    v_readlane_b32 s71, v12, 39
    v_readlane_b32 s72, v12, 40
    v_readlane_b32 s73, v12, 41
    v_readlane_b32 s74, v12, 42
    v_readlane_b32 s75, v12, 43
    v_readlane_b32 s76, v12, 44
    v_readlane_b32 s77, v12, 45
    v_readlane_b32 s78, v12, 46
    v_readlane_b32 s79, v12, 47
    v_and_b32 v6, 31, v1
    v_lshlrev_b32 v6, 2, v6
    v_add_u32 v6, 163584, v6
    ds_write_b32 v6, v24
    v_lshrrev_b32 v6, 1, v3
    v_xor_b32 v6, v6, v4
    v_lshlrev_b32_e64 v6, 4, v6
    v_lshl_add_u32 v6, v3, 7, v6
    v_add_u32 v22, s94, v6
    v_xor_b32 v6, 64, v6
    v_add_u32 v23, s94, v6
    v_min_u32 v46, 1, v4
    v_lshlrev_b32_e64 v46, 24, v46
    v_lshl_add_u32 v46, v1, 3, v46
    v_mad_u32_u24 v49, v3, 40, s92
    v_lshl_add_u32 v48, v4, 3, v49
    s_mov_b32 s14, 1966080
    s_mov_b32 s15, 0x20000
    s_mov_b32 s18, 1966080
    s_mov_b32 s19, 0x20000
    s_mov_b32 s22, 1966080
    s_mov_b32 s23, 0x20000
    s_waitcnt vmcnt(10)
    ds_read_b128 a[4:7], v22 offset:0
    ds_read_b128 a[12:15], v23 offset:0
    ds_read_b128 a[8:11], v22 offset:2048
    ds_read_b128 a[16:19], v23 offset:2048
    v_add_u32 v10, 0x7f4a7c15, v10
    v_add_u32 v11, 0x9e3779b9, v11
    v_min_u32 v84, 7, v1
    v_lshlrev_b32 v84, 7, v84
    v_cmp_gt_u32 vcc, 8, v3
    v_lshl_add_u32 v85, v4, 4, s77
    v_lshl_add_u32 v85, v7, 6, v85
    v_cndmask_b32 v85, v9, v85, vcc
    v_cmp_gt_u32 vcc, 24, v1
    s_add_u32 s90, s59, 61120
    v_add_u32_e64 v5, s90, v2
    s_sub_u32 s90, s59, 256
    v_cndmask_b32 v89, v9, v5, vcc
    v_cmp_gt_u32 vcc, 20, v1
    v_add_u32 v6, s90, v2
    v_add_u32 v5, s58, v2
    v_cndmask_b32 v89, v89, v6, vcc
    v_cmp_gt_u32 vcc, 16, v1
    v_mov_b32 v96, -1
    v_mov_b32 v97, -1
    v_cndmask_b32 v89, v89, v5, vcc
    v_cmp_gt_u32 vcc, 32, v1
    v_mov_b32 v98, -1
    v_mov_b32 v99, -1
    v_cndmask_b32_e64 v93, v9, v2, vcc
    v_add_u32 v63, 4096, v2
    v_lshrrev_b32_e64 v5, 3, v3
    v_lshl_add_u32 v6, v5, 1, v4
    v_and_b32 v6, 3, v6
    v_lshlrev_b32 v6, 6, v6
    v_mul_u32_u24 v5, 1280, v5
    v_lshl_add_u32 v6, v8, 4, v6
    v_add_u32_e64 v6, v6, v5
    v_bfe_u32 v5, v1, 2, 1
    v_mul_u32_u24 v53, 2560, v5
    v_add_u32_e64 v53, v53, v6
    v_add_u32 v54, 51200, v53
    v_add_u32 v6, 102400, v6
    v_mul_u32_u24 v55, 768, v5
    v_add_u32 v55, v55, v6
    v_lshlrev_b32 v5, 8, v5
    v_sub_u32 v56, v55, v5
    v_mul_u32_u24 v5, 13, v3
    v_lshrrev_b32 v5, 6, v5
    v_min_u32 v5, 2, v5
    v_mad_u32_u24 v5, v5, 48, v2
    v_lshl_add_u32 v86, v4, 7, v5
    v_cmp_gt_u32 vcc, 16, v1
    v_lshlrev_b32 v5, 2, v1
    v_lshlrev_b32 v6, 4, v3
    v_cndmask_b32 v82, v9, v5, vcc
    v_cmp_gt_u32_e64 vcc, 4, v3
    v_lshl_add_u32 v6, v4, 6, v6
    v_lshl_add_u32 v5, v4, 3, v7
    v_cndmask_b32 v83, v9, v6, vcc
    v_min_u32 v61, 19, v5
    v_add_u32 v5, 4, v5
    v_min_u32 v62, 19, v5
    v_lshrrev_b32 v5, 1, v8
    v_mul_u32_u24 v5, 40, v5
    v_add_u32 v5, 153600, v5
    v_lshl_add_u32 v61, v61, 8, v5
    v_lshl_add_u32 v62, v62, 8, v5
    v_and_b32_e64 v5, 1, v1
    v_mul_u32_u24 v6, 80, v5
    v_add_u32 v57, v6, v61
    v_add_u32 v58, v6, v62
    v_mad_u32_u24 v59, v5, 24, v61
    v_mad_u32_u24 v60, v5, 24, v62
    v_lshl_add_u32 v61, v5, 4, v61
    v_lshl_add_u32 v62, v5, 4, v62
    v_cmp_gt_u32 vcc, 16, v1
    v_lshlrev_b32 v5, 4, v3
    v_lshl_add_u32 v50, v4, 10, v5
    v_cndmask_b32 v51, v9, v63, vcc
    v_lshrrev_b32 v5, 3, v1
    v_mul_u32_u24 v68, 2944, v5
    v_add_u32_e64 v68, v68, v2
    v_mul_u32_u24 v69, 1152, v5
    v_add_u32 v69, v69, v2
    v_cmp_gt_u32 vcc, 32, v1
    v_and_b32_e64 v5, 1, v4
    v_mul_u32_u24 v5, 20480, v5
    v_lshl_add_u32 v5, v3, 4, v5
    v_lshrrev_b32_e64 v6, 5, v1
    v_lshl_add_u32 v87, v6, 9, v5
    v_cndmask_b32_e64 v88, v9, v87, vcc
    v_lshl_add_u32 v5, v3, 4, s76
    v_lshl_add_u32 v71, v4, 10, v5
    v_cndmask_b32 v90, v9, v71, vcc
    s_lshl_b32 s90, s83, 12
    s_add_u32 s90, s90, 69632
    v_and_b32_e64 v5, 31, v1
    v_lshl_add_u32 v64, v5, 7, s90
    v_and_b32_e64 v5, 7, v1
    v_lshl_add_u32 v64, v5, 4, v64
    v_lshrrev_b32_e64 v5, 5, v1
    v_lshl_add_u32 v64, v5, 14, v64
    s_lshr_b32 s90, s83, 1
    v_lshl_add_u32 v5, v4, 2, v7
    v_bfe_u32 v6, v1, 1, 1
    s_lshl_b32 s90, s90, 14
    v_and_b32 v73, 7, v5
    v_xor_b32 v6, v6, v73
    s_add_u32 s90, s90, 69632
    v_lshl_add_u32 v6, v6, 4, s90
    v_lshl_add_u32 v6, v5, 7, v6
    s_and_b32 s90, s83, 1
    v_and_b32 v5, 1, v1
    v_lshl_add_u32 v73, v5, 3, v6
    s_lshl_b32 s91, s90, 5
    v_xor_b32 v74, 32, v73
    v_xor_b32 v75, 64, v73
    v_xor_b32 v76, s91, v75
    s_and_b32 s91, s3, 1
    s_lshl_b32 s91, s91, 3
    v_xor_b32 v75, s91, v75
    s_lshl_b32 s91, s91, 2
    v_xor_b32 v73, s91, v73
    v_xor_b32 v74, s91, v74
    v_lshl_add_u32 v6, s90, 3, v3
    s_add_u32 s91, s90, 7
    v_cmp_le_u32 vcc, 8, v6
    v_lshlrev_b32_e64 v5, s91, v4
    v_lshl_add_u32 v5, v3, 4, v5
    v_cndmask_b32_e64 v65, v9, v5, vcc
    s_add_u32 m0, s94, 8192
    s_xor_b32 s86, s84, 256
    s_add_u32 s86, s86, s93
    buffer_load_dwordx4 v17, s[4:7], s86 offen offset:0 lds
    buffer_load_dwordx4 v18, s[4:7], s86 offen offset:1024 lds
    buffer_load_dwordx4 v19, s[4:7], s86 offen offset:2048 lds
    buffer_load_dwordx4 v20, s[4:7], s86 offen offset:3072 lds
    s_waitcnt vmcnt(8)
    s_barrier
    buffer_store_dwordx2 v[10:11], v46, s[28:31], s34 offen sc1
    s_add_u32 m0, s94, 12288
    s_xor_b32 s86, s84, 384
    s_add_u32 s86, s86, s93
    buffer_load_dwordx4 v17, s[4:7], s86 offen offset:0 lds
    buffer_load_dwordx4 v18, s[4:7], s86 offen offset:1024 lds
    buffer_load_dwordx4 v19, s[4:7], s86 offen offset:2048 lds
    buffer_load_dwordx4 v20, s[4:7], s86 offen offset:3072 lds
    s_waitcnt vmcnt(9) lgkmcnt(0)
    v_mfma_f32_16x16x32_bf16 v[188:191], a[4:7], a[4:7], 0
    ds_read_b128 a[20:23], v22 offset:4096
    s_add_u32 m0, s94, 16384
    v_mfma_f32_16x16x32_bf16 v[196:199], v[100:103], a[4:7], 0
    ds_read_b128 a[28:31], v23 offset:4096
    s_xor_b32 s86, s84, 512
    v_mfma_f32_16x16x32_bf16 v[192:195], a[8:11], a[8:11], 0
    ds_read_b128 a[24:27], v22 offset:6144
    s_add_u32 s86, s86, s93
    v_mfma_f32_16x16x32_bf16 v[200:203], v[100:103], a[8:11], 0
    ds_read_b128 a[32:35], v23 offset:6144
    s_lshl_b32 s90, s83, 5
    v_mfma_f32_16x16x32_bf16 v[188:191], a[12:15], a[12:15], v[188:191]
    buffer_load_dwordx4 v17, s[4:7], s86 offen offset:0 lds
    v_mfma_f32_16x16x32_bf16 v[196:199], v[104:107], a[12:15], v[196:199]
    buffer_load_dwordx4 v18, s[4:7], s86 offen offset:1024 lds
    v_mfma_f32_16x16x32_bf16 v[192:195], a[16:19], a[16:19], v[192:195]
    buffer_load_dwordx4 v19, s[4:7], s86 offen offset:2048 lds
    v_mfma_f32_16x16x32_bf16 v[200:203], v[104:107], a[16:19], v[200:203]
    buffer_load_dwordx4 v20, s[4:7], s86 offen offset:3072 lds
    s_waitcnt vmcnt(9) lgkmcnt(0)
    v_mfma_f32_16x16x32_bf16 v[188:191], a[20:23], a[20:23], v[188:191]
    ds_read_b128 a[36:39], v22 offset:8192
    s_add_u32 m0, s94, 0
    v_mfma_f32_16x16x32_bf16 v[196:199], v[108:111], a[20:23], v[196:199]
    ds_read_b128 a[44:47], v23 offset:8192
    s_xor_b32 s86, s84, 640
    v_mfma_f32_16x16x32_bf16 v[192:195], a[24:27], a[24:27], v[192:195]
    ds_read_b128 a[40:43], v22 offset:10240
    s_add_u32 s86, s86, s93
    v_mfma_f32_16x16x32_bf16 v[200:203], v[108:111], a[24:27], v[200:203]
    ds_read_b128 a[48:51], v23 offset:10240
    v_lshl_add_u32 v6, v8, 3, s90
    v_mfma_f32_16x16x32_bf16 v[188:191], a[28:31], a[28:31], v[188:191]
    ds_read_b64_tr_b16 v[204:205], v48 offset:2048
    v_lshl_add_u32 v6, v7, 7, v6
    v_mfma_f32_16x16x32_bf16 v[196:199], v[112:115], a[28:31], v[196:199]
    ds_read_b64_tr_b16 v[206:207], v48 offset:3072
    v_add_u32_e64 v6, 0, v6
    v_mfma_f32_16x16x32_bf16 v[192:195], a[32:35], a[32:35], v[192:195]
    ds_read_b64_tr_b16 v[208:209], v49 offset:2080
    v_lshl_add_u32 v70, v4, 10, v6
    v_mfma_f32_16x16x32_bf16 v[200:203], v[112:115], a[32:35], v[200:203]
    ds_read_b64_tr_b16 v[210:211], v49 offset:3104
    v_and_b32_e64 v5, 1, v1
    buffer_load_dwordx4 v17, s[4:7], s86 offen offset:0 lds
    buffer_load_dwordx4 v18, s[4:7], s86 offen offset:1024 lds
    buffer_load_dwordx4 v19, s[4:7], s86 offen offset:2048 lds
    buffer_load_dwordx4 v20, s[4:7], s86 offen offset:3072 lds
    s_waitcnt vmcnt(8) lgkmcnt(4)
    v_mfma_f32_16x16x32_bf16 v[188:191], a[36:39], a[36:39], v[188:191]
    ds_read_b128 a[52:55], v22 offset:12288
    s_add_u32 m0, s94, 4096
    v_mfma_f32_16x16x32_bf16 v[196:199], v[32:35], a[36:39], v[196:199]
    ds_read_b128 a[60:63], v23 offset:12288
    s_xor_b32 s86, s84, 768
    v_mfma_f32_16x16x32_bf16 v[192:195], a[40:43], a[40:43], v[192:195]
    ds_read_b128 a[56:59], v22 offset:14336
    s_add_u32 s86, s86, s93
    v_mfma_f32_16x16x32_bf16 v[200:203], v[32:35], a[40:43], v[200:203]
    ds_read_b128 a[64:67], v23 offset:14336
    v_lshlrev_b32_e64 v5, 7, v5
    v_mfma_f32_16x16x32_bf16 v[188:191], a[44:47], a[44:47], v[188:191]
    buffer_load_dwordx4 v17, s[4:7], s86 offen offset:0 lds
    v_mfma_f32_16x16x32_bf16 v[196:199], v[36:39], a[44:47], v[196:199]
    buffer_load_dwordx4 v18, s[4:7], s86 offen offset:1024 lds
    v_mfma_f32_16x16x32_bf16 v[192:195], a[48:51], a[48:51], v[192:195]
    buffer_load_dwordx4 v19, s[4:7], s86 offen offset:2048 lds
    v_mfma_f32_16x16x32_bf16 v[200:203], v[36:39], a[48:51], v[200:203]
    buffer_load_dwordx4 v20, s[4:7], s86 offen offset:3072 lds
    s_waitcnt vmcnt(8) lgkmcnt(0)
    v_mfma_f32_16x16x32_bf16 v[188:191], a[52:55], a[52:55], v[188:191]
    ds_read_b128 a[68:71], v22 offset:16384
    v_add_u32 v5, 153600, v5
    v_mfma_f32_16x16x32_bf16 v[196:199], v[40:43], a[52:55], v[196:199]
    ds_read_b128 a[76:79], v23 offset:16384
    v_lshl_add_u32 v92, v4, 4, v5
    v_mfma_f32_16x16x32_bf16 v[192:195], a[56:59], a[56:59], v[192:195]
    ds_read_b128 a[72:75], v22 offset:18432
    v_lshl_add_u32 v6, v7, 2, v4
    v_mfma_f32_16x16x32_bf16 v[200:203], v[40:43], a[56:59], v[200:203]
    ds_read_b128 a[80:83], v23 offset:18432
    v_lshl_add_u32 v6, v6, 1, s90
    v_mfma_f32_16x16x32_bf16 v[188:191], a[60:63], a[60:63], v[188:191]
    buffer_load_dwordx2 v[44:45], v84, s[28:31], s35 offen sc1
    v_mfma_f32_16x16x32_bf16 v[196:199], v[132:135], a[60:63], v[196:199]
    s_add_u32 m0, s94, 8192
    s_xor_b32 s86, s84, 896
    s_add_u32 s86, s86, s93
    v_mfma_f32_16x16x32_bf16 v[192:195], a[64:67], a[64:67], v[192:195]
    buffer_load_dwordx4 v17, s[4:7], s86 offen offset:0 lds
    v_mfma_f32_16x16x32_bf16 v[200:203], v[132:135], a[64:67], v[200:203]
    buffer_load_dwordx4 v18, s[4:7], s86 offen offset:1024 lds
    buffer_load_dwordx4 v19, s[4:7], s86 offen offset:2048 lds
    buffer_load_dwordx4 v20, s[4:7], s86 offen offset:3072 lds
    s_waitcnt vmcnt(9) lgkmcnt(0)
    v_mfma_f32_16x16x32_bf16 v[188:191], a[68:71], a[68:71], v[188:191]
    ds_read_b128 a[84:87], v22 offset:0
    s_add_u32 m0, s94, 12288
    v_mfma_f32_16x16x32_bf16 v[196:199], v[136:139], a[68:71], v[196:199]
    ds_read_b128 a[92:95], v23 offset:0
    s_xor_b32 s86, s85, 1024
    v_mfma_f32_16x16x32_bf16 v[192:195], a[72:75], a[72:75], v[192:195]
    ds_read_b128 a[88:91], v22 offset:2048
    s_add_u32 s86, s86, s93
    v_mfma_f32_16x16x32_bf16 v[200:203], v[136:139], a[72:75], v[200:203]
    ds_read_b128 a[96:99], v23 offset:2048
    v_lshl_add_u32 v6, v8, 7, v6
    v_mfma_f32_16x16x32_bf16 v[188:191], a[76:79], a[76:79], v[188:191]
    buffer_load_dwordx4 v17, s[4:7], s86 offen offset:0 lds
    v_mfma_f32_16x16x32_bf16 v[196:199], v[140:143], a[76:79], v[196:199]
    buffer_load_dwordx4 v18, s[4:7], s86 offen offset:1024 lds
    v_mfma_f32_16x16x32_bf16 v[192:195], a[80:83], a[80:83], v[192:195]
    buffer_load_dwordx4 v19, s[4:7], s86 offen offset:2048 lds
    v_mfma_f32_16x16x32_bf16 v[200:203], v[140:143], a[80:83], v[200:203]
    buffer_load_dwordx4 v20, s[4:7], s86 offen offset:3072 lds
    s_waitcnt vmcnt(9) lgkmcnt(0)
    v_mfma_f32_16x16x32_bf16 v[188:191], a[84:87], a[84:87], v[188:191]
    ds_read_b128 a[100:103], v22 offset:4096
    s_add_u32 m0, s94, 16384
    v_mfma_f32_16x16x32_bf16 v[196:199], v[144:147], a[84:87], v[196:199]
    ds_read_b128 a[108:111], v23 offset:4096
    s_xor_b32 s86, s85, 1152
    v_mfma_f32_16x16x32_bf16 v[192:195], a[88:91], a[88:91], v[192:195]
    ds_read_b128 a[104:107], v22 offset:6144
    s_add_u32 s86, s86, s93
    v_mfma_f32_16x16x32_bf16 v[200:203], v[144:147], a[88:91], v[200:203]
    ds_read_b128 a[112:115], v23 offset:6144
    v_add_u32 v91, 153600, v6
    v_mfma_f32_16x16x32_bf16 v[188:191], a[92:95], a[92:95], v[188:191]
    buffer_load_dwordx4 v17, s[4:7], s86 offen offset:0 lds
    v_mfma_f32_16x16x32_bf16 v[196:199], v[148:151], a[92:95], v[196:199]
    buffer_load_dwordx4 v18, s[4:7], s86 offen offset:1024 lds
    v_mfma_f32_16x16x32_bf16 v[192:195], a[96:99], a[96:99], v[192:195]
    buffer_load_dwordx4 v19, s[4:7], s86 offen offset:2048 lds
    v_mfma_f32_16x16x32_bf16 v[200:203], v[148:151], a[96:99], v[200:203]
    buffer_load_dwordx4 v20, s[4:7], s86 offen offset:3072 lds
    s_waitcnt vmcnt(12)
    v_cmp_ne_u64 s[8:9], v[10:11], v[44:45]
    s_nop 0
    s_cmp_lg_u64 s[8:9], 0
    s_cbranch_scc1 L_f0spin_1
L_f0ok_2:
    s_barrier
    s_waitcnt vmcnt(8) lgkmcnt(0)
    v_mfma_f32_16x16x32_bf16 v[188:191], a[100:103], a[100:103], v[188:191]
    ds_read_b128 a[116:119], v22 offset:8192
    s_add_u32 m0, s45, 0
    v_mfma_f32_16x16x32_bf16 v[196:199], v[152:155], a[100:103], v[196:199]
    buffer_load_dwordx4 v2, s[28:31], s46 offen offset:0 sc1 lds
    v_mfma_f32_16x16x32_bf16 v[192:195], a[104:107], a[104:107], v[192:195]
    buffer_load_dwordx4 v2, s[28:31], s46 offen offset:1024 sc1 lds
    v_mfma_f32_16x16x32_bf16 v[200:203], v[152:155], a[104:107], v[200:203]
    buffer_load_dwordx4 v2, s[28:31], s46 offen offset:2048 sc1 lds
    v_mfma_f32_16x16x32_bf16 v[188:191], a[108:111], a[108:111], v[188:191]
    buffer_load_dwordx4 v2, s[28:31], s46 offen offset:3072 sc1 lds
    v_mfma_f32_16x16x32_bf16 v[196:199], v[156:159], a[108:111], v[196:199]
    ds_read_b128 a[124:127], v23 offset:8192
    s_add_u32 m0, s45, 4096
    v_mfma_f32_16x16x32_bf16 v[192:195], a[112:115], a[112:115], v[192:195]
    buffer_load_dwordx4 v63, s[28:31], s46 offen sc1 lds
    v_mfma_f32_16x16x32_bf16 v[200:203], v[156:159], a[112:115], v[200:203]
    ds_read_b128 a[120:123], v22 offset:10240
    s_lshl_b32 s90, s82, 16
    ds_read_b128 a[128:131], v23 offset:10240
    s_waitcnt vmcnt(9) lgkmcnt(0)
    v_mfma_f32_16x16x32_bf16 v[188:191], a[116:119], a[116:119], v[188:191]
    ds_read_b128 a[132:135], v22 offset:12288
    s_add_u32 s90, s90, 3735552
    v_mfma_f32_16x16x32_bf16 v[196:199], v[160:163], a[116:119], v[196:199]
    ds_read_b128 a[140:143], v23 offset:12288
    v_min_u32 v5, 239, v0
    v_mfma_f32_16x16x32_bf16 v[192:195], a[120:123], a[120:123], v[192:195]
    ds_read_b128 a[136:139], v22 offset:14336
    v_lshl_add_u32 v67, v5, 4, s90
    v_mfma_f32_16x16x32_bf16 v[200:203], v[160:163], a[120:123], v[200:203]
    ds_read_b128 a[144:147], v23 offset:14336
    v_subrev_u32 v6, 120, v5
    v_mfma_f32_16x16x32_bf16 v[188:191], a[124:127], a[124:127], v[188:191]
    v_min_u32 v6, v6, v5
    v_sub_u32_e64 v66, v5, v6
    v_mfma_f32_16x16x32_bf16 v[196:199], v[164:167], a[124:127], v[196:199]
    v_cmp_le_u32 vcc, 40, v6
    v_lshrrev_b32 v77, 3, v6
    v_mfma_f32_16x16x32_bf16 v[192:195], a[128:131], a[128:131], v[192:195]
    v_and_b32 v78, 7, v6
    v_subrev_u32 v6, 40, v6
    v_mfma_f32_16x16x32_bf16 v[200:203], v[164:167], a[128:131], v[200:203]
    v_lshrrev_b32 v5, 4, v6
    v_cndmask_b32_e64 v77, v77, v5, vcc
    s_waitcnt vmcnt(5) lgkmcnt(0)
    v_mfma_f32_16x16x32_bf16 v[188:191], a[132:135], a[132:135], v[188:191]
    ds_read_b128 a[148:151], v22 offset:16384
    s_add_u32 m0, s45, 20480
    v_mfma_f32_16x16x32_bf16 v[196:199], v[168:171], a[132:135], v[196:199]
    ds_read_b128 a[156:159], v23 offset:16384
    v_and_b32_e64 v6, 15, v6
    v_mfma_f32_16x16x32_bf16 v[192:195], a[136:139], a[136:139], v[192:195]
    ds_read_b128 a[152:155], v22 offset:18432
    v_add_u32_e64 v6, 8, v6
    v_mfma_f32_16x16x32_bf16 v[200:203], v[168:171], a[136:139], v[200:203]
    ds_read_b128 a[160:163], v23 offset:18432
    v_cndmask_b32_e64 v78, v78, v6, vcc
    v_mfma_f32_16x16x32_bf16 v[188:191], a[140:143], a[140:143], v[188:191]
    buffer_load_dwordx4 v2, s[28:31], s47 offen offset:0 sc1 lds
    v_mfma_f32_16x16x32_bf16 v[196:199], v[172:175], a[140:143], v[196:199]
    buffer_load_dwordx4 v2, s[28:31], s47 offen offset:1024 sc1 lds
    v_mfma_f32_16x16x32_bf16 v[192:195], a[144:147], a[144:147], v[192:195]
    buffer_load_dwordx4 v2, s[28:31], s47 offen offset:2048 sc1 lds
    v_mfma_f32_16x16x32_bf16 v[200:203], v[172:175], a[144:147], v[200:203]
    buffer_load_dwordx4 v2, s[28:31], s47 offen offset:3072 sc1 lds
    s_add_u32 m0, s45, 24576
    s_nop 0
    buffer_load_dwordx4 v63, s[28:31], s47 offen sc1 lds
    s_waitcnt lgkmcnt(0)
    v_mfma_f32_16x16x32_bf16 v[188:191], a[148:151], a[148:151], v[188:191]
    buffer_store_dwordx4 v[204:207], v50, s[28:31], s69 offen sc1
    v_mfma_f32_16x16x32_bf16 v[196:199], v[176:179], a[148:151], v[196:199]
    buffer_store_dwordx4 v[208:211], v51, s[28:31], s69 offen sc1
    v_mfma_f32_16x16x32_bf16 v[192:195], a[152:155], a[152:155], v[192:195]
    buffer_store_dwordx4 v[96:99], v2, s[28:31], s75 offen sc1
    v_mfma_f32_16x16x32_bf16 v[200:203], v[176:179], a[152:155], v[200:203]
    buffer_store_dwordx4 v[96:99], v89, s[28:31], 0 offen sc1
    v_mfma_f32_16x16x32_bf16 v[188:191], a[156:159], a[156:159], v[188:191]
    v_mad_u32_u24 v77, v78, 5, v77
    s_mov_b32 s90, 159744
    v_mfma_f32_16x16x32_bf16 v[196:199], v[180:183], a[156:159], v[196:199]
    v_add_u32_e64 v66, v66, v77
    v_lshl_add_u32 v66, v66, 4, s90
    v_mfma_f32_16x16x32_bf16 v[192:195], a[160:163], a[160:163], v[192:195]
    v_bfe_u32 v5, v1, 3, 2
    v_lshl_add_u32 v5, v5, 2, v8
    v_mfma_f32_16x16x32_bf16 v[200:203], v[180:183], a[160:163], v[200:203]
    v_lshrrev_b32_e64 v6, 5, v1
    v_mad_u32_u24 v5, v6, 24, v5
    v_mul_u32_u24 v5, 80, v5
    v_add_u32_e64 v77, s90, v5
    v_bfe_u32 v5, v1, 4, 1
    v_mul_u32_u24 v5, 640, v5
    v_sub_u32_e64 v6, v77, v5
    v_add_u32 v78, 1280, v6
    v_mov_b32 v5, 163584
    s_mov_b32 s80, 0xf0f0f0f
    s_mov_b32 s81, 0xf0f0f0f0
    v_cndmask_b32 v77, v5, v77, s[80:81]
    v_cndmask_b32 v78, v5, v78, s[80:81]
    s_mov_b32 s90, 0x3acccccd
    v_lshl_add_u32 v5, v7, 4, v3
    v_lshlrev_b32_e64 v5, 2, v5
    s_mov_b32 s80, 0x22222222
    s_mov_b32 s81, 0x22222222
    v_cndmask_b32 v188, v188, v189, s[80:81]
    v_cndmask_b32 v192, v192, v193, s[80:81]
    s_mov_b32 s80, 0x44444444
    s_mov_b32 s81, 0x44444444
    v_cndmask_b32 v188, v188, v190, s[80:81]
    v_cndmask_b32 v192, v192, v194, s[80:81]
    s_mov_b32 s80, 0x88888888
    s_mov_b32 s81, 0x88888888
    v_cndmask_b32 v188, v188, v191, s[80:81]
    v_cndmask_b32 v192, v192, v195, s[80:81]
    ds_bpermute_b32 v189, v5, v188
    ds_bpermute_b32 v193, v5, v192
    s_mov_b32 s80, 0xffff0000
    s_mov_b32 s81, 0xffff0000
    v_mul_f32 v196, s90, v196
    v_mul_f32 v200, s90, v200
    v_cndmask_b32 v16, v196, v200, s[80:81]
    v_cndmask_b32 v35, v197, v201, s[80:81]
    v_mul_f32 v5, v16, v16
    v_and_b32 v6, 31, v1
    s_lshl2_add_u32 s10, s3, s83
    s_lshl_b32 s10, s10, 5
    s_sub_u32 s91, 2047, s10
    v_sub_u32 v37, s91, v6
    s_add_u32 s10, s10, s74
    v_mov_b32 v42, v10
    v_mov_b32_e64 v43, v11
    s_waitcnt lgkmcnt(0)
    v_cndmask_b32 v34, v189, v193, s[80:81]
    v_fma_f32 v34, v34, s90, -v5
    v_max_f32_e64 v34, 0, v34
    v_cvt_pk_bf16_f32 v34, 0, v34
    v_add_f32 v34, 0x3727c5ac, v34
    v_cvt_pk_bf16_f32 v34, 0, v34
    v_sqrt_f32_e64 v34, v34
    s_waitcnt vmcnt(9)
    s_barrier
    ds_read_b128 v[172:175], v53 offset:0
    ds_read_b128 v[176:179], v53 offset:256
    ds_read_b128 v[180:183], v53 offset:512
    ds_read_b128 v[212:215], v53 offset:768
    s_waitcnt lgkmcnt(2)
    v_mfma_f32_16x16x32_bf16 v[132:135], v[172:175], a[4:7], 0
    ds_read_b128 v[216:219], v53 offset:1024
    s_add_u32 m0, s45, 40960
    v_mfma_f32_16x16x32_bf16 v[152:155], v[172:175], a[8:11], 0
    ds_read_b128 v[220:223], v53 offset:5120
    v_mov_b32 v39, 0xff800000
    v_mfma_f32_16x16x32_bf16 v[136:139], v[176:179], a[4:7], 0
    ds_read_b128 v[224:227], v53 offset:5376
    v_mov_b32 v49, 0x7f800000
    v_mfma_f32_16x16x32_bf16 v[156:159], v[176:179], a[8:11], 0
    ds_read_b128 v[228:231], v53 offset:5632
    s_waitcnt lgkmcnt(5)
    v_mfma_f32_16x16x32_bf16 v[140:143], v[180:183], a[4:7], 0
    ds_read_b128 v[232:235], v53 offset:5888
    v_cvt_pk_bf16_f32 v36, 0, v16
    v_mfma_f32_16x16x32_bf16 v[160:163], v[180:183], a[8:11], 0
    ds_read_b128 v[236:239], v53 offset:6144
    s_waitcnt lgkmcnt(6)
    v_mfma_f32_16x16x32_bf16 v[144:147], v[212:215], a[4:7], 0
    ds_read_b128 v[172:175], v53 offset:10240
    v_cvt_pk_bf16_f32 v41, v16, v34
    v_mfma_f32_16x16x32_bf16 v[164:167], v[212:215], a[8:11], 0
    ds_read_b128 v[176:179], v53 offset:10496
    s_waitcnt lgkmcnt(7)
    v_mfma_f32_16x16x32_bf16 v[148:151], v[216:219], a[4:7], 0
    ds_read_b128 v[180:183], v53 offset:10752
    v_and_b32 v34, 0xffff0000, v41
    v_mfma_f32_16x16x32_bf16 v[168:171], v[216:219], a[8:11], 0
    ds_read_b128 v[212:215], v53 offset:11008
    s_waitcnt lgkmcnt(6)
    v_mfma_f32_16x16x32_bf16 v[132:135], v[220:223], a[12:15], v[132:135]
    buffer_load_dwordx4 v2, s[28:31], s48 offen offset:0 sc1 lds
    v_mfma_f32_16x16x32_bf16 v[152:155], v[220:223], a[16:19], v[152:155]
    ds_read_b128 v[216:219], v53 offset:11264
    v_rcp_f32 v33, v34
    v_mfma_f32_16x16x32_bf16 v[136:139], v[224:227], a[12:15], v[136:139]
    v_fma_f32 v35, -v36, v185, v35
    v_mul_f32_e64 v35, v35, v33
    v_mfma_f32_16x16x32_bf16 v[156:159], v[224:227], a[16:19], v[156:159]
    ds_read_b128 v[220:223], v53 offset:15360
    v_cvt_pk_bf16_f32 v35, 0, v35
    v_mfma_f32_16x16x32_bf16 v[140:143], v[228:231], a[12:15], v[140:143]
    buffer_load_dwordx4 v2, s[28:31], s48 offen offset:1024 sc1 lds
    v_mfma_f32_16x16x32_bf16 v[160:163], v[228:231], a[16:19], v[160:163]
    ds_read_b128 v[224:227], v53 offset:15616
    s_waitcnt lgkmcnt(7)
    v_mfma_f32_16x16x32_bf16 v[144:147], v[232:235], a[12:15], v[144:147]
    v_ashrrev_i32 v5, 31, v35
    v_and_b32 v5, 0x7fff0000, v5
    v_mfma_f32_16x16x32_bf16 v[164:167], v[232:235], a[16:19], v[164:167]
    ds_read_b128 v[228:231], v53 offset:15872
    v_xor_b32_e64 v35, v35, v5
    v_mfma_f32_16x16x32_bf16 v[148:151], v[236:239], a[12:15], v[148:151]
    buffer_load_dwordx4 v2, s[28:31], s48 offen offset:2048 sc1 lds
    v_mfma_f32_16x16x32_bf16 v[168:171], v[236:239], a[16:19], v[168:171]
    ds_read_b128 v[232:235], v53 offset:16128
    s_waitcnt lgkmcnt(4)
    v_mfma_f32_16x16x32_bf16 v[132:135], v[172:175], a[20:23], v[132:135]
    v_or_b32 v37, 0x80000000, v37
    v_xor_b32 v40, v35, v37
    v_mfma_f32_16x16x32_bf16 v[152:155], v[172:175], a[24:27], v[152:155]
    ds_read_b128 v[236:239], v53 offset:16384
    v_max_u32_dpp v37, v40, v40 row_ror:8 row_mask:0xf bank_mask:0xf
    v_mfma_f32_16x16x32_bf16 v[136:139], v[176:179], a[20:23], v[136:139]
    s_waitcnt vmcnt(7)
    s_barrier
    v_max_u32_dpp v37, v37, v37 row_ror:4 row_mask:0xf bank_mask:0xf
    v_mfma_f32_16x16x32_bf16 v[156:159], v[176:179], a[24:27], v[156:159]
    ds_read_b128 v[172:175], v53 offset:20480
    v_max_u32_dpp v37, v37, v37 row_ror:2 row_mask:0xf bank_mask:0xf
    v_mfma_f32_16x16x32_bf16 v[140:143], v[180:183], a[20:23], v[140:143]
    buffer_load_dwordx4 v2, s[28:31], s48 offen offset:3072 sc1 lds
    v_mfma_f32_16x16x32_bf16 v[160:163], v[180:183], a[24:27], v[160:163]
    ds_read_b128 v[176:179], v53 offset:20736
    s_add_u32 m0, s45, 45056
    v_mfma_f32_16x16x32_bf16 v[144:147], v[212:215], a[20:23], v[144:147]
    v_max_u32_dpp v37, v37, v37 row_ror:1 row_mask:0xf bank_mask:0xf
    v_mov_b32_e64 v5, v37
    v_mfma_f32_16x16x32_bf16 v[164:167], v[212:215], a[24:27], v[164:167]
    ds_read_b128 v[180:183], v53 offset:20992
    v_permlane16_swap_b32_e64 v37, v5
    v_mfma_f32_16x16x32_bf16 v[148:151], v[216:219], a[20:23], v[148:151]
    buffer_load_dwordx4 v63, s[28:31], s48 offen sc1 lds
    v_mfma_f32_16x16x32_bf16 v[168:171], v[216:219], a[24:27], v[168:171]
    ds_read_b128 v[212:215], v53 offset:21248
    s_waitcnt lgkmcnt(4)
    v_mfma_f32_16x16x32_bf16 v[132:135], v[220:223], a[28:31], v[132:135]
    s_add_u32 m0, s45, 61440
    v_max_u32 v37, v37, v5
    v_cmp_ne_u32_e64 vcc, v37, v40
    v_mfma_f32_16x16x32_bf16 v[152:155], v[220:223], a[32:35], v[152:155]
    ds_read_b128 v[216:219], v53 offset:21504
    v_cndmask_b32_e64 v35, 0, v40, vcc
    v_mfma_f32_16x16x32_bf16 v[136:139], v[224:227], a[28:31], v[136:139]
    buffer_load_dwordx4 v2, s[28:31], s49 offen offset:0 sc1 lds
    v_mfma_f32_16x16x32_bf16 v[156:159], v[224:227], a[32:35], v[156:159]
    ds_read_b128 v[220:223], v53 offset:25600
    v_cndmask_b32 v6, 0, 16, vcc
    v_mfma_f32_16x16x32_bf16 v[140:143], v[228:231], a[28:31], v[140:143]
    v_max_u32_dpp v37, v35, v35 row_ror:8 row_mask:0xf bank_mask:0xf
    v_mfma_f32_16x16x32_bf16 v[160:163], v[228:231], a[32:35], v[160:163]
    ds_read_b128 v[224:227], v53 offset:25856
    v_max_u32_dpp v37, v37, v37 row_ror:4 row_mask:0xf bank_mask:0xf
    v_mfma_f32_16x16x32_bf16 v[144:147], v[232:235], a[28:31], v[144:147]
    buffer_load_dwordx4 v2, s[28:31], s49 offen offset:1024 sc1 lds
    v_mfma_f32_16x16x32_bf16 v[164:167], v[232:235], a[32:35], v[164:167]
    ds_read_b128 v[228:231], v53 offset:26112
    v_max_u32_dpp v37, v37, v37 row_ror:2 row_mask:0xf bank_mask:0xf
    v_mfma_f32_16x16x32_bf16 v[148:151], v[236:239], a[28:31], v[148:151]
    s_nop 0
    v_max_u32_dpp v37, v37, v37 row_ror:1 row_mask:0xf bank_mask:0xf
    v_mov_b32 v5, v37
    v_mfma_f32_16x16x32_bf16 v[168:171], v[236:239], a[32:35], v[168:171]
    ds_read_b128 v[232:235], v53 offset:26368
    s_waitcnt lgkmcnt(4)
    v_mfma_f32_16x16x32_bf16 v[132:135], v[172:175], a[36:39], v[132:135]
    buffer_load_dwordx4 v2, s[28:31], s49 offen offset:2048 sc1 lds
    v_mfma_f32_16x16x32_bf16 v[152:155], v[172:175], a[40:43], v[152:155]
    ds_read_b128 v[236:239], v53 offset:26624
    v_permlane16_swap_b32 v37, v5
    v_mfma_f32_16x16x32_bf16 v[136:139], v[176:179], a[36:39], v[136:139]
    v_max_u32 v37, v37, v5
    v_cmp_ge_u32 vcc, v40, v37
    v_mfma_f32_16x16x32_bf16 v[156:159], v[176:179], a[40:43], v[156:159]
    ds_read_b128 v[172:175], v53 offset:30720
    s_mov_b32 vcc_hi, 0
    v_mfma_f32_16x16x32_bf16 v[140:143], v[180:183], a[36:39], v[140:143]
    buffer_load_dwordx4 v2, s[28:31], s49 offen offset:3072 sc1 lds
    v_mfma_f32_16x16x32_bf16 v[160:163], v[180:183], a[40:43], v[160:163]
    ds_read_b128 v[176:179], v53 offset:30976
    s_add_u32 m0, s45, 65536
    v_mfma_f32_16x16x32_bf16 v[144:147], v[212:215], a[36:39], v[144:147]
    v_cndmask_b32 v6, v9, v6, vcc
    v_mfma_f32_16x16x32_bf16 v[164:167], v[212:215], a[40:43], v[164:167]
    ds_read_b128 v[180:183], v53 offset:31232
    v_mfma_f32_16x16x32_bf16 v[148:151], v[216:219], a[36:39], v[148:151]
    buffer_load_dwordx4 v63, s[28:31], s49 offen sc1 lds
    v_mfma_f32_16x16x32_bf16 v[168:171], v[216:219], a[40:43], v[168:171]
    ds_read_b128 v[212:215], v53 offset:31488
    s_waitcnt lgkmcnt(4)
    v_mfma_f32_16x16x32_bf16 v[132:135], v[220:223], a[44:47], v[132:135]
    buffer_store_dwordx4 v[40:43], v6, s[28:31], s10 offen sc1
    v_mfma_f32_16x16x32_bf16 v[152:155], v[220:223], a[48:51], v[152:155]
    ds_read_b128 v[216:219], v53 offset:31744
    s_add_u32 m0, s45, 81920
    v_mfma_f32_16x16x32_bf16 v[136:139], v[224:227], a[44:47], v[136:139]
    buffer_load_dwordx4 v2, s[28:31], s50 offen offset:0 sc1 lds
    v_mfma_f32_16x16x32_bf16 v[156:159], v[224:227], a[48:51], v[156:159]
    ds_read_b128 v[220:223], v53 offset:35840
    v_mul_f32 v32, 0x3fb8aa3b, v33
    v_mfma_f32_16x16x32_bf16 v[140:143], v[228:231], a[44:47], v[140:143]
    v_lshrrev_b32 v130, 16, v41
    v_mov_b32_e64 v131, 0
    v_mfma_f32_16x16x32_bf16 v[160:163], v[228:231], a[48:51], v[160:163]
    ds_read_b128 v[224:227], v53 offset:36096
    v_and_b32_e64 v5, 31, v1
    v_mfma_f32_16x16x32_bf16 v[144:147], v[232:235], a[44:47], v[144:147]
    buffer_load_dwordx4 v2, s[28:31], s50 offen offset:1024 sc1 lds
    v_mfma_f32_16x16x32_bf16 v[164:167], v[232:235], a[48:51], v[164:167]
    ds_read_b128 v[228:231], v53 offset:36352
    v_lshl_add_u32 v5, v5, 2, s44
    v_mfma_f32_16x16x32_bf16 v[148:151], v[236:239], a[44:47], v[148:151]
    ds_write_b32 v5, v41
    v_mfma_f32_16x16x32_bf16 v[168:171], v[236:239], a[48:51], v[168:171]
    ds_read_b128 v[232:235], v53 offset:36608
    s_waitcnt lgkmcnt(5)
    v_mfma_f32_16x16x32_bf16 v[132:135], v[172:175], a[52:55], v[132:135]
    buffer_load_dwordx4 v2, s[28:31], s50 offen offset:2048 sc1 lds
    v_mfma_f32_16x16x32_bf16 v[152:155], v[172:175], a[56:59], v[152:155]
    ds_read_b128 v[236:239], v53 offset:36864
    v_min_u32 v84, s38, v1
    v_mfma_f32_16x16x32_bf16 v[136:139], v[176:179], a[52:55], v[136:139]
    s_waitcnt vmcnt(9)
    s_barrier
    v_lshlrev_b32_e64 v84, 7, v84
    v_mfma_f32_16x16x32_bf16 v[156:159], v[176:179], a[56:59], v[156:159]
    ds_read_b128 v[172:175], v53 offset:40960
    v_cvt_pk_bf16_f32 v198, -v196, -v196
    v_mfma_f32_16x16x32_bf16 v[140:143], v[180:183], a[52:55], v[140:143]
    buffer_load_dwordx4 v2, s[28:31], s50 offen offset:3072 sc1 lds
    v_mfma_f32_16x16x32_bf16 v[160:163], v[180:183], a[56:59], v[160:163]
    ds_read_b128 v[176:179], v53 offset:41216
    s_add_u32 m0, s45, 86016
    v_mfma_f32_16x16x32_bf16 v[144:147], v[212:215], a[52:55], v[144:147]
    buffer_store_dwordx2 v[10:11], v46, s[28:31], s36 offen sc1
    v_mfma_f32_16x16x32_bf16 v[164:167], v[212:215], a[56:59], v[164:167]
    ds_read_b128 v[180:183], v53 offset:41472
    v_cvt_pk_bf16_f32 v202, -v200, -v200
    v_mfma_f32_16x16x32_bf16 v[148:151], v[216:219], a[52:55], v[148:151]
    buffer_load_dwordx4 v63, s[28:31], s50 offen sc1 lds
    v_mfma_f32_16x16x32_bf16 v[168:171], v[216:219], a[56:59], v[168:171]
    ds_read_b128 v[212:215], v53 offset:41728
    s_waitcnt lgkmcnt(4)
    v_mfma_f32_16x16x32_bf16 v[132:135], v[220:223], a[60:63], v[132:135]
    s_lshl_b32 s87, s83, 10
    s_add_u32 m0, s87, 153600
    s_add_u32 s86, s55, 512
    v_mfma_f32_16x16x32_bf16 v[152:155], v[220:223], a[64:67], v[152:155]
    ds_read_b128 v[216:219], v53 offset:41984
    s_mov_b32 s8, 0xffffffff
    v_mfma_f32_16x16x32_bf16 v[136:139], v[224:227], a[60:63], v[136:139]
    buffer_load_dwordx4 v86, s[28:31], s55 offen sc1 lds
    v_mfma_f32_16x16x32_bf16 v[156:159], v[224:227], a[64:67], v[156:159]
    ds_read_b128 v[220:223], v53 offset:46080
    s_mov_b32 s9, 0xffff
    v_mfma_f32_16x16x32_bf16 v[140:143], v[228:231], a[60:63], v[140:143]
    v_cndmask_b32 v12, 0, v198, s[8:9]
    v_cndmask_b32 v13, 0, v198, s[8:9]
    v_mfma_f32_16x16x32_bf16 v[160:163], v[228:231], a[64:67], v[160:163]
    ds_read_b128 v[224:227], v53 offset:46336
    v_cndmask_b32 v24, 0, v202, s[8:9]
    v_mfma_f32_16x16x32_bf16 v[144:147], v[232:235], a[60:63], v[144:147]
    buffer_load_dwordx4 v86, s[28:31], s86 offen offset:1024 sc1 lds
    v_mfma_f32_16x16x32_bf16 v[164:167], v[232:235], a[64:67], v[164:167]
    ds_read_b128 v[228:231], v53 offset:46592
    s_add_u32 m0, s45, 102400
    v_mfma_f32_16x16x32_bf16 v[148:151], v[236:239], a[60:63], v[148:151]
    v_cndmask_b32 v25, 0, v202, s[8:9]
    s_mov_b32 s8, 0xffffffff
    v_mfma_f32_16x16x32_bf16 v[168:171], v[236:239], a[64:67], v[168:171]
    ds_read_b128 v[232:235], v53 offset:46848
    s_waitcnt lgkmcnt(4)
    v_mfma_f32_16x16x32_bf16 v[132:135], v[172:175], a[68:71], v[132:135]
    buffer_load_dwordx4 v2, s[28:31], s51 offen offset:0 sc1 lds
    v_mfma_f32_16x16x32_bf16 v[152:155], v[172:175], a[72:75], v[152:155]
    ds_read_b128 v[236:239], v53 offset:47104
    s_mov_b32 s9, 0x0
    v_mfma_f32_16x16x32_bf16 v[136:139], v[176:179], a[68:71], v[136:139]
    v_cndmask_b32 v14, 0, v198, s[8:9]
    v_cndmask_b32 v15, 0, v198, s[8:9]
    v_mfma_f32_16x16x32_bf16 v[156:159], v[176:179], a[72:75], v[156:159]
    ds_read_b128 v[172:175], v54 offset:0
    v_cndmask_b32 v26, 0, v202, s[8:9]
    v_mfma_f32_16x16x32_bf16 v[140:143], v[180:183], a[68:71], v[140:143]
    buffer_load_dwordx4 v2, s[28:31], s51 offen offset:1024 sc1 lds
    v_mfma_f32_16x16x32_bf16 v[160:163], v[180:183], a[72:75], v[160:163]
    ds_read_b128 v[176:179], v54 offset:256
    v_cndmask_b32 v27, 0, v202, s[8:9]
    v_mfma_f32_16x16x32_bf16 v[144:147], v[212:215], a[68:71], v[144:147]
    v_and_b32 v5, 1, v1
    v_lshlrev_b32 v5, 4, v5
    v_mfma_f32_16x16x32_bf16 v[164:167], v[212:215], a[72:75], v[164:167]
    ds_read_b128 v[180:183], v54 offset:512
    v_mov_b32 v6, 0x3f80
    v_mfma_f32_16x16x32_bf16 v[148:151], v[216:219], a[68:71], v[148:151]
    buffer_load_dwordx4 v2, s[28:31], s51 offen offset:2048 sc1 lds
    v_mfma_f32_16x16x32_bf16 v[168:171], v[216:219], a[72:75], v[168:171]
    ds_read_b128 v[212:215], v54 offset:768
    s_waitcnt lgkmcnt(4)
    v_mfma_f32_16x16x32_bf16 v[132:135], v[220:223], a[76:79], v[132:135]
    v_lshlrev_b32 v5, v5, v6
    s_mov_b32 s80, 0x300003
    v_mfma_f32_16x16x32_bf16 v[152:155], v[220:223], a[80:83], v[152:155]
    ds_read_b128 v[216:219], v54 offset:1024
    s_mov_b32 s81, 0x30000300
    v_mfma_f32_16x16x32_bf16 v[136:139], v[224:227], a[76:79], v[136:139]
    buffer_load_dwordx4 v2, s[28:31], s51 offen offset:3072 sc1 lds
    v_mfma_f32_16x16x32_bf16 v[156:159], v[224:227], a[80:83], v[156:159]
    ds_read_b128 v[220:223], v54 offset:5120
    s_add_u32 m0, s45, 106496
    v_mfma_f32_16x16x32_bf16 v[140:143], v[228:231], a[76:79], v[140:143]
    v_cndmask_b32 v6, 0, v5, s[80:81]
    v_accvgpr_write_b32 a0, v6
    v_mfma_f32_16x16x32_bf16 v[160:163], v[228:231], a[80:83], v[160:163]
    ds_read_b128 v[224:227], v54 offset:5376
    v_accvgpr_write_b32 a2, v6
    v_mfma_f32_16x16x32_bf16 v[144:147], v[232:235], a[76:79], v[144:147]
    buffer_load_dwordx4 v63, s[28:31], s51 offen sc1 lds
    v_mfma_f32_16x16x32_bf16 v[164:167], v[232:235], a[80:83], v[164:167]
    ds_read_b128 v[228:231], v54 offset:5632
    s_add_u32 m0, s45, 122880
    v_mfma_f32_16x16x32_bf16 v[148:151], v[236:239], a[76:79], v[148:151]
    s_mov_b32 s80, 0xc0000c
    s_mov_b32 s81, 0xc0000c00
    v_cndmask_b32 v6, 0, v5, s[80:81]
    v_mfma_f32_16x16x32_bf16 v[168:171], v[236:239], a[80:83], v[168:171]
    ds_read_b128 v[232:235], v54 offset:5888
    s_waitcnt lgkmcnt(4)
    v_mfma_f32_16x16x32_bf16 v[132:135], v[172:175], a[84:87], v[132:135]
    buffer_load_dwordx4 v2, s[28:31], s52 offen offset:0 sc1 lds
    v_mfma_f32_16x16x32_bf16 v[152:155], v[172:175], a[88:91], v[152:155]
    ds_read_b128 v[236:239], v54 offset:6144
    v_accvgpr_write_b32 a1, v6
    v_mfma_f32_16x16x32_bf16 v[136:139], v[176:179], a[84:87], v[136:139]
    s_waitcnt vmcnt(15)
    s_barrier
    v_accvgpr_write_b32 a3, v6
    v_mfma_f32_16x16x32_bf16 v[156:159], v[176:179], a[88:91], v[156:159]
    ds_read_b128 v[172:175], v54 offset:10240
    v_lshl_add_u32 v72, v3, 2, v4
    v_mfma_f32_16x16x32_bf16 v[140:143], v[180:183], a[84:87], v[140:143]
    buffer_load_dwordx4 v2, s[28:31], s52 offen offset:1024 sc1 lds
    v_mfma_f32_16x16x32_bf16 v[160:163], v[180:183], a[88:91], v[160:163]
    ds_read_b128 v[176:179], v54 offset:10496
    v_mad_u32_u24 v72, v72, 40, s72
    v_mfma_f32_16x16x32_bf16 v[144:147], v[212:215], a[84:87], v[144:147]
    v_mul_u32_u24 v5, 11, v3
    v_and_b32 v5, 0xc0, v5
    v_mfma_f32_16x16x32_bf16 v[164:167], v[212:215], a[88:91], v[164:167]
    ds_read_b128 v[180:183], v54 offset:10752
    v_add_u32_e64 v72, v72, v5
    v_mfma_f32_16x16x32_bf16 v[148:151], v[216:219], a[84:87], v[148:151]
    buffer_load_dwordx4 v2, s[28:31], s52 offen offset:2048 sc1 lds
    v_mfma_f32_16x16x32_bf16 v[168:171], v[216:219], a[88:91], v[168:171]
    ds_read_b128 v[212:215], v54 offset:11008
    s_waitcnt lgkmcnt(4)
    v_mfma_f32_16x16x32_bf16 v[132:135], v[220:223], a[92:95], v[132:135]
    v_cmp_gt_u32 vcc, 60, v1
    v_mul_u32_u24 v6, 6554, v1
    v_mfma_f32_16x16x32_bf16 v[152:155], v[220:223], a[96:99], v[152:155]
    ds_read_b128 v[216:219], v54 offset:11264
    v_lshrrev_b32_e64 v6, 16, v6
    v_mfma_f32_16x16x32_bf16 v[136:139], v[224:227], a[92:95], v[136:139]
    buffer_load_dwordx4 v2, s[28:31], s52 offen offset:3072 sc1 lds
    v_mfma_f32_16x16x32_bf16 v[156:159], v[224:227], a[96:99], v[156:159]
    ds_read_b128 v[220:223], v54 offset:15360
    s_add_u32 m0, s45, 126976
    v_mfma_f32_16x16x32_bf16 v[140:143], v[228:231], a[92:95], v[140:143]
    v_mul_u32_u24 v6, 1120, v6
    v_add_u32_e64 v6, v6, v2
    v_mfma_f32_16x16x32_bf16 v[160:163], v[228:231], a[96:99], v[160:163]
    ds_read_b128 v[224:227], v54 offset:15616
    v_cndmask_b32_e64 v79, v9, v6, vcc
    v_mfma_f32_16x16x32_bf16 v[144:147], v[232:235], a[92:95], v[144:147]
    buffer_load_dwordx4 v63, s[28:31], s52 offen sc1 lds
    v_mfma_f32_16x16x32_bf16 v[164:167], v[232:235], a[96:99], v[164:167]
    ds_read_b128 v[228:231], v54 offset:15872
    s_add_u32 m0, s54, 0
    v_mfma_f32_16x16x32_bf16 v[148:151], v[236:239], a[92:95], v[148:151]
    v_cmp_gt_u32 vcc, 40, v1
    v_add_u32 v80, 6656, v79
    v_mfma_f32_16x16x32_bf16 v[168:171], v[236:239], a[96:99], v[168:171]
    ds_read_b128 v[232:235], v54 offset:16128
    s_waitcnt lgkmcnt(4)
    v_mfma_f32_16x16x32_bf16 v[132:135], v[172:175], a[100:103], v[132:135]
    v_lshlrev_b32 v47, 5, v1
    v_add_u32 v6, 13312, v6
    v_mfma_f32_16x16x32_bf16 v[152:155], v[172:175], a[104:107], v[152:155]
    ds_read_b128 v[236:239], v54 offset:16384
    v_cndmask_b32_e64 v81, v9, v6, vcc
    v_mfma_f32_16x16x32_bf16 v[136:139], v[176:179], a[100:103], v[136:139]
    buffer_load_dwordx4 v[240:243], v47, s[28:31], s74 offen sc1
    v_mfma_f32_16x16x32_bf16 v[156:159], v[176:179], a[104:107], v[156:159]
    ds_read_b128 v[172:175], v54 offset:20480
    v_mfma_f32_16x16x32_bf16 v[140:143], v[180:183], a[100:103], v[140:143]
    v_mfma_f32_16x16x32_bf16 v[160:163], v[180:183], a[104:107], v[160:163]
    ds_read_b128 v[176:179], v54 offset:20736
    v_mfma_f32_16x16x32_bf16 v[144:147], v[212:215], a[100:103], v[144:147]
    buffer_load_dwordx4 v[244:247], v47, s[28:31], s74 offen offset:16 sc1
    v_mfma_f32_16x16x32_bf16 v[164:167], v[212:215], a[104:107], v[164:167]
    ds_read_b128 v[180:183], v54 offset:20992
    v_mfma_f32_16x16x32_bf16 v[148:151], v[216:219], a[100:103], v[148:151]
    v_mfma_f32_16x16x32_bf16 v[168:171], v[216:219], a[104:107], v[168:171]
    ds_read_b128 v[212:215], v54 offset:21248
    s_waitcnt lgkmcnt(4)
    v_mfma_f32_16x16x32_bf16 v[132:135], v[220:223], a[108:111], v[132:135]
    buffer_load_dwordx4 v2, s[28:31], s53 offen offset:0 sc1 lds
    v_mfma_f32_16x16x32_bf16 v[152:155], v[220:223], a[112:115], v[152:155]
    ds_read_b128 v[216:219], v54 offset:21504
    v_mfma_f32_16x16x32_bf16 v[136:139], v[224:227], a[108:111], v[136:139]
    v_mfma_f32_16x16x32_bf16 v[156:159], v[224:227], a[112:115], v[156:159]
    ds_read_b128 v[220:223], v54 offset:25600
    v_mfma_f32_16x16x32_bf16 v[140:143], v[228:231], a[108:111], v[140:143]
    buffer_load_dwordx4 v2, s[28:31], s53 offen offset:1024 sc1 lds
    v_mfma_f32_16x16x32_bf16 v[160:163], v[228:231], a[112:115], v[160:163]
    ds_read_b128 v[224:227], v54 offset:25856
    v_mfma_f32_16x16x32_bf16 v[144:147], v[232:235], a[108:111], v[144:147]
    v_mfma_f32_16x16x32_bf16 v[164:167], v[232:235], a[112:115], v[164:167]
    ds_read_b128 v[228:231], v54 offset:26112
    v_mfma_f32_16x16x32_bf16 v[148:151], v[236:239], a[108:111], v[148:151]
    buffer_load_dwordx4 v2, s[28:31], s53 offen offset:2048 sc1 lds
    v_mfma_f32_16x16x32_bf16 v[168:171], v[236:239], a[112:115], v[168:171]
    ds_read_b128 v[232:235], v54 offset:26368
    s_waitcnt lgkmcnt(4)
    v_mfma_f32_16x16x32_bf16 v[132:135], v[172:175], a[116:119], v[132:135]
    v_mfma_f32_16x16x32_bf16 v[152:155], v[172:175], a[120:123], v[152:155]
    ds_read_b128 v[236:239], v54 offset:26624
    v_mfma_f32_16x16x32_bf16 v[136:139], v[176:179], a[116:119], v[136:139]
    s_waitcnt vmcnt(15)
    s_barrier
    v_mfma_f32_16x16x32_bf16 v[156:159], v[176:179], a[120:123], v[156:159]
    ds_read_b128 v[172:175], v54 offset:30720
    v_mfma_f32_16x16x32_bf16 v[140:143], v[180:183], a[116:119], v[140:143]
    v_mfma_f32_16x16x32_bf16 v[160:163], v[180:183], a[120:123], v[160:163]
    ds_read_b128 v[176:179], v54 offset:35840
    v_mfma_f32_16x16x32_bf16 v[144:147], v[212:215], a[116:119], v[144:147]
    v_mfma_f32_16x16x32_bf16 v[164:167], v[212:215], a[120:123], v[164:167]
    ds_read_b128 v[180:183], v54 offset:40960
    v_mfma_f32_16x16x32_bf16 v[148:151], v[216:219], a[116:119], v[148:151]
    v_mfma_f32_16x16x32_bf16 v[168:171], v[216:219], a[120:123], v[168:171]
    ds_read_b128 v[212:215], v54 offset:46080
    s_waitcnt lgkmcnt(4)
    v_mfma_f32_16x16x32_bf16 v[132:135], v[220:223], a[124:127], v[132:135]
    ds_read_b64_tr_b16 v[216:217], v57 offset:0
    v_mfma_f32_16x16x32_bf16 v[152:155], v[220:223], a[128:131], v[152:155]
    ds_read_b64_tr_b16 v[218:219], v58 offset:0
    v_mfma_f32_16x16x32_bf16 v[136:139], v[224:227], a[124:127], v[136:139]
    s_waitcnt vmcnt(3)
    v_cmp_ne_u64 s[8:9], v[10:11], v[242:243]
    v_cmp_ne_u64 s[0:1], v[10:11], v[246:247]
    v_mfma_f32_16x16x32_bf16 v[156:159], v[224:227], a[128:131], v[156:159]
    ds_read_b128 v[220:223], v54 offset:30976
    s_or_b64 s[8:9], s[8:9], s[0:1]
    s_cbranch_scc1 L_cspin_4
L_cok_5:
    v_mfma_f32_16x16x32_bf16 v[140:143], v[228:231], a[124:127], v[140:143]
    buffer_store_dwordx4 v[96:99], v2, s[28:31], s43 offen sc1
    v_mfma_f32_16x16x32_bf16 v[160:163], v[228:231], a[128:131], v[160:163]
    ds_read_b128 v[224:227], v54 offset:36096
    v_min_u32_dpp v5, v240, v240 row_ror:8 row_mask:0xf bank_mask:0xf
    v_mfma_f32_16x16x32_bf16 v[144:147], v[232:235], a[124:127], v[144:147]
    v_max_u32_dpp v242, v240, v240 row_ror:8 row_mask:0xf bank_mask:0xf
    v_max_u32_dpp v6, v244, v244 row_ror:8 row_mask:0xf bank_mask:0xf
    v_mfma_f32_16x16x32_bf16 v[164:167], v[232:235], a[128:131], v[164:167]
    ds_read_b128 v[228:231], v54 offset:41216
    v_max_u32_e64 v243, v5, v6
    v_mfma_f32_16x16x32_bf16 v[148:151], v[236:239], a[124:127], v[148:151]
    v_min_u32_dpp v5, v242, v242 row_ror:4 row_mask:0xf bank_mask:0xf
    v_max_u32_dpp v242, v242, v242 row_ror:4 row_mask:0xf bank_mask:0xf
    v_mfma_f32_16x16x32_bf16 v[168:171], v[236:239], a[128:131], v[168:171]
    ds_read_b128 v[232:235], v54 offset:46336
    s_waitcnt lgkmcnt(4)
    v_mfma_f32_16x16x32_bf16 v[132:135], v[172:175], a[132:135], v[132:135]
    ds_read_b64_tr_b16 v[236:237], v57 offset:8
    v_max_u32_dpp v6, v243, v243 row_ror:4 row_mask:0xf bank_mask:0xf
    v_mfma_f32_16x16x32_bf16 v[152:155], v[172:175], a[136:139], v[152:155]
    ds_read_b64_tr_b16 v[238:239], v58 offset:8
    v_max_u32 v243, v5, v6
    v_mfma_f32_16x16x32_bf16 v[132:135], v[176:179], a[140:143], v[132:135]
    buffer_store_dwordx4 v[96:99], v2, s[28:31], s43 offen offset:1024 sc1
    v_mfma_f32_16x16x32_bf16 v[152:155], v[176:179], a[144:147], v[152:155]
    ds_read_b128 v[172:175], v54 offset:31232
    v_min_u32_dpp v5, v242, v242 row_ror:2 row_mask:0xf bank_mask:0xf
    v_mfma_f32_16x16x32_bf16 v[132:135], v[180:183], a[148:151], v[132:135]
    v_max_u32_dpp v242, v242, v242 row_ror:2 row_mask:0xf bank_mask:0xf
    v_max_u32_dpp v6, v243, v243 row_ror:2 row_mask:0xf bank_mask:0xf
    v_mfma_f32_16x16x32_bf16 v[152:155], v[180:183], a[152:155], v[152:155]
    ds_read_b128 v[176:179], v54 offset:36352
    v_max_u32_e64 v243, v5, v6
    v_mfma_f32_16x16x32_bf16 v[132:135], v[212:215], a[156:159], v[132:135]
    v_min_u32_dpp v5, v242, v242 row_ror:1 row_mask:0xf bank_mask:0xf
    v_max_u32_dpp v242, v242, v242 row_ror:1 row_mask:0xf bank_mask:0xf
    v_mfma_f32_16x16x32_bf16 v[152:155], v[212:215], a[160:163], v[152:155]
    ds_read_b128 v[180:183], v54 offset:41472
    v_max_u32_dpp v6, v243, v243 row_ror:1 row_mask:0xf bank_mask:0xf
    v_mfma_f32_16x16x32_bf16 v[132:135], v[216:219], v[12:15], v[132:135]
    buffer_store_dwordx4 v[96:99], v93, s[28:31], s43 offen offset:2048 sc1
    v_mfma_f32_16x16x32_bf16 v[152:155], v[216:219], v[24:27], v[152:155]
    ds_read_b128 v[212:215], v54 offset:46592
    s_waitcnt lgkmcnt(4)
    v_mfma_f32_16x16x32_bf16 v[136:139], v[220:223], a[132:135], v[136:139]
    ds_read_b64_tr_b16 v[216:217], v57 offset:16
    v_max_u32 v243, v5, v6
    v_mfma_f32_16x16x32_bf16 v[156:159], v[220:223], a[136:139], v[156:159]
    ds_read_b64_tr_b16 v[218:219], v58 offset:16
    v_min_u32_dpp v5, v242, v242 row_bcast:15 row_mask:0xf bank_mask:0xf
    v_mfma_f32_16x16x32_bf16 v[136:139], v[224:227], a[140:143], v[136:139]
    v_max_u32_dpp v242, v242, v242 row_bcast:15 row_mask:0xf bank_mask:0xf
    v_max_u32_dpp v6, v243, v243 row_bcast:15 row_mask:0xf bank_mask:0xf
    v_mfma_f32_16x16x32_bf16 v[156:159], v[224:227], a[144:147], v[156:159]
    ds_read_b128 v[220:223], v54 offset:31488
    v_max_u32_e64 v243, v5, v6
    v_mfma_f32_16x16x32_bf16 v[136:139], v[228:231], a[148:151], v[136:139]
    v_min_u32_dpp v5, v242, v242 row_bcast:31 row_mask:0xf bank_mask:0xf
    v_max_u32_dpp v242, v242, v242 row_bcast:31 row_mask:0xf bank_mask:0xf
    v_mfma_f32_16x16x32_bf16 v[156:159], v[228:231], a[152:155], v[156:159]
    ds_read_b128 v[224:227], v54 offset:36608
    v_max_u32_dpp v6, v243, v243 row_bcast:31 row_mask:0xf bank_mask:0xf
    v_mfma_f32_16x16x32_bf16 v[136:139], v[232:235], a[156:159], v[136:139]
    buffer_load_dwordx2 v[44:45], v84, s[28:31], s37 offen sc1
    v_mfma_f32_16x16x32_bf16 v[156:159], v[232:235], a[160:163], v[156:159]
    ds_read_b128 v[228:231], v54 offset:41728
    v_max_u32_e64 v243, v5, v6
    v_mfma_f32_16x16x32_bf16 v[136:139], v[236:239], v[12:15], v[136:139]
    v_readlane_b32 s11, v242, 63
    v_readlane_b32 s33, v243, 63
    v_mfma_f32_16x16x32_bf16 v[156:159], v[236:239], v[24:27], v[156:159]
    ds_read_b128 v[232:235], v54 offset:46848
    s_waitcnt lgkmcnt(4)
    v_mfma_f32_16x16x32_bf16 v[140:143], v[172:175], a[132:135], v[140:143]
    ds_read_b64_tr_b16 v[236:237], v57 offset:24
    s_mov_b32 vcc_lo, 0xaaaaaaaa
    v_mfma_f32_16x16x32_bf16 v[160:163], v[172:175], a[136:139], v[160:163]
    ds_read_b64_tr_b16 v[238:239], v58 offset:24
    s_mov_b32 vcc_hi, 0xaaaaaaaa
    v_mfma_f32_16x16x32_bf16 v[140:143], v[176:179], a[140:143], v[140:143]
    s_lshl_b32 s88, s83, 11
    s_add_u32 m0, s88, 0
    s_add_u32 s87, s56, 23552
    v_mfma_f32_16x16x32_bf16 v[160:163], v[176:179], a[144:147], v[160:163]
    ds_read_b128 v[172:175], v54 offset:31744
    s_andn2_b32 s35, 2047, s11
    v_mfma_f32_16x16x32_bf16 v[140:143], v[180:183], a[148:151], v[140:143]
    buffer_load_dwordx4 v68, s[12:15], s56 offen lds
    v_mfma_f32_16x16x32_bf16 v[160:163], v[180:183], a[152:155], v[160:163]
    ds_read_b128 v[176:179], v54 offset:36864
    s_andn2_b32 s67, 2047, s33
    v_mfma_f32_16x16x32_bf16 v[140:143], v[212:215], a[156:159], v[140:143]
    s_mul_i32 s90, s35, 1280
    s_mul_i32 s91, s67, 1280
    v_add_u32 v5, s90, v85
    v_mfma_f32_16x16x32_bf16 v[160:163], v[212:215], a[160:163], v[160:163]
    ds_read_b128 v[180:183], v54 offset:41984
    v_add_u32_e64 v6, s91, v85
    v_mfma_f32_16x16x32_bf16 v[140:143], v[216:219], v[12:15], v[140:143]
    buffer_load_dwordx4 v68, s[12:15], s87 offen offset:1024 lds
    v_mfma_f32_16x16x32_bf16 v[160:163], v[216:219], v[24:27], v[160:163]
    ds_read_b128 v[212:215], v54 offset:47104
    s_waitcnt lgkmcnt(4)
    v_mfma_f32_16x16x32_bf16 v[144:147], v[220:223], a[132:135], v[144:147]
    ds_read_b64_tr_b16 v[216:217], v57 offset:32
    s_add_u32 m0, s88, 8192
    v_mfma_f32_16x16x32_bf16 v[164:167], v[220:223], a[136:139], v[164:167]
    ds_read_b64_tr_b16 v[218:219], v58 offset:32
    v_cndmask_b32 v47, v5, v6, vcc
    v_mfma_f32_16x16x32_bf16 v[144:147], v[224:227], a[140:143], v[144:147]
    buffer_load_dwordx4 v68, s[16:19], s56 offen lds
    v_mfma_f32_16x16x32_bf16 v[164:167], v[224:227], a[144:147], v[164:167]
    buffer_load_dwordx4 v[204:207], v47, s[4:7], 0 offen
    v_mfma_f32_16x16x32_bf16 v[144:147], v[228:231], a[148:151], v[144:147]
    buffer_load_dwordx4 v68, s[16:19], s87 offen offset:1024 lds
    v_mfma_f32_16x16x32_bf16 v[164:167], v[228:231], a[152:155], v[164:167]
    s_add_u32 m0, s88, 16384
    s_add_u32 s87, s57, 9216
    v_permlane16_swap_b32_e64 v132, v152
    v_mfma_f32_16x16x32_bf16 v[144:147], v[232:235], a[156:159], v[144:147]
    v_permlane16_swap_b32_e64 v133, v153
    v_mfma_f32_16x16x32_bf16 v[164:167], v[232:235], a[160:163], v[164:167]
    v_permlane16_swap_b32_e64 v134, v154
    v_mfma_f32_16x16x32_bf16 v[144:147], v[236:239], v[12:15], v[144:147]
    buffer_load_dwordx4 v69, s[20:23], s57 offen lds
    v_mfma_f32_16x16x32_bf16 v[164:167], v[236:239], v[24:27], v[164:167]
    s_waitcnt lgkmcnt(0)
    v_permlane16_swap_b32 v135, v155
    v_mfma_f32_16x16x32_bf16 v[148:151], v[172:175], a[132:135], v[148:151]
    v_max3_f32 v39, v39, v132, v133
    v_min3_f32 v49, v49, v132, v133
    v_mfma_f32_16x16x32_bf16 v[168:171], v[172:175], a[136:139], v[168:171]
    v_max3_f32 v39, v39, v134, v135
    v_min3_f32 v49, v49, v134, v135
    v_mfma_f32_16x16x32_bf16 v[148:151], v[176:179], a[140:143], v[148:151]
    buffer_load_dwordx4 v69, s[20:23], s87 offen offset:1024 lds
    v_mfma_f32_16x16x32_bf16 v[168:171], v[176:179], a[144:147], v[168:171]
    v_cvt_pk_bf16_f32 v120, v152, v153
    v_cvt_pk_bf16_f32 v121, v154, v155
    v_mfma_f32_16x16x32_bf16 v[148:151], v[180:183], a[148:151], v[148:151]
    v_permlane16_swap_b32_e64 v136, v156
    v_mfma_f32_16x16x32_bf16 v[168:171], v[180:183], a[152:155], v[168:171]
    v_permlane16_swap_b32_e64 v137, v157
    v_mfma_f32_16x16x32_bf16 v[148:151], v[212:215], a[156:159], v[148:151]
    v_permlane16_swap_b32_e64 v138, v158
    v_mfma_f32_16x16x32_bf16 v[168:171], v[212:215], a[160:163], v[168:171]
    v_permlane16_swap_b32_e64 v139, v159
    v_mfma_f32_16x16x32_bf16 v[148:151], v[216:219], v[12:15], v[148:151]
    v_max3_f32 v39, v39, v136, v137
    v_min3_f32 v49, v49, v136, v137
    v_mfma_f32_16x16x32_bf16 v[168:171], v[216:219], v[24:27], v[168:171]
    v_max3_f32 v39, v39, v138, v139
    v_min3_f32 v49, v49, v138, v139
    v_cvt_pk_bf16_f32 v122, v156, v157
    v_cvt_pk_bf16_f32 v123, v158, v159
    v_permlane16_swap_b32 v140, v160
    v_permlane16_swap_b32 v141, v161
    v_permlane16_swap_b32 v142, v162
    v_permlane16_swap_b32 v143, v163
    v_max3_f32 v39, v39, v140, v141
    v_min3_f32 v49, v49, v140, v141
    v_max3_f32 v39, v39, v142, v143
    v_min3_f32 v49, v49, v142, v143
    v_cvt_pk_bf16_f32 v124, v160, v161
    v_cvt_pk_bf16_f32 v125, v162, v163
    v_permlane16_swap_b32 v144, v164
    v_permlane16_swap_b32 v145, v165
    v_permlane16_swap_b32 v146, v166
    v_permlane16_swap_b32 v147, v167
    v_max3_f32 v39, v39, v144, v145
    v_min3_f32 v49, v49, v144, v145
    v_max3_f32 v39, v39, v146, v147
    v_min3_f32 v49, v49, v146, v147
    v_cvt_pk_bf16_f32 v126, v164, v165
    v_cvt_pk_bf16_f32 v127, v166, v167
    s_barrier
    v_xor_b32 v5, 80, v64
    ds_write_b128 v5, v[120:123]
    v_permlane16_swap_b32 v148, v168
    v_permlane16_swap_b32 v149, v169
    v_permlane16_swap_b32 v150, v170
    v_permlane16_swap_b32_e64 v151, v171
    v_max3_f32 v39, v39, v148, v149
    v_min3_f32 v49, v49, v148, v149
    v_max3_f32 v39, v39, v150, v151
    v_min3_f32 v49, v49, v150, v151
    v_cvt_pk_bf16_f32 v128, v168, v169
    v_cvt_pk_bf16_f32 v129, v170, v171
    v_xor_b32 v5, 96, v64
    ds_write_b128 v5, v[124:127]
    v_mul_f32 v39, v39, v32
    v_mul_f32 v49, v49, v32
    v_pk_fma_f32 v[16:17], v[132:133], v[32:33], v[38:39] op_sel:[0,0,1] op_sel_hi:[1,0,1] neg_lo:[0,0,1] neg_hi:[0,0,1]
    v_pk_fma_f32 v[18:19], v[134:135], v[32:33], v[38:39] op_sel:[0,0,1] op_sel_hi:[1,0,1] neg_lo:[0,0,1] neg_hi:[0,0,1]
    v_pk_fma_f32 v[20:21], v[136:137], v[32:33], v[38:39] op_sel:[0,0,1] op_sel_hi:[1,0,1] neg_lo:[0,0,1] neg_hi:[0,0,1]
    v_pk_fma_f32 v[22:23], v[138:139], v[32:33], v[38:39] op_sel:[0,0,1] op_sel_hi:[1,0,1] neg_lo:[0,0,1] neg_hi:[0,0,1]
    v_pk_fma_f32 v[28:29], v[140:141], v[32:33], v[38:39] op_sel:[0,0,1] op_sel_hi:[1,0,1] neg_lo:[0,0,1] neg_hi:[0,0,1]
    v_pk_fma_f32 v[30:31], v[142:143], v[32:33], v[38:39] op_sel:[0,0,1] op_sel_hi:[1,0,1] neg_lo:[0,0,1] neg_hi:[0,0,1]
    v_pk_fma_f32 v[40:41], v[144:145], v[32:33], v[38:39] op_sel:[0,0,1] op_sel_hi:[1,0,1] neg_lo:[0,0,1] neg_hi:[0,0,1]
    v_pk_fma_f32 v[42:43], v[146:147], v[32:33], v[38:39] op_sel:[0,0,1] op_sel_hi:[1,0,1] neg_lo:[0,0,1] neg_hi:[0,0,1]
    v_pk_fma_f32 v[184:185], v[148:149], v[32:33], v[38:39] op_sel:[0,0,1] op_sel_hi:[1,0,1] neg_lo:[0,0,1] neg_hi:[0,0,1]
    v_pk_fma_f32 v[186:187], v[150:151], v[32:33], v[38:39] op_sel:[0,0,1] op_sel_hi:[1,0,1] neg_lo:[0,0,1] neg_hi:[0,0,1]
    v_exp_f32 v16, v16
    v_exp_f32 v17, v17
    v_exp_f32 v18, v18
    v_exp_f32 v19, v19
    v_exp_f32 v20, v20
    v_exp_f32 v21, v21
    v_pk_add_f32 v[34:35], v[16:17], v[18:19]
    v_exp_f32 v22, v22
    v_exp_f32 v23, v23
    v_pk_add_f32 v[34:35], v[34:35], v[20:21]
    v_exp_f32 v28, v28
    v_exp_f32 v29, v29
    v_pk_add_f32 v[34:35], v[34:35], v[22:23]
    v_exp_f32 v30, v30
    v_exp_f32 v31, v31
    v_pk_add_f32 v[34:35], v[34:35], v[28:29]
    v_exp_f32 v40, v40
    v_exp_f32 v41, v41
    v_pk_add_f32 v[34:35], v[34:35], v[30:31]
    v_exp_f32 v42, v42
    v_exp_f32 v43, v43
    v_pk_add_f32 v[34:35], v[34:35], v[40:41]
    v_exp_f32 v184, v184
    v_exp_f32 v185, v185
    v_pk_add_f32 v[34:35], v[34:35], v[42:43]
    v_exp_f32 v186, v186
    v_exp_f32 v187, v187
    v_pk_add_f32 v[34:35], v[34:35], v[184:185]
    v_xor_b32 v5, 112, v64
    ds_write_b128 v5, v[128:131]
    v_pk_fma_f32 v[132:133], v[132:133], v[32:33], v[48:49] op_sel:[0,0,1] op_sel_hi:[1,0,1] neg_lo:[1,0,0] neg_hi:[1,0,0]
    v_pk_add_f32 v[34:35], v[34:35], v[186:187]
    v_pk_fma_f32 v[134:135], v[134:135], v[32:33], v[48:49] op_sel:[0,0,1] op_sel_hi:[1,0,1] neg_lo:[1,0,0] neg_hi:[1,0,0]
    v_add_f32_e64 v34, v34, v35
    v_pk_fma_f32 v[136:137], v[136:137], v[32:33], v[48:49] op_sel:[0,0,1] op_sel_hi:[1,0,1] neg_lo:[1,0,0] neg_hi:[1,0,0]
    v_rcp_f32_e64 v35, v34
    v_pk_fma_f32 v[138:139], v[138:139], v[32:33], v[48:49] op_sel:[0,0,1] op_sel_hi:[1,0,1] neg_lo:[1,0,0] neg_hi:[1,0,0]
    v_pk_fma_f32 v[140:141], v[140:141], v[32:33], v[48:49] op_sel:[0,0,1] op_sel_hi:[1,0,1] neg_lo:[1,0,0] neg_hi:[1,0,0]
    v_mul_f32_e64 v35, v35, v33
    v_pk_fma_f32 v[142:143], v[142:143], v[32:33], v[48:49] op_sel:[0,0,1] op_sel_hi:[1,0,1] neg_lo:[1,0,0] neg_hi:[1,0,0]
    v_pk_fma_f32 v[144:145], v[144:145], v[32:33], v[48:49] op_sel:[0,0,1] op_sel_hi:[1,0,1] neg_lo:[1,0,0] neg_hi:[1,0,0]
    v_pk_fma_f32 v[146:147], v[146:147], v[32:33], v[48:49] op_sel:[0,0,1] op_sel_hi:[1,0,1] neg_lo:[1,0,0] neg_hi:[1,0,0]
    v_pk_fma_f32 v[148:149], v[148:149], v[32:33], v[48:49] op_sel:[0,0,1] op_sel_hi:[1,0,1] neg_lo:[1,0,0] neg_hi:[1,0,0]
    v_pk_fma_f32 v[150:151], v[150:151], v[32:33], v[48:49] op_sel:[0,0,1] op_sel_hi:[1,0,1] neg_lo:[1,0,0] neg_hi:[1,0,0]
    v_pk_mul_f32 v[16:17], v[16:17], v[34:35] op_sel:[0,1] op_sel_hi:[1,1]
    v_cvt_pk_bf16_f32 v100, v16, v17
    v_pk_mul_f32 v[18:19], v[18:19], v[34:35] op_sel:[0,1] op_sel_hi:[1,1]
    v_cvt_pk_bf16_f32 v101, v18, v19
    v_pk_mul_f32 v[20:21], v[20:21], v[34:35] op_sel:[0,1] op_sel_hi:[1,1]
    v_cvt_pk_bf16_f32 v102, v20, v21
    v_pk_mul_f32 v[22:23], v[22:23], v[34:35] op_sel:[0,1] op_sel_hi:[1,1]
    v_cvt_pk_bf16_f32 v103, v22, v23
    v_xor_b32_e64 v5, 0, v64
    ds_write_b128 v5, v[100:103]
    v_pk_mul_f32 v[28:29], v[28:29], v[34:35] op_sel:[0,1] op_sel_hi:[1,1]
    v_cvt_pk_bf16_f32 v104, v28, v29
    v_pk_mul_f32 v[30:31], v[30:31], v[34:35] op_sel:[0,1] op_sel_hi:[1,1]
    v_cvt_pk_bf16_f32 v105, v30, v31
    v_pk_mul_f32 v[40:41], v[40:41], v[34:35] op_sel:[0,1] op_sel_hi:[1,1]
    v_cvt_pk_bf16_f32 v106, v40, v41
    v_pk_mul_f32 v[42:43], v[42:43], v[34:35] op_sel:[0,1] op_sel_hi:[1,1]
    v_cvt_pk_bf16_f32 v107, v42, v43
    v_xor_b32_e64 v5, 16, v64
    ds_write_b128 v5, v[104:107]
    v_pk_mul_f32 v[184:185], v[184:185], v[34:35] op_sel:[0,1] op_sel_hi:[1,1]
    v_cvt_pk_bf16_f32 v108, v184, v185
    v_pk_mul_f32 v[186:187], v[186:187], v[34:35] op_sel:[0,1] op_sel_hi:[1,1]
    v_cvt_pk_bf16_f32 v109, v186, v187
    v_exp_f32 v132, v132
    v_exp_f32 v133, v133
    v_exp_f32 v134, v134
    v_exp_f32 v135, v135
    v_exp_f32 v136, v136
    v_exp_f32 v137, v137
    v_pk_add_f32 v[36:37], v[132:133], v[134:135]
    v_exp_f32 v138, v138
    v_exp_f32 v139, v139
    v_pk_add_f32 v[36:37], v[36:37], v[136:137]
    v_exp_f32 v140, v140
    v_exp_f32 v141, v141
    v_pk_add_f32 v[36:37], v[36:37], v[138:139]
    v_exp_f32 v142, v142
    v_exp_f32 v143, v143
    v_pk_add_f32 v[36:37], v[36:37], v[140:141]
    v_exp_f32 v144, v144
    v_exp_f32 v145, v145
    v_pk_add_f32 v[36:37], v[36:37], v[142:143]
    v_exp_f32 v146, v146
    v_exp_f32 v147, v147
    v_pk_add_f32 v[36:37], v[36:37], v[144:145]
    v_exp_f32 v148, v148
    v_exp_f32 v149, v149
    v_pk_add_f32 v[36:37], v[36:37], v[146:147]
    v_exp_f32 v150, v150
    v_exp_f32 v151, v151
    v_pk_add_f32 v[36:37], v[36:37], v[148:149]
    v_mul_f32 v38, 0x358637bd, v34
    v_pk_add_f32 v[36:37], v[36:37], v[150:151]
    v_add_f32 v36, v36, v37
    v_rcp_f32 v36, v36
    s_nop 0
    v_mul_f32 v36, v36, v33
    v_pk_mul_f32 v[132:133], v[132:133], v[36:37] op_sel_hi:[1,0]
    v_cvt_pk_bf16_f32 v110, v132, v133
    v_pk_mul_f32 v[134:135], v[134:135], v[36:37] op_sel_hi:[1,0]
    v_cvt_pk_bf16_f32 v111, v134, v135
    v_xor_b32_e64 v5, 32, v64
    ds_write_b128 v5, v[108:111]
    v_pk_mul_f32 v[136:137], v[136:137], v[36:37] op_sel_hi:[1,0]
    v_cvt_pk_bf16_f32 v112, v136, v137
    v_pk_mul_f32 v[138:139], v[138:139], v[36:37] op_sel_hi:[1,0]
    v_cvt_pk_bf16_f32 v113, v138, v139
    v_pk_mul_f32 v[140:141], v[140:141], v[36:37] op_sel_hi:[1,0]
    v_cvt_pk_bf16_f32 v114, v140, v141
    v_pk_mul_f32 v[142:143], v[142:143], v[36:37] op_sel_hi:[1,0]
    v_cvt_pk_bf16_f32 v115, v142, v143
    v_xor_b32_e64 v5, 48, v64
    ds_write_b128 v5, v[112:115]
    v_pk_mul_f32 v[144:145], v[144:145], v[36:37] op_sel_hi:[1,0]
    v_cvt_pk_bf16_f32 v116, v144, v145
    v_pk_mul_f32 v[146:147], v[146:147], v[36:37] op_sel_hi:[1,0]
    v_cvt_pk_bf16_f32 v117, v146, v147
    v_pk_mul_f32 v[148:149], v[148:149], v[36:37] op_sel_hi:[1,0]
    v_cvt_pk_bf16_f32 v118, v148, v149
    v_pk_mul_f32 v[150:151], v[150:151], v[36:37] op_sel_hi:[1,0]
    v_cvt_pk_bf16_f32 v119, v150, v151
    v_xor_b32_e64 v5, 64, v64
    ds_write_b128 v5, v[116:119]
    s_waitcnt vmcnt(7)
    v_cmp_ne_u64 s[8:9], v[10:11], v[44:45]
    s_nop 0
    s_cmp_lg_u64 s[8:9], 0
    s_cbranch_scc1 L_f1spin_7
L_f1ok_8:
    s_waitcnt vmcnt(11) lgkmcnt(0)
    s_barrier
    ds_read_b64_tr_b16 a[200:201], v76 offset:0
    ds_read_b64_tr_b16 a[202:203], v76 offset:2048
    ds_read_b64_tr_b16 a[188:189], v73 offset:0
    ds_read_b64_tr_b16 a[190:191], v73 offset:2048
    ds_read_b64_tr_b16 a[192:193], v74 offset:0
    ds_read_b64_tr_b16 a[194:195], v74 offset:2048
    ds_read_b64_tr_b16 a[196:197], v75 offset:0
    ds_read_b64_tr_b16 a[198:199], v75 offset:2048
    ds_read_b64_tr_b16 a[216:217], v76 offset:4096
    ds_read_b64_tr_b16 a[218:219], v76 offset:6144
    ds_read_b64_tr_b16 a[204:205], v73 offset:4096
    ds_read_b64_tr_b16 a[206:207], v73 offset:6144
    ds_read_b64_tr_b16 a[208:209], v74 offset:4096
    ds_read_b64_tr_b16 a[210:211], v74 offset:6144
    ds_read_b64_tr_b16 a[212:213], v75 offset:4096
    ds_read_b64_tr_b16 a[214:215], v75 offset:6144
    s_waitcnt lgkmcnt(12)
    v_mfma_f32_16x16x32_bf16 v[16:19], a[188:191], a[200:203], 0
    ds_read_b64_tr_b16 a[232:233], v76 offset:8192
    ds_read_b64_tr_b16 a[234:235], v76 offset:10240
    ds_read_b64_tr_b16 a[220:221], v73 offset:8192
    s_waitcnt lgkmcnt(13)
    v_mfma_f32_16x16x32_bf16 v[20:23], a[192:195], a[200:203], 0
    ds_read_b64_tr_b16 a[222:223], v73 offset:10240
    ds_read_b64_tr_b16 a[224:225], v74 offset:8192
    ds_read_b64_tr_b16 a[226:227], v74 offset:10240
    s_waitcnt lgkmcnt(14)
    v_mfma_f32_16x16x32_bf16 v[28:31], a[196:199], a[200:203], 0
    ds_read_b64_tr_b16 a[228:229], v75 offset:8192
    ds_read_b64_tr_b16 a[230:231], v75 offset:10240
    ds_read_b64_tr_b16 a[248:249], v76 offset:12288
    s_waitcnt lgkmcnt(13)
    v_mfma_f32_16x16x32_bf16 v[16:19], a[204:207], a[216:219], v[16:19]
    ds_read_b64_tr_b16 a[250:251], v76 offset:14336
    ds_read_b64_tr_b16 a[236:237], v73 offset:12288
    ds_read_b64_tr_b16 a[238:239], v73 offset:14336
    s_waitcnt lgkmcnt(14)
    v_mfma_f32_16x16x32_bf16 v[20:23], a[208:211], a[216:219], v[20:23]
    ds_read_b64_tr_b16 a[240:241], v74 offset:12288
    ds_read_b64_tr_b16 a[242:243], v74 offset:14336
    ds_read_b64_tr_b16 a[244:245], v75 offset:12288
    s_waitcnt lgkmcnt(15)
    v_mfma_f32_16x16x32_bf16 v[28:31], a[212:215], a[216:219], v[28:31]
    ds_read_b64_tr_b16 a[246:247], v75 offset:14336
    s_waitcnt lgkmcnt(12)
    v_mfma_f32_16x16x32_bf16 v[16:19], a[220:223], a[232:235], v[16:19]
    ds_read_b128 v[172:175], v55 offset:0
    s_waitcnt lgkmcnt(11)
    v_mfma_f32_16x16x32_bf16 v[20:23], a[224:227], a[232:235], v[20:23]
    ds_read_b128 v[176:179], v55 offset:256
    s_waitcnt lgkmcnt(10)
    v_mfma_f32_16x16x32_bf16 v[28:31], a[228:231], a[232:235], v[28:31]
    ds_read_b128 v[180:183], v56 offset:512
    s_waitcnt lgkmcnt(7)
    v_mfma_f32_16x16x32_bf16 v[16:19], a[236:239], a[248:251], v[16:19]
    ds_read_b128 v[212:215], v55 offset:2560
    s_waitcnt lgkmcnt(6)
    v_mfma_f32_16x16x32_bf16 v[20:23], a[240:243], a[248:251], v[20:23]
    ds_read_b128 v[216:219], v55 offset:2816
    s_waitcnt lgkmcnt(5)
    v_mfma_f32_16x16x32_bf16 v[28:31], a[244:247], a[248:251], v[28:31]
    ds_read_b128 v[220:223], v56 offset:3072
    ds_read_b128 v[224:227], v55 offset:5120
    ds_read_b128 v[228:231], v55 offset:5376
    ds_read_b128 v[232:235], v56 offset:5632
    s_mov_b32 s80, 0xffff
    s_mov_b32 s81, 0x0
    v_cndmask_b32 v5, v9, v65, s[80:81]
    v_cvt_pk_bf16_f32 v40, v16, v17
    v_cvt_pk_bf16_f32 v41, v18, v19
    v_cvt_pk_bf16_f32 v42, v20, v21
    v_cvt_pk_bf16_f32 v43, v22, v23
    v_cvt_pk_bf16_f32 v96, v28, v29
    v_cvt_pk_bf16_f32 v97, v30, v31
    buffer_store_dwordx4 v[40:43], v65, s[28:31], s62 offen sc1
    v_permlane16_swap_b32 v96, v98
    v_permlane16_swap_b32_e64 v97, v99
    buffer_store_dwordx4 v[96:99], v5, s[28:31], s63 offen sc1
    s_waitcnt lgkmcnt(7)
    v_mfma_f32_16x16x32_bf16 v[132:135], v[172:175], a[4:7], 0
    s_xor_b32 s86, s39, 8192
    s_mul_i32 s86, s86, 5
    s_add_u32 s86, s86, s66
    v_mfma_f32_16x16x32_bf16 v[152:155], v[172:175], a[8:11], 0
    ds_read_b128 v[236:239], v55 offset:7680
    s_add_u32 m0, s45, 40960
    v_mfma_f32_16x16x32_bf16 v[136:139], v[176:179], a[4:7], 0
    buffer_load_dwordx4 v2, s[28:31], s86 offen offset:0 sc1 lds
    v_mfma_f32_16x16x32_bf16 v[156:159], v[176:179], a[8:11], 0
    ds_read_b128 v[172:175], v55 offset:7936
    s_waitcnt lgkmcnt(6)
    v_mfma_f32_16x16x32_bf16 v[140:143], v[180:183], a[4:7], 0
    s_waitcnt vmcnt(3)
    s_barrier
    v_mov_b32 v39, 0xff800000
    v_mfma_f32_16x16x32_bf16 v[160:163], v[180:183], a[8:11], 0
    ds_read_b128 v[176:179], v56 offset:8192
    v_mov_b32 v49, 0x7f800000
    v_mfma_f32_16x16x32_bf16 v[132:135], v[212:215], a[12:15], v[132:135]
    buffer_load_dwordx4 v2, s[28:31], s86 offen offset:1024 sc1 lds
    v_mfma_f32_16x16x32_bf16 v[152:155], v[212:215], a[16:19], v[152:155]
    ds_read_b128 v[180:183], v55 offset:10240
    v_lshlrev_b32_e64 v84, 7, v8
    v_mfma_f32_16x16x32_bf16 v[136:139], v[216:219], a[12:15], v[136:139]
    buffer_store_dwordx2 v[10:11], v46, s[28:31], s41 offen sc1
    v_mfma_f32_16x16x32_bf16 v[156:159], v[216:219], a[16:19], v[156:159]
    ds_read_b128 v[212:215], v55 offset:10496
    s_waitcnt lgkmcnt(4)
    v_mfma_f32_16x16x32_bf16 v[140:143], v[220:223], a[12:15], v[140:143]
    buffer_load_dwordx4 v2, s[28:31], s86 offen offset:2048 sc1 lds
    v_mfma_f32_16x16x32_bf16 v[160:163], v[220:223], a[16:19], v[160:163]
    ds_read_b128 v[216:219], v56 offset:10752
    s_lshr_b32 s90, s35, 5
    v_mfma_f32_16x16x32_bf16 v[132:135], v[224:227], a[20:23], v[132:135]
    ds_read_b64_tr_b16 a[164:165], v70 offset:0
    s_lshr_b32 s91, s67, 5
    v_mfma_f32_16x16x32_bf16 v[152:155], v[224:227], a[24:27], v[152:155]
    ds_read_b128 v[220:223], v55 offset:12800
    v_readlane_b32 s32, v241, s90
    v_mfma_f32_16x16x32_bf16 v[136:139], v[228:231], a[20:23], v[136:139]
    buffer_load_dwordx4 v2, s[28:31], s86 offen offset:3072 sc1 lds
    v_mfma_f32_16x16x32_bf16 v[156:159], v[228:231], a[24:27], v[156:159]
    ds_read_b128 v[224:227], v55 offset:13056
    s_add_u32 m0, s45, 45056
    v_mfma_f32_16x16x32_bf16 v[140:143], v[232:235], a[20:23], v[140:143]
    ds_read_b64_tr_b16 a[172:173], v70 offset:8192
    v_readlane_b32 s34, v241, s91
    v_mfma_f32_16x16x32_bf16 v[160:163], v[232:235], a[24:27], v[160:163]
    ds_read_b128 v[228:231], v56 offset:13312
    v_readlane_b32 s80, v245, s91
    v_mfma_f32_16x16x32_bf16 v[132:135], v[236:239], a[28:31], v[132:135]
    buffer_load_dwordx4 v63, s[28:31], s86 offen sc1 lds
    v_mfma_f32_16x16x32_bf16 v[152:155], v[236:239], a[32:35], v[152:155]
    ds_read_b128 v[232:235], v55 offset:15360
    s_waitcnt lgkmcnt(6)
    v_mfma_f32_16x16x32_bf16 v[136:139], v[172:175], a[28:31], v[136:139]
    ds_read_b64_tr_b16 a[166:167], v70 offset:512
    s_xor_b32 s86, s39, 12288
    v_mfma_f32_16x16x32_bf16 v[156:159], v[172:175], a[32:35], v[156:159]
    ds_read_b128 v[236:239], v55 offset:15616
    s_mul_i32 s86, s86, 5
    v_mfma_f32_16x16x32_bf16 v[140:143], v[176:179], a[28:31], v[140:143]
    ds_read_b64_tr_b16 a[174:175], v70 offset:8704
    s_add_u32 s86, s86, s66
    v_mfma_f32_16x16x32_bf16 v[160:163], v[176:179], a[32:35], v[160:163]
    ds_read_b128 v[172:175], v56 offset:15872
    s_add_u32 m0, s45, 61440
    v_mfma_f32_16x16x32_bf16 v[132:135], v[180:183], a[36:39], v[132:135]
    buffer_load_dwordx4 v2, s[28:31], s86 offen offset:0 sc1 lds
    v_mfma_f32_16x16x32_bf16 v[152:155], v[180:183], a[40:43], v[152:155]
    ds_read_b128 v[176:179], v55 offset:17920
    s_mov_b32 vcc_lo, 0xaaaaaaaa
    v_mfma_f32_16x16x32_bf16 v[136:139], v[212:215], a[36:39], v[136:139]
    ds_read_b64_tr_b16 a[168:169], v70 offset:4096
    s_mov_b32 vcc_hi, 0xaaaaaaaa
    v_mfma_f32_16x16x32_bf16 v[156:159], v[212:215], a[40:43], v[156:159]
    ds_read_b128 v[180:183], v55 offset:18176
    s_cmp_eq_u32 s90, s91
    s_cselect_b32 s34, s80, s34
    v_mfma_f32_16x16x32_bf16 v[140:143], v[216:219], a[36:39], v[140:143]
    buffer_load_dwordx4 v2, s[28:31], s86 offen offset:1024 sc1 lds
    v_mfma_f32_16x16x32_bf16 v[160:163], v[216:219], a[40:43], v[160:163]
    ds_read_b128 v[212:215], v56 offset:18432
    s_waitcnt lgkmcnt(6)
    v_mfma_f32_16x16x32_bf16 v[132:135], v[220:223], a[44:47], v[132:135]
    ds_read_b64_tr_b16 a[176:177], v70 offset:12288
    v_mov_b32 v5, s32
    v_mfma_f32_16x16x32_bf16 v[152:155], v[220:223], a[48:51], v[152:155]
    ds_read_b128 v[216:219], v55 offset:20480
    v_mov_b32_e64 v6, s34
    v_mfma_f32_16x16x32_bf16 v[136:139], v[224:227], a[44:47], v[136:139]
    buffer_load_dwordx4 v2, s[28:31], s86 offen offset:2048 sc1 lds
    v_mfma_f32_16x16x32_bf16 v[156:159], v[224:227], a[48:51], v[156:159]
    ds_read_b128 v[220:223], v55 offset:20736
    v_cndmask_b32_e64 v249, v5, v6, vcc
    v_mfma_f32_16x16x32_bf16 v[140:143], v[228:231], a[44:47], v[140:143]
    ds_read_b64_tr_b16 a[170:171], v70 offset:4608
    v_and_b32 v6, 0xffff0000, v249
    v_mfma_f32_16x16x32_bf16 v[160:163], v[228:231], a[48:51], v[160:163]
    ds_read_b128 v[224:227], v56 offset:20992
    v_rcp_f32_e64 v248, v6
    v_mfma_f32_16x16x32_bf16 v[132:135], v[232:235], a[52:55], v[132:135]
    buffer_load_dwordx4 v2, s[28:31], s86 offen offset:3072 sc1 lds
    v_mfma_f32_16x16x32_bf16 v[152:155], v[232:235], a[56:59], v[152:155]
    ds_read_b128 v[228:231], v55 offset:23040
    s_add_u32 m0, s45, 65536
    v_mfma_f32_16x16x32_bf16 v[136:139], v[236:239], a[52:55], v[136:139]
    ds_read_b64_tr_b16 a[178:179], v70 offset:12800
    v_lshlrev_b32_e64 v249, 16, v249
    v_mfma_f32_16x16x32_bf16 v[156:159], v[236:239], a[56:59], v[156:159]
    ds_read_b128 v[232:235], v55 offset:23296
    s_waitcnt lgkmcnt(6)
    v_mfma_f32_16x16x32_bf16 v[140:143], v[172:175], a[52:55], v[140:143]
    buffer_load_dwordx4 v63, s[28:31], s86 offen sc1 lds
    v_mfma_f32_16x16x32_bf16 v[160:163], v[172:175], a[56:59], v[160:163]
    ds_read_b128 v[236:239], v56 offset:23552
    s_add_u32 m0, s45, 81920
    v_mfma_f32_16x16x32_bf16 v[132:135], v[176:179], a[60:63], v[132:135]
    v_mul_f32_e64 v249, v249, v248
    s_waitcnt vmcnt(16)
    v_mfma_f32_16x16x32_bf16 v[152:155], v[176:179], a[64:67], v[152:155]
    ds_read_b128 v[172:175], v55 offset:25600
    v_lshlrev_b32_e64 v16, 16, v204
    v_mfma_f32_16x16x32_bf16 v[136:139], v[180:183], a[60:63], v[136:139]
    buffer_load_dwordx4 v2, s[28:31], s61 offen offset:0 sc1 lds
    v_mfma_f32_16x16x32_bf16 v[156:159], v[180:183], a[64:67], v[156:159]
    ds_read_b128 v[176:179], v55 offset:25856
    v_and_b32 v17, 0xffff0000, v204
    v_mfma_f32_16x16x32_bf16 v[140:143], v[212:215], a[60:63], v[140:143]
    v_fma_f32 v16, v16, v248, -v249
    v_fma_f32 v17, v17, v248, -v249
    v_mfma_f32_16x16x32_bf16 v[160:163], v[212:215], a[64:67], v[160:163]
    ds_read_b128 v[180:183], v56 offset:26112
    v_cvt_pk_bf16_f32 v204, v16, v17
    v_mfma_f32_16x16x32_bf16 v[132:135], v[216:219], a[68:71], v[132:135]
    buffer_load_dwordx4 v2, s[28:31], s61 offen offset:1024 sc1 lds
    v_mfma_f32_16x16x32_bf16 v[152:155], v[216:219], a[72:75], v[152:155]
    ds_read_b128 v[212:215], v55 offset:28160
    s_waitcnt lgkmcnt(4)
    v_mfma_f32_16x16x32_bf16 v[136:139], v[220:223], a[68:71], v[136:139]
    v_lshlrev_b32 v16, 16, v205
    v_and_b32 v17, 0xffff0000, v205
    v_mfma_f32_16x16x32_bf16 v[156:159], v[220:223], a[72:75], v[156:159]
    ds_read_b128 v[216:219], v55 offset:28416
    v_fma_f32 v16, v16, v248, -v249
    v_mfma_f32_16x16x32_bf16 v[140:143], v[224:227], a[68:71], v[140:143]
    buffer_load_dwordx4 v2, s[28:31], s61 offen offset:2048 sc1 lds
    v_mfma_f32_16x16x32_bf16 v[160:163], v[224:227], a[72:75], v[160:163]
    ds_read_b128 v[220:223], v56 offset:28672
    v_fma_f32 v17, v17, v248, -v249
    v_mfma_f32_16x16x32_bf16 v[132:135], v[228:231], a[76:79], v[132:135]
    v_cvt_pk_bf16_f32 v205, v16, v17
    v_lshlrev_b32_e64 v16, 16, v206
    v_mfma_f32_16x16x32_bf16 v[152:155], v[228:231], a[80:83], v[152:155]
    ds_read_b128 v[224:227], v55 offset:30720
    v_and_b32 v17, 0xffff0000, v206
    v_mfma_f32_16x16x32_bf16 v[136:139], v[232:235], a[76:79], v[136:139]
    buffer_load_dwordx4 v2, s[28:31], s61 offen offset:3072 sc1 lds
    v_mfma_f32_16x16x32_bf16 v[156:159], v[232:235], a[80:83], v[156:159]
    ds_read_b128 v[228:231], v55 offset:30976
    s_add_u32 m0, s45, 86016
    v_mfma_f32_16x16x32_bf16 v[140:143], v[236:239], a[76:79], v[140:143]
    v_fma_f32 v16, v16, v248, -v249
    v_fma_f32 v17, v17, v248, -v249
    v_mfma_f32_16x16x32_bf16 v[160:163], v[236:239], a[80:83], v[160:163]
    ds_read_b128 v[232:235], v56 offset:31232
    s_waitcnt lgkmcnt(4)
    v_mfma_f32_16x16x32_bf16 v[132:135], v[172:175], a[84:87], v[132:135]
    buffer_load_dwordx4 v63, s[28:31], s61 offen sc1 lds
    v_mfma_f32_16x16x32_bf16 v[152:155], v[172:175], a[88:91], v[152:155]
    ds_read_b128 v[236:239], v55 offset:33280
    v_cvt_pk_bf16_f32 v206, v16, v17
    v_mfma_f32_16x16x32_bf16 v[136:139], v[176:179], a[84:87], v[136:139]
    buffer_load_dwordx4 a[188:191], v67, s[28:31], 0 offen sc1
    v_mfma_f32_16x16x32_bf16 v[156:159], v[176:179], a[88:91], v[156:159]
    ds_read_b128 v[172:175], v55 offset:33536
    s_mov_b32 s86, 4096
    v_mfma_f32_16x16x32_bf16 v[140:143], v[180:183], a[84:87], v[140:143]
    v_lshlrev_b32 v16, 16, v207
    v_and_b32 v17, 0xffff0000, v207
    v_mfma_f32_16x16x32_bf16 v[160:163], v[180:183], a[88:91], v[160:163]
    ds_read_b128 v[176:179], v56 offset:33792
    v_fma_f32 v16, v16, v248, -v249
    v_mfma_f32_16x16x32_bf16 v[132:135], v[212:215], a[92:95], v[132:135]
    buffer_load_dwordx4 a[192:195], v67, s[28:31], s86 offen sc1
    v_mfma_f32_16x16x32_bf16 v[152:155], v[212:215], a[96:99], v[152:155]
    ds_read_b128 v[180:183], v55 offset:35840
    s_mov_b32 s86, 8192
    v_mfma_f32_16x16x32_bf16 v[136:139], v[216:219], a[92:95], v[136:139]
    v_fma_f32 v17, v17, v248, -v249
    v_cvt_pk_bf16_f32 v207, v16, v17
    v_mfma_f32_16x16x32_bf16 v[156:159], v[216:219], a[96:99], v[156:159]
    ds_read_b128 v[212:215], v55 offset:36096
    s_waitcnt lgkmcnt(4)
    v_mfma_f32_16x16x32_bf16 v[140:143], v[220:223], a[92:95], v[140:143]
    buffer_load_dwordx4 a[196:199], v67, s[28:31], s86 offen sc1
    v_mfma_f32_16x16x32_bf16 v[160:163], v[220:223], a[96:99], v[160:163]
    ds_read_b128 v[216:219], v56 offset:36352
    s_mov_b32 s86, 12288
    v_mfma_f32_16x16x32_bf16 v[132:135], v[224:227], a[100:103], v[132:135]
    v_mov_b32_dpp v208, v204 row_shl:4 row_mask:0xf bank_mask:0xf bound_ctrl:1
    v_mov_b32_dpp v209, v205 row_shl:4 row_mask:0xf bank_mask:0xf bound_ctrl:1
    v_mfma_f32_16x16x32_bf16 v[152:155], v[224:227], a[104:107], v[152:155]
    ds_read_b128 v[220:223], v55 offset:38400
    v_mov_b32_dpp v210, v206 row_shl:4 row_mask:0xf bank_mask:0xf bound_ctrl:1
    v_mfma_f32_16x16x32_bf16 v[136:139], v[228:231], a[100:103], v[136:139]
    buffer_load_dwordx4 a[200:203], v67, s[28:31], s86 offen sc1
    v_mfma_f32_16x16x32_bf16 v[156:159], v[228:231], a[104:107], v[156:159]
    ds_read_b128 v[224:227], v55 offset:38656
    s_mov_b32 s86, 16384
    v_mfma_f32_16x16x32_bf16 v[140:143], v[232:235], a[100:103], v[140:143]
    v_mov_b32_dpp v211, v207 row_shl:4 row_mask:0xf bank_mask:0xf bound_ctrl:1
    s_waitcnt lgkmcnt(15)
    v_mfma_f32_16x16x32_bf16 v[240:243], a[164:167], v[204:207], 0
    v_mfma_f32_16x16x32_bf16 v[244:247], a[172:175], v[204:207], 0
    buffer_load_dwordx4 a[204:207], v67, s[28:31], s86 offen sc1
    v_mfma_f32_16x16x32_bf16 v[240:243], a[168:171], v[208:211], v[240:243]
    s_mov_b32 s86, 20480
    v_mfma_f32_16x16x32_bf16 v[244:247], a[176:179], v[208:211], v[244:247]
    s_mov_b32 vcc_lo, 0xcccccccc
    v_mfma_f32_16x16x32_bf16 v[160:163], v[232:235], a[104:107], v[160:163]
    ds_read_b128 v[228:231], v56 offset:38912
    s_mov_b32 vcc_hi, 0xcccccccc
    v_mfma_f32_16x16x32_bf16 v[132:135], v[236:239], a[108:111], v[132:135]
    buffer_load_dwordx4 a[208:211], v67, s[28:31], s86 offen sc1
    v_mfma_f32_16x16x32_bf16 v[152:155], v[236:239], a[112:115], v[152:155]
    ds_read_b128 v[232:235], v55 offset:40960
    s_waitcnt lgkmcnt(4)
    v_mfma_f32_16x16x32_bf16 v[136:139], v[172:175], a[108:111], v[136:139]
    s_mov_b32 s86, 24576
    s_nop 0
    v_mfma_f32_16x16x32_bf16 v[156:159], v[172:175], a[112:115], v[156:159]
    ds_read_b128 v[236:239], v55 offset:43520
    v_cndmask_b32_e64 v240, v240, v244, vcc
    v_mfma_f32_16x16x32_bf16 v[140:143], v[176:179], a[108:111], v[140:143]
    buffer_load_dwordx4 a[212:215], v67, s[28:31], s86 offen sc1
    v_mfma_f32_16x16x32_bf16 v[160:163], v[176:179], a[112:115], v[160:163]
    ds_read_b128 v[172:175], v55 offset:46080
    s_mov_b32 s86, 28672
    v_mfma_f32_16x16x32_bf16 v[132:135], v[180:183], a[116:119], v[132:135]
    v_cndmask_b32 v241, v241, v245, vcc
    v_cndmask_b32 v242, v242, v246, vcc
    v_mfma_f32_16x16x32_bf16 v[152:155], v[180:183], a[120:123], v[152:155]
    ds_read_b128 v[176:179], v55 offset:48640
    v_cndmask_b32_e64 v243, v243, v247, vcc
    v_mfma_f32_16x16x32_bf16 v[136:139], v[212:215], a[116:119], v[136:139]
    ds_read_b64_tr_b16 v[180:181], v59 offset:160
    v_mfma_f32_16x16x32_bf16 v[156:159], v[212:215], a[120:123], v[156:159]
    ds_read_b64_tr_b16 v[182:183], v60 offset:160
    v_mfma_f32_16x16x32_bf16 v[140:143], v[216:219], a[116:119], v[140:143]
    buffer_load_dwordx4 a[216:219], v67, s[28:31], s86 offen sc1
    v_mfma_f32_16x16x32_bf16 v[160:163], v[216:219], a[120:123], v[160:163]
    ds_read_b128 v[212:215], v55 offset:41216
    s_waitcnt lgkmcnt(5)
    v_mfma_f32_16x16x32_bf16 v[132:135], v[220:223], a[124:127], v[132:135]
    buffer_store_dwordx4 v[240:243], v83, s[28:31], s58 offen sc1
    v_mfma_f32_16x16x32_bf16 v[152:155], v[220:223], a[128:131], v[152:155]
    ds_read_b128 v[216:219], v55 offset:43776
    s_mov_b32 s86, 32768
    v_mfma_f32_16x16x32_bf16 v[136:139], v[224:227], a[124:127], v[136:139]
    buffer_load_dwordx4 a[220:223], v67, s[28:31], s86 offen sc1
    v_mfma_f32_16x16x32_bf16 v[156:159], v[224:227], a[128:131], v[156:159]
    ds_read_b128 v[220:223], v55 offset:46336
    s_mov_b32 s86, 36864
    v_mfma_f32_16x16x32_bf16 v[140:143], v[228:231], a[124:127], v[140:143]
    ds_read_b64_tr_b16 a[180:181], v70 offset:16384
    v_mfma_f32_16x16x32_bf16 v[160:163], v[228:231], a[128:131], v[160:163]
    ds_read_b128 v[224:227], v55 offset:48896
    v_mfma_f32_16x16x32_bf16 v[132:135], v[232:235], a[132:135], v[132:135]
    ds_read_b64_tr_b16 v[228:229], v59 offset:168
    v_mfma_f32_16x16x32_bf16 v[152:155], v[232:235], a[136:139], v[152:155]
    ds_read_b64_tr_b16 v[230:231], v60 offset:168
    v_mfma_f32_16x16x32_bf16 v[132:135], v[236:239], a[140:143], v[132:135]
    buffer_load_dwordx4 a[224:227], v67, s[28:31], s86 offen sc1
    v_mfma_f32_16x16x32_bf16 v[152:155], v[236:239], a[144:147], v[152:155]
    ds_read_b128 v[232:235], v56 offset:41472
    s_waitcnt lgkmcnt(6)
    v_mfma_f32_16x16x32_bf16 v[132:135], v[172:175], a[148:151], v[132:135]
    ds_read_b64_tr_b16 a[182:183], v70 offset:16896
    s_mov_b32 s86, 40960
    v_mfma_f32_16x16x32_bf16 v[152:155], v[172:175], a[152:155], v[152:155]
    ds_read_b128 v[236:239], v56 offset:44032
    v_mfma_f32_16x16x32_bf16 v[132:135], v[176:179], a[156:159], v[132:135]
    buffer_load_dwordx4 a[228:231], v67, s[28:31], s86 offen sc1
    v_mfma_f32_16x16x32_bf16 v[152:155], v[176:179], a[160:163], v[152:155]
    ds_read_b128 v[172:175], v56 offset:46592
    s_mov_b32 s86, 45056
    v_mfma_f32_16x16x32_bf16 v[132:135], v[180:183], v[12:15], v[132:135]
    ds_read_b64_tr_b16 a[184:185], v70 offset:20480
    v_mfma_f32_16x16x32_bf16 v[152:155], v[180:183], v[24:27], v[152:155]
    ds_read_b128 v[176:179], v56 offset:49152
    v_mfma_f32_16x16x32_bf16 v[136:139], v[212:215], a[132:135], v[136:139]
    ds_read_b64_tr_b16 v[180:181], v61 offset:176
    v_mfma_f32_16x16x32_bf16 v[156:159], v[212:215], a[136:139], v[156:159]
    ds_read_b64_tr_b16 v[182:183], v62 offset:176
    v_mfma_f32_16x16x32_bf16 v[136:139], v[216:219], a[140:143], v[136:139]
    buffer_load_dwordx4 a[232:235], v67, s[28:31], s86 offen sc1
    v_mfma_f32_16x16x32_bf16 v[156:159], v[216:219], a[144:147], v[156:159]
    s_waitcnt lgkmcnt(5)
    s_mov_b32 s86, 49152
    v_mfma_f32_16x16x32_bf16 v[136:139], v[220:223], a[148:151], v[136:139]
    buffer_load_dwordx4 a[236:239], v67, s[28:31], s86 offen sc1
    v_mfma_f32_16x16x32_bf16 v[156:159], v[220:223], a[152:155], v[156:159]
    ds_read_b64_tr_b16 a[186:187], v70 offset:20992
    s_mov_b32 s86, 53248
    v_mfma_f32_16x16x32_bf16 v[136:139], v[224:227], a[156:159], v[136:139]
    buffer_load_dwordx4 a[240:243], v67, s[28:31], s86 offen sc1
    v_mfma_f32_16x16x32_bf16 v[156:159], v[224:227], a[160:163], v[156:159]
    s_mov_b32 s86, 57344
    v_permlane16_swap_b32 v132, v152
    v_mfma_f32_16x16x32_bf16 v[136:139], v[228:231], v[12:15], v[136:139]
    v_permlane16_swap_b32_e64 v133, v153
    v_mfma_f32_16x16x32_bf16 v[156:159], v[228:231], v[24:27], v[156:159]
    v_permlane16_swap_b32_e64 v134, v154
    v_mfma_f32_16x16x32_bf16 v[140:143], v[232:235], a[132:135], v[140:143]
    buffer_load_dwordx4 a[244:247], v67, s[28:31], s86 offen sc1
    v_mfma_f32_16x16x32_bf16 v[160:163], v[232:235], a[136:139], v[160:163]
    s_mov_b32 s86, 61440
    v_permlane16_swap_b32_e64 v135, v155
    v_mfma_f32_16x16x32_bf16 v[140:143], v[236:239], a[140:143], v[140:143]
    v_max3_f32 v39, v39, v132, v133
    v_min3_f32 v49, v49, v132, v133
    v_mfma_f32_16x16x32_bf16 v[160:163], v[236:239], a[144:147], v[160:163]
    s_waitcnt lgkmcnt(1)
    v_max3_f32 v39, v39, v134, v135
    v_min3_f32 v49, v49, v134, v135
    v_mfma_f32_16x16x32_bf16 v[140:143], v[172:175], a[148:151], v[140:143]
    buffer_load_dwordx4 a[248:251], v67, s[28:31], s86 offen sc1
    v_mfma_f32_16x16x32_bf16 v[160:163], v[172:175], a[152:155], v[160:163]
    v_max3_f32 v39, v39, v152, v153
    v_min3_f32 v49, v49, v152, v153
    v_mfma_f32_16x16x32_bf16 v[140:143], v[176:179], a[156:159], v[140:143]
    v_max3_f32 v39, v39, v154, v155
    v_min3_f32 v49, v49, v154, v155
    v_mfma_f32_16x16x32_bf16 v[160:163], v[176:179], a[160:163], v[160:163]
    s_waitcnt lgkmcnt(0)
    s_barrier
    v_permlane16_swap_b32 v136, v156
    v_mfma_f32_16x16x32_bf16 v[140:143], v[180:183], v[12:15], v[140:143]
    buffer_load_dwordx2 v[44:45], v84, s[28:31], s42 offen sc1
    v_mfma_f32_16x16x32_bf16 v[160:163], v[180:183], v[24:27], v[160:163]
    v_permlane16_swap_b32 v137, v157
    v_permlane16_swap_b32 v138, v158
    v_permlane16_swap_b32_e64 v139, v159
    v_max3_f32 v39, v39, v136, v137
    v_min3_f32 v49, v49, v136, v137
    v_max3_f32 v39, v39, v138, v139
    v_min3_f32 v49, v49, v138, v139
    v_max3_f32 v39, v39, v156, v157
    v_min3_f32 v49, v49, v156, v157
    v_max3_f32 v39, v39, v158, v159
    v_min3_f32 v49, v49, v158, v159
    v_permlane16_swap_b32 v140, v160
    v_permlane16_swap_b32 v141, v161
    v_permlane16_swap_b32 v142, v162
    v_permlane16_swap_b32 v143, v163
    v_max3_f32 v39, v39, v140, v141
    v_min3_f32 v49, v49, v140, v141
    v_max3_f32 v39, v39, v142, v143
    v_min3_f32 v49, v49, v142, v143
    v_mul_f32 v39, v39, v32
    v_mul_f32 v49, v49, v32
    v_pk_fma_f32 v[100:101], v[132:133], v[32:33], v[38:39] op_sel:[0,0,1] op_sel_hi:[1,0,1] neg_lo:[0,0,1] neg_hi:[0,0,1]
    v_pk_fma_f32 v[102:103], v[134:135], v[32:33], v[38:39] op_sel:[0,0,1] op_sel_hi:[1,0,1] neg_lo:[0,0,1] neg_hi:[0,0,1]
    v_pk_fma_f32 v[104:105], v[136:137], v[32:33], v[38:39] op_sel:[0,0,1] op_sel_hi:[1,0,1] neg_lo:[0,0,1] neg_hi:[0,0,1]
    v_pk_fma_f32 v[106:107], v[138:139], v[32:33], v[38:39] op_sel:[0,0,1] op_sel_hi:[1,0,1] neg_lo:[0,0,1] neg_hi:[0,0,1]
    v_pk_fma_f32 v[108:109], v[140:141], v[32:33], v[38:39] op_sel:[0,0,1] op_sel_hi:[1,0,1] neg_lo:[0,0,1] neg_hi:[0,0,1]
    v_pk_fma_f32 v[110:111], v[142:143], v[32:33], v[38:39] op_sel:[0,0,1] op_sel_hi:[1,0,1] neg_lo:[0,0,1] neg_hi:[0,0,1]
    v_pk_fma_f32 v[112:113], v[152:153], v[32:33], v[38:39] op_sel:[0,0,1] op_sel_hi:[1,0,1] neg_lo:[0,0,1] neg_hi:[0,0,1]
    v_pk_fma_f32 v[114:115], v[154:155], v[32:33], v[38:39] op_sel:[0,0,1] op_sel_hi:[1,0,1] neg_lo:[0,0,1] neg_hi:[0,0,1]
    v_pk_fma_f32 v[116:117], v[156:157], v[32:33], v[38:39] op_sel:[0,0,1] op_sel_hi:[1,0,1] neg_lo:[0,0,1] neg_hi:[0,0,1]
    v_pk_fma_f32 v[118:119], v[158:159], v[32:33], v[38:39] op_sel:[0,0,1] op_sel_hi:[1,0,1] neg_lo:[0,0,1] neg_hi:[0,0,1]
    v_exp_f32 v100, v100
    v_exp_f32 v101, v101
    v_exp_f32 v102, v102
    v_exp_f32 v103, v103
    v_exp_f32 v104, v104
    v_exp_f32 v105, v105
    v_pk_add_f32 v[34:35], v[100:101], v[102:103]
    v_exp_f32 v106, v106
    v_exp_f32 v107, v107
    v_pk_add_f32 v[34:35], v[34:35], v[104:105]
    v_exp_f32 v108, v108
    v_exp_f32 v109, v109
    v_pk_add_f32 v[34:35], v[34:35], v[106:107]
    v_exp_f32 v110, v110
    v_exp_f32 v111, v111
    v_pk_add_f32 v[34:35], v[34:35], v[108:109]
    v_exp_f32 v112, v112
    v_exp_f32 v113, v113
    v_pk_add_f32 v[34:35], v[34:35], v[110:111]
    v_exp_f32 v114, v114
    v_exp_f32 v115, v115
    v_pk_add_f32 v[34:35], v[34:35], v[112:113]
    v_exp_f32 v116, v116
    v_exp_f32 v117, v117
    v_pk_add_f32 v[34:35], v[34:35], v[114:115]
    v_exp_f32 v118, v118
    v_exp_f32 v119, v119
    v_pk_add_f32 v[34:35], v[34:35], v[116:117]
    v_pk_fma_f32 v[132:133], v[132:133], v[32:33], v[48:49] op_sel:[0,0,1] op_sel_hi:[1,0,1] neg_lo:[1,0,0] neg_hi:[1,0,0]
    v_pk_add_f32 v[34:35], v[34:35], v[118:119]
    v_pk_fma_f32 v[134:135], v[134:135], v[32:33], v[48:49] op_sel:[0,0,1] op_sel_hi:[1,0,1] neg_lo:[1,0,0] neg_hi:[1,0,0]
    v_add_f32_e64 v34, v34, v35
    v_pk_fma_f32 v[136:137], v[136:137], v[32:33], v[48:49] op_sel:[0,0,1] op_sel_hi:[1,0,1] neg_lo:[1,0,0] neg_hi:[1,0,0]
    v_pk_fma_f32 v[138:139], v[138:139], v[32:33], v[48:49] op_sel:[0,0,1] op_sel_hi:[1,0,1] neg_lo:[1,0,0] neg_hi:[1,0,0]
    v_pk_fma_f32 v[140:141], v[140:141], v[32:33], v[48:49] op_sel:[0,0,1] op_sel_hi:[1,0,1] neg_lo:[1,0,0] neg_hi:[1,0,0]
    v_pk_fma_f32 v[142:143], v[142:143], v[32:33], v[48:49] op_sel:[0,0,1] op_sel_hi:[1,0,1] neg_lo:[1,0,0] neg_hi:[1,0,0]
    v_pk_fma_f32 v[152:153], v[152:153], v[32:33], v[48:49] op_sel:[0,0,1] op_sel_hi:[1,0,1] neg_lo:[1,0,0] neg_hi:[1,0,0]
    v_pk_fma_f32 v[154:155], v[154:155], v[32:33], v[48:49] op_sel:[0,0,1] op_sel_hi:[1,0,1] neg_lo:[1,0,0] neg_hi:[1,0,0]
    v_pk_fma_f32 v[156:157], v[156:157], v[32:33], v[48:49] op_sel:[0,0,1] op_sel_hi:[1,0,1] neg_lo:[1,0,0] neg_hi:[1,0,0]
    v_pk_fma_f32 v[158:159], v[158:159], v[32:33], v[48:49] op_sel:[0,0,1] op_sel_hi:[1,0,1] neg_lo:[1,0,0] neg_hi:[1,0,0]
    v_cvt_pk_bf16_f32 v12, v100, v101
    v_cvt_pk_bf16_f32 v13, v102, v103
    v_cvt_pk_bf16_f32 v16, v104, v105
    v_cvt_pk_bf16_f32 v17, v106, v107
    v_cvt_pk_bf16_f32 v20, v108, v109
    v_cvt_pk_bf16_f32 v21, v110, v111
    v_cvt_pk_bf16_f32 v24, v112, v113
    v_cvt_pk_bf16_f32 v25, v114, v115
    v_cvt_pk_bf16_f32 v14, v116, v117
    v_cvt_pk_bf16_f32 v15, v118, v119
    v_exp_f32 v132, v132
    v_exp_f32 v133, v133
    v_exp_f32 v134, v134
    v_exp_f32 v135, v135
    v_exp_f32 v136, v136
    v_exp_f32 v137, v137
    v_exp_f32 v138, v138
    v_exp_f32 v139, v139
    v_exp_f32 v140, v140
    v_exp_f32_e64 v141, v141
    s_waitcnt vmcnt(13)
    v_accvgpr_mov_b32 a252, a188
    v_accvgpr_mov_b32 a253, a189
    v_mfma_f32_16x16x32_bf16 v[96:99], a[0:3], a[190:193], 0
    v_exp_f32_e64 v142, v142
    v_mfma_f32_16x16x32_bf16 v[56:59], a[0:3], a[194:197], 0
    v_exp_f32_e64 v143, v143
    v_mfma_f32_16x16x32_bf16 v[96:99], a[0:3], a[198:201], v[96:99]
    v_exp_f32_e64 v152, v152
    v_mfma_f32_16x16x32_bf16 v[56:59], a[0:3], a[202:205], v[56:59]
    v_exp_f32 v153, v153
    s_waitcnt vmcnt(8)
    v_mfma_f32_16x16x32_bf16 v[96:99], a[0:3], a[206:209], v[96:99]
    v_exp_f32_e64 v154, v154
    v_mfma_f32_16x16x32_bf16 v[56:59], a[0:3], a[210:213], v[56:59]
    v_exp_f32_e64 v155, v155
    v_mfma_f32_16x16x32_bf16 v[96:99], a[0:3], a[214:217], v[96:99]
    v_exp_f32_e64 v156, v156
    v_mfma_f32_16x16x32_bf16 v[56:59], a[0:3], a[218:221], v[56:59]
    v_exp_f32 v157, v157
    v_exp_f32 v158, v158
    v_exp_f32_e64 v159, v159
    v_pk_add_f32 v[36:37], v[132:133], v[134:135]
    v_pk_add_f32 v[36:37], v[36:37], v[136:137]
    v_pk_add_f32 v[36:37], v[36:37], v[138:139]
    v_pk_add_f32 v[36:37], v[36:37], v[140:141]
    v_pk_add_f32 v[36:37], v[36:37], v[142:143]
    v_pk_add_f32 v[36:37], v[36:37], v[152:153]
    v_pk_add_f32 v[36:37], v[36:37], v[154:155]
    v_pk_add_f32 v[36:37], v[36:37], v[156:157]
    v_mul_f32 v38, 0x358637bd, v34
    v_pk_add_f32 v[36:37], v[36:37], v[158:159]
    v_add_f32 v36, v36, v37
    v_rcp_f32 v36, v36
    s_nop 0
    v_mul_f32 v36, v36, v34
    v_pk_mul_f32 v[132:133], v[132:133], v[36:37] op_sel_hi:[1,0]
    v_cvt_pk_bf16_f32 v18, v132, v133
    v_pk_mul_f32 v[134:135], v[134:135], v[36:37] op_sel_hi:[1,0]
    v_cvt_pk_bf16_f32 v19, v134, v135
    v_pk_mul_f32 v[136:137], v[136:137], v[36:37] op_sel_hi:[1,0]
    v_cvt_pk_bf16_f32 v22, v136, v137
    v_pk_mul_f32 v[138:139], v[138:139], v[36:37] op_sel_hi:[1,0]
    v_cvt_pk_bf16_f32 v23, v138, v139
    v_pk_mul_f32 v[140:141], v[140:141], v[36:37] op_sel_hi:[1,0]
    v_cvt_pk_bf16_f32 v26, v140, v141
    v_pk_mul_f32 v[142:143], v[142:143], v[36:37] op_sel_hi:[1,0]
    v_cvt_pk_bf16_f32 v27, v142, v143
    v_pk_mul_f32 v[152:153], v[152:153], v[36:37] op_sel_hi:[1,0]
    v_cvt_pk_bf16_f32 v28, v152, v153
    v_pk_mul_f32 v[154:155], v[154:155], v[36:37] op_sel_hi:[1,0]
    v_cvt_pk_bf16_f32 v29, v154, v155
    v_pk_mul_f32 v[156:157], v[156:157], v[36:37] op_sel_hi:[1,0]
    v_cvt_pk_bf16_f32 v30, v156, v157
    v_pk_mul_f32 v[158:159], v[158:159], v[36:37] op_sel_hi:[1,0]
    v_cvt_pk_bf16_f32 v31, v158, v159
    s_waitcnt vmcnt(4)
    v_mfma_f32_16x16x32_bf16 v[96:99], a[0:3], a[222:225], v[96:99]
    s_xor_b32 s86, s39, 0
    s_mul_i32 s86, s86, 5
    s_add_u32 s86, s86, s66
    v_mfma_f32_16x16x32_bf16 v[56:59], a[0:3], a[226:229], v[56:59]
    s_add_u32 m0, s45, 0
    v_mfma_f32_16x16x32_bf16 v[96:99], a[0:3], a[230:233], v[96:99]
    buffer_load_dwordx4 v2, s[28:31], s86 offen offset:0 sc1 lds
    v_mfma_f32_16x16x32_bf16 v[56:59], a[0:3], a[234:237], v[56:59]
    s_waitcnt vmcnt(2)
    v_mfma_f32_16x16x32_bf16 v[96:99], a[0:3], a[238:241], v[96:99]
    buffer_load_dwordx4 v2, s[28:31], s86 offen offset:1024 sc1 lds
    v_mfma_f32_16x16x32_bf16 v[56:59], a[0:3], a[242:245], v[56:59]
    v_mfma_f32_16x16x32_bf16 v[96:99], a[0:3], a[246:249], v[96:99]
    buffer_load_dwordx4 v2, s[28:31], s86 offen offset:2048 sc1 lds
    v_mfma_f32_16x16x32_bf16 v[56:59], a[0:3], a[250:253], v[56:59]
    buffer_load_dwordx4 v2, s[28:31], s86 offen offset:3072 sc1 lds
    s_add_u32 m0, s45, 4096
    s_nop 0
    buffer_load_dwordx4 v63, s[28:31], s86 offen sc1 lds
    s_waitcnt vmcnt(5)
    v_cmp_ne_u64 s[8:9], v[10:11], v[44:45]
    s_nop 0
    s_cmp_lg_u64 s[8:9], 0
    s_cbranch_scc1 L_f3spin_10
L_f3ok_11:
    buffer_load_dwordx4 v[48:51], v71, s[28:31], 0 offen sc1
    s_mov_b32 s90, 4096
    buffer_load_dwordx4 v[100:103], v71, s[28:31], s90 offen sc1
    v_cmp_u_f32_e64 vcc, v96, v56
    s_cbranch_vccnz L_gredo_13
L_gok_14:
    v_cvt_pk_bf16_f32 v40, v56, v57
    v_cvt_pk_bf16_f32 v41, v58, v59
    v_cvt_pk_bf16_f32 v42, v96, v97
    v_cvt_pk_bf16_f32 v43, v98, v99
    ds_write_b128 v66, v[40:43]
    s_mov_b32 s90, 8192
    buffer_load_dwordx4 v[104:107], v90, s[28:31], s90 offen sc1
    s_waitcnt lgkmcnt(0)
    s_barrier
    ds_read_b128 v[120:123], v78 offset:0
    ds_read_b128 v[124:127], v78 offset:16
    ds_read_b128 v[128:131], v78 offset:32
    ds_read_b128 v[132:135], v78 offset:48
    ds_read_b128 v[136:139], v78 offset:64
    ds_read_b128 v[56:59], v77 offset:0
    ds_read_b128 v[96:99], v77 offset:16
    ds_read_b128 v[108:111], v77 offset:32
    ds_read_b128 v[112:115], v77 offset:48
    ds_read_b128 v[116:119], v77 offset:64
    s_waitcnt lgkmcnt(8)
    v_mfma_f32_32x32x16_bf16 v[156:171], v[120:123], v[12:15], 0
    s_mov_b32 m0, s72
    s_nop 0
    buffer_load_dwordx4 v79, s[4:7], s71 offen offset:0 lds
    v_mfma_f32_32x32x16_bf16 v[156:171], v[124:127], v[16:19], v[156:171]
    s_waitcnt lgkmcnt(0)
    buffer_load_dwordx4 v80, s[4:7], s71 offen offset:1024 lds
    v_mfma_f32_32x32x16_bf16 v[156:171], v[128:131], v[20:23], v[156:171]
    buffer_load_dwordx4 v81, s[4:7], s71 offen offset:2048 lds
    v_mfma_f32_32x32x16_bf16 v[156:171], v[132:135], v[24:27], v[156:171]
    v_mfma_f32_32x32x16_bf16 v[156:171], v[136:139], v[28:31], v[156:171]
    v_mfma_f32_32x32x16_bf16 v[140:155], v[56:59], v[12:15], 0
    v_mfma_f32_32x32x16_bf16 v[140:155], v[96:99], v[16:19], v[140:155]
    v_mfma_f32_32x32x16_bf16 v[140:155], v[108:111], v[20:23], v[140:155]
    v_mfma_f32_32x32x16_bf16 v[140:155], v[112:115], v[24:27], v[140:155]
    v_mfma_f32_32x32x16_bf16 v[140:155], v[116:119], v[28:31], v[140:155]
    s_nop 6
    v_add_f32 v54, v38, v160
    v_rcp_f32 v54, v54
    s_nop 0
    v_mul_f32 v156, v156, v54
    v_mul_f32 v157, v157, v54
    v_mul_f32 v158, v158, v54
    v_mul_f32 v159, v159, v54
    v_cvt_pk_bf16_f32 v180, v156, v157
    v_cvt_pk_bf16_f32 v181, v158, v159
    s_nop 0
    v_permlane32_swap_b32 v180, v182
    v_permlane32_swap_b32_e64 v181, v183
    v_pk_mul_f32 v[140:141], v[140:141], v[54:55] op_sel_hi:[1,0]
    v_cvt_pk_bf16_f32 v172, v140, v141
    v_pk_mul_f32 v[142:143], v[142:143], v[54:55] op_sel_hi:[1,0]
    v_cvt_pk_bf16_f32 v173, v142, v143
    v_pk_mul_f32 v[148:149], v[148:149], v[54:55] op_sel_hi:[1,0]
    v_cvt_pk_bf16_f32 v174, v148, v149
    v_pk_mul_f32 v[150:151], v[150:151], v[54:55] op_sel_hi:[1,0]
    v_cvt_pk_bf16_f32 v175, v150, v151
    buffer_store_dwordx4 v[172:175], v87, s[28:31], s64 offen sc1
    v_pk_mul_f32 v[144:145], v[144:145], v[54:55] op_sel_hi:[1,0]
    v_cvt_pk_bf16_f32 v176, v144, v145
    v_pk_mul_f32 v[146:147], v[146:147], v[54:55] op_sel_hi:[1,0]
    v_cvt_pk_bf16_f32 v177, v146, v147
    v_pk_mul_f32 v[152:153], v[152:153], v[54:55] op_sel_hi:[1,0]
    v_cvt_pk_bf16_f32 v178, v152, v153
    v_pk_mul_f32 v[154:155], v[154:155], v[54:55] op_sel_hi:[1,0]
    v_cvt_pk_bf16_f32 v179, v154, v155
    buffer_store_dwordx4 v[176:179], v87, s[28:31], s64 offen offset:256 sc1
    buffer_store_dwordx4 v[180:183], v88, s[28:31], s65 offen sc1
    buffer_load_dword v52, v52, s[24:27], s60 offen
    s_xor_b32 s86, s39, 4096
    s_mul_i32 s86, s86, 5
    s_add_u32 s86, s86, s66
    s_add_u32 m0, s45, 20480
    s_nop 0
    buffer_load_dwordx4 v2, s[28:31], s86 offen offset:0 sc1 lds
    buffer_load_dwordx4 v2, s[28:31], s86 offen offset:1024 sc1 lds
    buffer_load_dwordx4 v2, s[28:31], s86 offen offset:2048 sc1 lds
    buffer_load_dwordx4 v2, s[28:31], s86 offen offset:3072 sc1 lds
    s_add_u32 m0, s45, 24576
    s_nop 0
    buffer_load_dwordx4 v63, s[28:31], s86 offen sc1 lds
    v_add_u32 v37, 51200, v2
    s_waitcnt vmcnt(12)
    v_pk_add_f32 v[48:49], v[48:49], v[100:101]
    v_pk_add_f32 v[50:51], v[50:51], v[102:103]
    v_pk_add_f32 v[48:49], v[48:49], v[104:105]
    v_pk_add_f32 v[50:51], v[50:51], v[106:107]
    s_nop 0
    v_permlane16_swap_b32 v48, v49
    v_permlane16_swap_b32 v50, v51
    v_add_f32 v48, v48, v49
    v_add_f32 v50, v50, v51
    s_nop 1
    v_permlane32_swap_b32 v48, v50
    v_add_f32 v48, v48, v50
    v_cmp_u_f32_e64 vcc, v48, v48
    s_cbranch_vccnz L_predo_16
L_pok_17:
    v_mul_f32 v100, 0xbfb8aa3b, v48
    v_exp_f32_e64 v100, v100
    v_mul_f32_dpp v101, v48, v48 quad_perm:[2,3,0,1] row_mask:0xf bank_mask:0xf
    v_add_f32 v100, 1.0, v100
    v_rcp_f32 v100, v100
    v_lshl_add_u32 v5, v3, 2, s79
    v_mul_f32_e64 v100, v100, v101
    v_cvt_pk_bf16_f32 v100, v100, v100
    ds_read_b32 v33, v5
    ds_write_b16 v91, v100
    s_waitcnt vmcnt(9)
    ds_read_b64 v[108:109], v72 offset:0
    ds_read_b64 v[110:111], v72 offset:8
    ds_read_b64 v[112:113], v72 offset:16
    ds_read_b64 v[114:115], v72 offset:24
    ds_read_b64 v[116:117], v72 offset:32
    s_waitcnt lgkmcnt(5)
    s_barrier
    ds_read_b128 v[172:175], v92 offset:0
    ds_read_b128 v[176:179], v92 offset:64
    v_and_b32 v6, 0xffff0000, v33
    v_rcp_f32 v38, v6
    v_lshlrev_b32 v5, 16, v33
    v_mul_f32 v39, v5, v38
    v_add_f32_e64 v38, 1.0, v38
    s_add_u32 s91, s59, 61440
    s_waitcnt lgkmcnt(0)
    v_mfma_f32_16x16x32_bf16 v[104:107], v[172:175], a[180:183], 0
    v_mfma_f32_16x16x32_bf16 v[104:107], v[176:179], a[184:187], v[104:107]
    ds_read_b128 a[0:3], v2 offset:40960
    ds_read_b128 a[4:7], v2 offset:41984
    ds_read_b128 a[8:11], v2 offset:43008
    ds_read_b128 a[12:15], v2 offset:44032
    ds_read_b128 a[16:19], v2 offset:45056
    ds_read_b128 a[20:23], v2 offset:46080
    ds_read_b128 a[24:27], v2 offset:47104
    ds_read_b128 a[28:31], v2 offset:48128
    ds_read_b128 a[32:35], v2 offset:49152
    ds_read_b128 a[36:39], v2 offset:50176
    buffer_store_dword v104, v82, s[28:31], s59 offen sc1
    buffer_store_dword v105, v82, s[28:31], s91 offen sc1
    v_lshlrev_b32 v12, 16, v108
    v_and_b32 v13, 0xffff0000, v108
    v_pk_fma_f32 v[12:13], v[12:13], v[38:39], v[38:39] op_sel:[0,0,1] op_sel_hi:[1,0,1] neg_lo:[0,0,1] neg_hi:[0,0,1]
    v_lshlrev_b32_e64 v14, 16, v109
    v_and_b32 v15, 0xffff0000, v109
    v_pk_fma_f32 v[14:15], v[14:15], v[38:39], v[38:39] op_sel:[0,0,1] op_sel_hi:[1,0,1] neg_lo:[0,0,1] neg_hi:[0,0,1]
    v_lshlrev_b32_e64 v16, 16, v110
    v_and_b32 v17, 0xffff0000, v110
    v_pk_fma_f32 v[16:17], v[16:17], v[38:39], v[38:39] op_sel:[0,0,1] op_sel_hi:[1,0,1] neg_lo:[0,0,1] neg_hi:[0,0,1]
    v_lshlrev_b32_e64 v18, 16, v111
    v_and_b32 v19, 0xffff0000, v111
    v_pk_fma_f32 v[18:19], v[18:19], v[38:39], v[38:39] op_sel:[0,0,1] op_sel_hi:[1,0,1] neg_lo:[0,0,1] neg_hi:[0,0,1]
    v_lshlrev_b32_e64 v20, 16, v112
    v_and_b32 v21, 0xffff0000, v112
    v_pk_fma_f32 v[20:21], v[20:21], v[38:39], v[38:39] op_sel:[0,0,1] op_sel_hi:[1,0,1] neg_lo:[0,0,1] neg_hi:[0,0,1]
    v_lshlrev_b32_e64 v22, 16, v113
    v_and_b32 v23, 0xffff0000, v113
    v_pk_fma_f32 v[22:23], v[22:23], v[38:39], v[38:39] op_sel:[0,0,1] op_sel_hi:[1,0,1] neg_lo:[0,0,1] neg_hi:[0,0,1]
    v_lshlrev_b32_e64 v24, 16, v114
    v_and_b32 v25, 0xffff0000, v114
    v_pk_fma_f32 v[24:25], v[24:25], v[38:39], v[38:39] op_sel:[0,0,1] op_sel_hi:[1,0,1] neg_lo:[0,0,1] neg_hi:[0,0,1]
    v_lshlrev_b32_e64 v26, 16, v115
    v_and_b32 v27, 0xffff0000, v115
    v_pk_fma_f32 v[26:27], v[26:27], v[38:39], v[38:39] op_sel:[0,0,1] op_sel_hi:[1,0,1] neg_lo:[0,0,1] neg_hi:[0,0,1]
    v_lshlrev_b32_e64 v28, 16, v116
    v_and_b32 v29, 0xffff0000, v116
    v_pk_fma_f32 v[28:29], v[28:29], v[38:39], v[38:39] op_sel:[0,0,1] op_sel_hi:[1,0,1] neg_lo:[0,0,1] neg_hi:[0,0,1]
    v_lshlrev_b32_e64 v30, 16, v117
    v_and_b32 v31, 0xffff0000, v117
    v_pk_fma_f32 v[30:31], v[30:31], v[38:39], v[38:39] op_sel:[0,0,1] op_sel_hi:[1,0,1] neg_lo:[0,0,1] neg_hi:[0,0,1]
    v_mul_u32_u24 v47, 176, v3
    v_mad_u32_u24 v47, v4, 40, v47
    v_mul_u32_u24 v53, 6554, v1
    v_lshrrev_b32 v53, 16, v53
    v_add_u32 v53, v53, v1
    v_add_u32_e64 v47, s72, v47
    v_lshl_add_u32 v53, v53, 4, s72
    s_xor_b32 s90, s39, 8192
    s_add_u32 s90, s90, s73
    buffer_load_dwordx4 v[136:139], v2, s[28:31], s90 offen offset:0 sc1
    buffer_load_dwordx4 v[140:143], v2, s[28:31], s90 offen offset:1024 sc1
    buffer_load_dwordx4 v[144:147], v2, s[28:31], s90 offen offset:2048 sc1
    buffer_load_dwordx4 v[148:151], v2, s[28:31], s90 offen offset:3072 sc1
    s_xor_b32 s90, s39, 12288
    s_add_u32 s90, s90, s73
    buffer_load_dwordx4 v[152:155], v2, s[28:31], s90 offen offset:0 sc1
    buffer_load_dwordx4 v[156:159], v2, s[28:31], s90 offen offset:1024 sc1
    buffer_load_dwordx4 v[160:163], v2, s[28:31], s90 offen offset:2048 sc1
    buffer_load_dwordx4 v[164:167], v2, s[28:31], s90 offen offset:3072 sc1
    s_xor_b32 s90, s40, 16384
    s_add_u32 s90, s90, s73
    buffer_load_dwordx4 v[168:171], v2, s[28:31], s90 offen offset:0 sc1
    buffer_load_dwordx4 v[184:187], v2, s[28:31], s90 offen offset:1024 sc1
    ds_read_b128 a[40:43], v37 offset:0
    ds_read_b128 a[44:47], v37 offset:1024
    ds_read_b128 a[48:51], v37 offset:2048
    ds_read_b128 a[52:55], v37 offset:3072
    ds_read_b128 a[56:59], v37 offset:4096
    ds_read_b128 a[60:63], v37 offset:5120
    ds_read_b128 a[64:67], v37 offset:6144
    ds_read_b128 a[68:71], v37 offset:7168
    ds_read_b128 a[72:75], v37 offset:8192
    ds_read_b128 a[76:79], v37 offset:9216
    ds_read_b128 a[80:83], v37 offset:10240
    ds_read_b128 a[84:87], v37 offset:11264
    ds_read_b128 a[88:91], v37 offset:12288
    ds_read_b128 a[92:95], v37 offset:13312
    ds_read_b128 a[96:99], v37 offset:14336
    ds_read_b128 a[100:103], v37 offset:15360
    ds_read_b128 a[104:107], v37 offset:16384
    ds_read_b128 a[108:111], v37 offset:17408
    ds_read_b128 a[112:115], v37 offset:18432
    ds_read_b128 a[116:119], v37 offset:19456
    s_waitcnt vmcnt(9)
    v_cmp_eq_u32_e64 vcc, -1, v139
    s_waitcnt lgkmcnt(15)
    s_cbranch_vccnz L_fsp_19
L_fok_20:
    v_mfma_f32_16x16x32_bf16 v[12:15], a[0:3], v[136:139], v[12:15]
    ds_read_b128 a[120:123], v37 offset:20480
    s_xor_b32 s90, s40, 18432
    v_mfma_f32_16x16x32_bf16 v[16:19], a[4:7], v[136:139], v[16:19]
    ds_read_b128 a[124:127], v37 offset:21504
    s_add_u32 s90, s90, s73
    v_mfma_f32_16x16x32_bf16 v[20:23], a[8:11], v[136:139], v[20:23]
    s_waitcnt vmcnt(7)
    v_max_u32 v5, v143, v147
    v_cmp_eq_u32 vcc, -1, v5
    v_mfma_f32_16x16x32_bf16 v[24:27], a[12:15], v[136:139], v[24:27]
    buffer_load_dwordx4 v[188:191], v2, s[28:31], s90 offen offset:0 sc1
    v_mfma_f32_16x16x32_bf16 v[28:31], a[16:19], v[136:139], v[28:31]
    s_cbranch_vccnz L_fsp_23
L_fok_24:
    s_waitcnt lgkmcnt(15)
    v_mfma_f32_16x16x32_bf16 v[12:15], a[20:23], v[140:143], v[12:15]
    buffer_load_dwordx4 v[192:195], v2, s[28:31], s90 offen offset:1024 sc1
    v_mfma_f32_16x16x32_bf16 v[16:19], a[24:27], v[140:143], v[16:19]
    ds_read_b128 a[128:131], v37 offset:22528
    s_xor_b32 s90, s39, 0
    v_mfma_f32_16x16x32_bf16 v[20:23], a[28:31], v[140:143], v[20:23]
    ds_read_b128 a[132:135], v37 offset:23552
    s_add_u32 s90, s90, s73
    v_mfma_f32_16x16x32_bf16 v[24:27], a[32:35], v[140:143], v[24:27]
    buffer_load_dwordx4 v[40:43], v2, s[28:31], s90 offen offset:0 sc1
    v_mfma_f32_16x16x32_bf16 v[28:31], a[36:39], v[140:143], v[28:31]
    s_waitcnt lgkmcnt(15)
    ds_read_b128 a[136:139], v37 offset:24576
    s_barrier
    v_mfma_f32_16x16x32_bf16 v[12:15], a[40:43], v[144:147], v[12:15]
    buffer_load_dwordx4 v[56:59], v2, s[28:31], s90 offen offset:1024 sc1
    v_mfma_f32_16x16x32_bf16 v[16:19], a[44:47], v[144:147], v[16:19]
    ds_read_b128 a[140:143], v37 offset:25600
    v_mfma_f32_16x16x32_bf16 v[20:23], a[48:51], v[144:147], v[20:23]
    s_waitcnt vmcnt(8)
    v_max3_u32 v5, v151, v155, v159
    v_cmp_eq_u32 vcc, -1, v5
    v_mfma_f32_16x16x32_bf16 v[24:27], a[52:55], v[144:147], v[24:27]
    buffer_load_dwordx4 v[64:67], v2, s[28:31], s90 offen offset:2048 sc1
    v_mfma_f32_16x16x32_bf16 v[28:31], a[56:59], v[144:147], v[28:31]
    s_cbranch_vccnz L_fsp_26
L_fok_27:
    s_waitcnt lgkmcnt(15)
    v_mfma_f32_16x16x32_bf16 v[12:15], a[60:63], v[148:151], v[12:15]
    buffer_load_dwordx4 v[96:99], v2, s[28:31], s90 offen offset:3072 sc1
    v_mfma_f32_16x16x32_bf16 v[16:19], a[64:67], v[148:151], v[16:19]
    ds_read_b128 a[144:147], v37 offset:26624
    s_xor_b32 s90, s39, 4096
    v_mfma_f32_16x16x32_bf16 v[20:23], a[68:71], v[148:151], v[20:23]
    ds_read_b128 a[148:151], v37 offset:27648
    s_add_u32 s90, s90, s73
    v_mfma_f32_16x16x32_bf16 v[24:27], a[72:75], v[148:151], v[24:27]
    buffer_load_dwordx4 v[120:123], v2, s[28:31], s90 offen offset:0 sc1
    v_mfma_f32_16x16x32_bf16 v[28:31], a[76:79], v[148:151], v[28:31]
    s_waitcnt lgkmcnt(13)
    ds_read_b128 a[152:155], v37 offset:28672
    v_mfma_f32_16x16x32_bf16 v[12:15], a[80:83], v[152:155], v[12:15]
    buffer_load_dwordx4 v[124:127], v2, s[28:31], s90 offen offset:1024 sc1
    v_mfma_f32_16x16x32_bf16 v[16:19], a[84:87], v[152:155], v[16:19]
    ds_read_b128 a[156:159], v37 offset:29696
    v_mfma_f32_16x16x32_bf16 v[20:23], a[88:91], v[152:155], v[20:23]
    buffer_load_dwordx4 v[128:131], v2, s[28:31], s90 offen offset:2048 sc1
    v_mfma_f32_16x16x32_bf16 v[24:27], a[92:95], v[152:155], v[24:27]
    ds_read_b128 a[160:163], v37 offset:30720
    v_mfma_f32_16x16x32_bf16 v[28:31], a[96:99], v[152:155], v[28:31]
    s_waitcnt lgkmcnt(11)
    ds_read_b128 a[164:167], v37 offset:31744
    v_mfma_f32_16x16x32_bf16 v[12:15], a[100:103], v[156:159], v[12:15]
    buffer_load_dwordx4 v[132:135], v2, s[28:31], s90 offen offset:3072 sc1
    v_mfma_f32_16x16x32_bf16 v[16:19], a[104:107], v[156:159], v[16:19]
    ds_read_b128 a[168:171], v37 offset:32768
    v_mfma_f32_16x16x32_bf16 v[20:23], a[108:111], v[156:159], v[20:23]
    s_waitcnt vmcnt(11)
    v_max3_u32 v5, v163, v167, v171
    v_cmp_eq_u32_e64 vcc, -1, v5
    v_mfma_f32_16x16x32_bf16 v[24:27], a[112:115], v[156:159], v[24:27]
    ds_read_b128 a[172:175], v37 offset:33792
    v_mfma_f32_16x16x32_bf16 v[28:31], a[116:119], v[156:159], v[28:31]
    s_cbranch_vccnz L_fsp_29
L_fok_30:
    s_waitcnt lgkmcnt(9)
    v_mfma_f32_16x16x32_bf16 v[12:15], a[120:123], v[160:163], v[12:15]
    ds_read_b128 a[176:179], v37 offset:34816
    v_mfma_f32_16x16x32_bf16 v[16:19], a[124:127], v[160:163], v[16:19]
    ds_read_b128 a[188:191], v37 offset:35840
    v_mfma_f32_16x16x32_bf16 v[20:23], a[128:131], v[160:163], v[20:23]
    ds_read_b128 a[192:195], v37 offset:36864
    v_mfma_f32_16x16x32_bf16 v[24:27], a[132:135], v[160:163], v[24:27]
    ds_read_b128 a[196:199], v37 offset:37888
    v_mfma_f32_16x16x32_bf16 v[28:31], a[136:139], v[160:163], v[28:31]
    s_waitcnt lgkmcnt(8)
    ds_read_b128 a[200:203], v37 offset:38912
    v_mfma_f32_16x16x32_bf16 v[12:15], a[140:143], v[164:167], v[12:15]
    ds_read_b128 a[204:207], v37 offset:39936
    v_mfma_f32_16x16x32_bf16 v[16:19], a[144:147], v[164:167], v[16:19]
    ds_read_b128 a[208:211], v37 offset:40960
    v_mfma_f32_16x16x32_bf16 v[20:23], a[148:151], v[164:167], v[20:23]
    ds_read_b128 a[212:215], v37 offset:41984
    v_mfma_f32_16x16x32_bf16 v[24:27], a[152:155], v[164:167], v[24:27]
    ds_read_b128 a[216:219], v37 offset:43008
    v_mfma_f32_16x16x32_bf16 v[28:31], a[156:159], v[164:167], v[28:31]
    s_waitcnt lgkmcnt(8)
    ds_read_b128 a[220:223], v37 offset:44032
    v_mfma_f32_16x16x32_bf16 v[12:15], a[160:163], v[168:171], v[12:15]
    ds_read_b128 a[224:227], v37 offset:45056
    v_mfma_f32_16x16x32_bf16 v[16:19], a[164:167], v[168:171], v[16:19]
    ds_read_b128 a[228:231], v37 offset:46080
    v_mfma_f32_16x16x32_bf16 v[20:23], a[168:171], v[168:171], v[20:23]
    s_waitcnt vmcnt(8)
    v_max3_u32 v5, v187, v191, v195
    v_cmp_eq_u32 vcc, -1, v5
    v_mfma_f32_16x16x32_bf16 v[24:27], a[172:175], v[168:171], v[24:27]
    ds_read_b128 a[232:235], v37 offset:47104
    v_mfma_f32_16x16x32_bf16 v[28:31], a[176:179], v[168:171], v[28:31]
    s_cbranch_vccnz L_fsp_32
L_fok_33:
    s_waitcnt lgkmcnt(7)
    v_mfma_f32_16x16x32_bf16 v[12:15], a[188:191], v[184:187], v[12:15]
    ds_read_b128 a[236:239], v37 offset:48128
    v_mfma_f32_16x16x32_bf16 v[16:19], a[192:195], v[184:187], v[16:19]
    ds_read_b128 a[240:243], v37 offset:49152
    v_mfma_f32_16x16x32_bf16 v[20:23], a[196:199], v[184:187], v[20:23]
    ds_read_b128 a[244:247], v37 offset:50176
    v_mfma_f32_16x16x32_bf16 v[24:27], a[200:203], v[184:187], v[24:27]
    ds_read_b128 a[0:3], v2 offset:0
    v_mfma_f32_16x16x32_bf16 v[28:31], a[204:207], v[184:187], v[28:31]
    s_waitcnt lgkmcnt(6)
    ds_read_b128 a[4:7], v2 offset:1024
    v_mfma_f32_16x16x32_bf16 v[12:15], a[208:211], v[188:191], v[12:15]
    ds_read_b128 a[8:11], v2 offset:2048
    v_mfma_f32_16x16x32_bf16 v[16:19], a[212:215], v[188:191], v[16:19]
    ds_read_b128 a[12:15], v2 offset:3072
    v_mfma_f32_16x16x32_bf16 v[20:23], a[216:219], v[188:191], v[20:23]
    ds_read_b128 a[16:19], v2 offset:4096
    v_mfma_f32_16x16x32_bf16 v[24:27], a[220:223], v[188:191], v[24:27]
    ds_read_b128 a[20:23], v2 offset:5120
    v_mfma_f32_16x16x32_bf16 v[28:31], a[224:227], v[188:191], v[28:31]
    s_waitcnt lgkmcnt(6)
    ds_read_b128 a[24:27], v2 offset:6144
    v_mfma_f32_16x16x32_bf16 v[12:15], a[228:231], v[192:195], v[12:15]
    ds_read_b128 a[28:31], v2 offset:7168
    v_mfma_f32_16x16x32_bf16 v[16:19], a[232:235], v[192:195], v[16:19]
    ds_read_b128 a[32:35], v2 offset:8192
    v_mfma_f32_16x16x32_bf16 v[20:23], a[236:239], v[192:195], v[20:23]
    s_waitcnt vmcnt(0)
    v_max3_u32 v5, v43, v59, v67
    v_max_u32 v5, v5, v99
    v_cmp_eq_u32_e64 vcc, -1, v5
    v_mfma_f32_16x16x32_bf16 v[24:27], a[240:243], v[192:195], v[24:27]
    ds_read_b128 a[36:39], v2 offset:9216
    v_mfma_f32_16x16x32_bf16 v[28:31], a[244:247], v[192:195], v[28:31]
    s_cbranch_vccnz L_fsp_36
L_fok_37:
    s_waitcnt lgkmcnt(5)
    s_lshr_b32 s87, s35, 4
    s_cmp_eq_u32 s87, s70
    s_cbranch_scc1 L_yl_39
L_yldone_40:
    s_lshr_b32 s88, s67, 4
    s_cmp_eq_u32 s88, s70
    s_cbranch_scc1 L_yl_41
L_yldone_42:
    v_mfma_f32_16x16x32_bf16 v[12:15], a[0:3], v[40:43], v[12:15]
    ds_read_b128 a[40:43], v2 offset:10240
    v_mfma_f32_16x16x32_bf16 v[16:19], a[4:7], v[40:43], v[16:19]
    ds_read_b128 a[44:47], v2 offset:11264
    v_mfma_f32_16x16x32_bf16 v[20:23], a[8:11], v[40:43], v[20:23]
    ds_read_b128 a[48:51], v2 offset:12288
    v_mfma_f32_16x16x32_bf16 v[24:27], a[12:15], v[40:43], v[24:27]
    ds_read_b128 a[52:55], v2 offset:13312
    v_mfma_f32_16x16x32_bf16 v[28:31], a[16:19], v[40:43], v[28:31]
    s_waitcnt lgkmcnt(4)
    ds_read_b128 a[56:59], v2 offset:14336
    v_mfma_f32_16x16x32_bf16 v[12:15], a[20:23], v[56:59], v[12:15]
    ds_read_b128 a[60:63], v2 offset:15360
    v_mfma_f32_16x16x32_bf16 v[16:19], a[24:27], v[56:59], v[16:19]
    ds_read_b128 a[64:67], v2 offset:16384
    v_mfma_f32_16x16x32_bf16 v[20:23], a[28:31], v[56:59], v[20:23]
    ds_read_b128 a[68:71], v2 offset:17408
    v_mfma_f32_16x16x32_bf16 v[24:27], a[32:35], v[56:59], v[24:27]
    ds_read_b128 a[72:75], v2 offset:18432
    v_mfma_f32_16x16x32_bf16 v[28:31], a[36:39], v[56:59], v[28:31]
    s_waitcnt lgkmcnt(4)
    ds_read_b128 a[76:79], v2 offset:19456
    v_mfma_f32_16x16x32_bf16 v[12:15], a[40:43], v[64:67], v[12:15]
    ds_read_b128 a[80:83], v2 offset:20480
    v_mfma_f32_16x16x32_bf16 v[16:19], a[44:47], v[64:67], v[16:19]
    ds_read_b128 a[84:87], v2 offset:21504
    v_mfma_f32_16x16x32_bf16 v[20:23], a[48:51], v[64:67], v[20:23]
    ds_read_b128 a[88:91], v2 offset:22528
    v_mfma_f32_16x16x32_bf16 v[24:27], a[52:55], v[64:67], v[24:27]
    ds_read_b128 a[92:95], v2 offset:23552
    v_mfma_f32_16x16x32_bf16 v[28:31], a[56:59], v[64:67], v[28:31]
    s_waitcnt lgkmcnt(4)
    ds_read_b128 a[96:99], v2 offset:24576
    v_mfma_f32_16x16x32_bf16 v[12:15], a[60:63], v[96:99], v[12:15]
    ds_read_b128 a[100:103], v2 offset:25600
    v_mfma_f32_16x16x32_bf16 v[16:19], a[64:67], v[96:99], v[16:19]
    ds_read_b128 a[104:107], v2 offset:26624
    v_mfma_f32_16x16x32_bf16 v[20:23], a[68:71], v[96:99], v[20:23]
    v_max3_u32 v5, v123, v127, v131
    v_max_u32 v5, v5, v135
    v_cmp_eq_u32_e64 vcc, -1, v5
    v_mfma_f32_16x16x32_bf16 v[24:27], a[72:75], v[96:99], v[24:27]
    ds_read_b128 a[108:111], v2 offset:27648
    v_mfma_f32_16x16x32_bf16 v[28:31], a[76:79], v[96:99], v[28:31]
    s_cbranch_vccnz L_fsp_43
L_fok_44:
    s_waitcnt lgkmcnt(3)
    ds_read_b128 a[112:115], v2 offset:28672
    ds_read_b128 a[116:119], v2 offset:29696
    v_mfma_f32_16x16x32_bf16 v[12:15], a[80:83], v[120:123], v[12:15]
    ds_read_b128 a[120:123], v2 offset:30720
    v_mfma_f32_16x16x32_bf16 v[16:19], a[84:87], v[120:123], v[16:19]
    ds_read_b128 a[124:127], v2 offset:31744
    v_mfma_f32_16x16x32_bf16 v[20:23], a[88:91], v[120:123], v[20:23]
    ds_read_b128 a[128:131], v2 offset:32768
    v_mfma_f32_16x16x32_bf16 v[24:27], a[92:95], v[120:123], v[24:27]
    ds_read_b128 a[132:135], v2 offset:33792
    v_mfma_f32_16x16x32_bf16 v[28:31], a[96:99], v[120:123], v[28:31]
    s_waitcnt lgkmcnt(4)
    ds_read_b128 a[136:139], v2 offset:34816
    v_mfma_f32_16x16x32_bf16 v[12:15], a[100:103], v[124:127], v[12:15]
    ds_read_b128 a[140:143], v2 offset:35840
    v_mfma_f32_16x16x32_bf16 v[16:19], a[104:107], v[124:127], v[16:19]
    ds_read_b128 a[144:147], v2 offset:36864
    v_mfma_f32_16x16x32_bf16 v[20:23], a[108:111], v[124:127], v[20:23]
    ds_read_b128 a[148:151], v2 offset:37888
    v_mfma_f32_16x16x32_bf16 v[24:27], a[112:115], v[124:127], v[24:27]
    ds_read_b128 a[152:155], v2 offset:38912
    v_mfma_f32_16x16x32_bf16 v[28:31], a[116:119], v[124:127], v[28:31]
    s_waitcnt lgkmcnt(4)
    ds_read_b128 a[156:159], v2 offset:39936
    v_mfma_f32_16x16x32_bf16 v[12:15], a[120:123], v[128:131], v[12:15]
    v_mfma_f32_16x16x32_bf16 v[16:19], a[124:127], v[128:131], v[16:19]
    v_mfma_f32_16x16x32_bf16 v[20:23], a[128:131], v[128:131], v[20:23]
    v_mfma_f32_16x16x32_bf16 v[24:27], a[132:135], v[128:131], v[24:27]
    v_mfma_f32_16x16x32_bf16 v[28:31], a[136:139], v[128:131], v[28:31]
    s_waitcnt lgkmcnt(0)
    v_mfma_f32_16x16x32_bf16 v[12:15], a[140:143], v[132:135], v[12:15]
    v_mfma_f32_16x16x32_bf16 v[16:19], a[144:147], v[132:135], v[16:19]
    v_mfma_f32_16x16x32_bf16 v[20:23], a[148:151], v[132:135], v[20:23]
    v_mfma_f32_16x16x32_bf16 v[24:27], a[152:155], v[132:135], v[24:27]
    v_mfma_f32_16x16x32_bf16 v[28:31], a[156:159], v[132:135], v[28:31]
    s_mov_b32 s0, 0
    s_or_b32 s86, s2, s83
    s_cselect_b32 s86, 16777216, 0
    s_nop 0
    v_cmp_u_f32 vcc, v12, v12
    s_cbranch_vccnz L_oredo_46
L_ook_47:
    s_cmp_eq_u32 s87, s70
    s_cbranch_scc1 L_sel_49
L_seldone_50:
    s_cmp_eq_u32 s88, s70
    s_cbranch_scc1 L_sel_54
L_seldone_55:
    v_cvt_pk_bf16_f32 v108, v12, v13
    v_cvt_pk_bf16_f32 v109, v14, v15
    ds_write_b64 v47, v[108:109] offset:0
    v_cvt_pk_bf16_f32 v110, v16, v17
    v_cvt_pk_bf16_f32 v111, v18, v19
    ds_write_b64 v47, v[110:111] offset:8
    v_cvt_pk_bf16_f32 v112, v20, v21
    v_cvt_pk_bf16_f32 v113, v22, v23
    ds_write_b64 v47, v[112:113] offset:16
    v_cvt_pk_bf16_f32 v114, v24, v25
    v_cvt_pk_bf16_f32 v115, v26, v27
    ds_write_b64 v47, v[114:115] offset:24
    v_cvt_pk_bf16_f32 v116, v28, v29
    v_cvt_pk_bf16_f32 v117, v30, v31
    ds_write_b64 v47, v[116:117] offset:32
    ds_read_b128 v[40:43], v53 offset:0
    ds_read_b128 v[56:59], v53 offset:1056
    ds_read_b128 v[64:67], v53 offset:2112
    s_waitcnt lgkmcnt(2)
    buffer_store_dwordx4 v[40:43], v79, s[24:27], s71 offen offset:0 sc1
    s_waitcnt lgkmcnt(1)
    buffer_store_dwordx4 v[56:59], v80, s[24:27], s71 offen offset:1024 sc1
    s_waitcnt lgkmcnt(0)
    buffer_store_dwordx4 v[64:67], v81, s[24:27], s71 offen offset:2048 sc1
    buffer_store_dwordx2 v[10:11], v46, s[28:31], s86 offen sc1
L_end:
    s_endpgm
L_f0spin_1:
    s_mov_b32 s89, 0
L_f0loop_3:
    buffer_load_dwordx2 v[44:45], v84, s[28:31], s35 offen sc1
    s_add_u32 s89, s89, 1
    s_waitcnt vmcnt(0)
    v_cmp_ne_u64 s[8:9], v[10:11], v[44:45]
    s_nop 0
    s_cmp_lg_u64 s[8:9], 0
    s_cbranch_scc0 L_f0ok_2
    s_cmp_lt_u32 s89, 262144
    s_cbranch_scc1 L_f0loop_3
    s_branch L_f0ok_2
L_cspin_4:
    s_mov_b32 s89, 0
L_cloop_6:
    buffer_load_dwordx4 v[240:243], v47, s[28:31], s74 offen sc1
    buffer_load_dwordx4 v[244:247], v47, s[28:31], s74 offen offset:16 sc1
    s_add_u32 s89, s89, 1
    s_waitcnt vmcnt(0)
    v_cmp_ne_u64 s[8:9], v[10:11], v[242:243]
    v_cmp_ne_u64 s[0:1], v[10:11], v[246:247]
    s_nop 0
    s_or_b64 s[8:9], s[8:9], s[0:1]
    s_cbranch_scc0 L_cok_5
    s_cmp_lt_u32 s89, 262144
    s_cbranch_scc1 L_cloop_6
    s_branch L_cok_5
L_f1spin_7:
    s_mov_b32 s89, 0
L_f1loop_9:
    buffer_load_dwordx2 v[44:45], v84, s[28:31], s37 offen sc1
    s_add_u32 s89, s89, 1
    s_waitcnt vmcnt(0)
    v_cmp_ne_u64 s[8:9], v[10:11], v[44:45]
    s_nop 0
    s_cmp_lg_u64 s[8:9], 0
    s_cbranch_scc0 L_f1ok_8
    s_cmp_lt_u32 s89, 262144
    s_cbranch_scc1 L_f1loop_9
    s_branch L_f1ok_8
L_f3spin_10:
    s_mov_b32 s89, 0
L_f3loop_12:
    buffer_load_dwordx2 v[44:45], v84, s[28:31], s42 offen sc1
    s_add_u32 s89, s89, 1
    s_waitcnt vmcnt(0)
    v_cmp_ne_u64 s[8:9], v[10:11], v[44:45]
    s_nop 0
    s_cmp_lg_u64 s[8:9], 0
    s_cbranch_scc0 L_f3ok_11
    s_cmp_lt_u32 s89, 262144
    s_cbranch_scc1 L_f3loop_12
    s_branch L_f3ok_11
L_gredo_13:
    s_mov_b32 s89, 0
L_gloop_15:
    buffer_load_dwordx4 a[188:191], v67, s[28:31], 0 offen sc1
    s_mov_b32 s86, 4096
    buffer_load_dwordx4 a[192:195], v67, s[28:31], s86 offen sc1
    s_mov_b32 s86, 8192
    buffer_load_dwordx4 a[196:199], v67, s[28:31], s86 offen sc1
    s_mov_b32 s86, 12288
    buffer_load_dwordx4 a[200:203], v67, s[28:31], s86 offen sc1
    s_mov_b32 s86, 16384
    buffer_load_dwordx4 a[204:207], v67, s[28:31], s86 offen sc1
    s_mov_b32 s86, 20480
    buffer_load_dwordx4 a[208:211], v67, s[28:31], s86 offen sc1
    s_mov_b32 s86, 24576
    buffer_load_dwordx4 a[212:215], v67, s[28:31], s86 offen sc1
    s_mov_b32 s86, 28672
    buffer_load_dwordx4 a[216:219], v67, s[28:31], s86 offen sc1
    s_mov_b32 s86, 32768
    buffer_load_dwordx4 a[220:223], v67, s[28:31], s86 offen sc1
    s_mov_b32 s86, 36864
    buffer_load_dwordx4 a[224:227], v67, s[28:31], s86 offen sc1
    s_mov_b32 s86, 40960
    buffer_load_dwordx4 a[228:231], v67, s[28:31], s86 offen sc1
    s_mov_b32 s86, 45056
    buffer_load_dwordx4 a[232:235], v67, s[28:31], s86 offen sc1
    s_mov_b32 s86, 49152
    buffer_load_dwordx4 a[236:239], v67, s[28:31], s86 offen sc1
    s_mov_b32 s86, 53248
    buffer_load_dwordx4 a[240:243], v67, s[28:31], s86 offen sc1
    s_mov_b32 s86, 57344
    buffer_load_dwordx4 a[244:247], v67, s[28:31], s86 offen sc1
    s_mov_b32 s86, 61440
    buffer_load_dwordx4 a[248:251], v67, s[28:31], s86 offen sc1
    s_add_u32 s89, s89, 1
    s_waitcnt vmcnt(0)
    v_accvgpr_mov_b32 a252, a188
    v_accvgpr_mov_b32 a253, a189
    v_mfma_f32_16x16x32_bf16 v[96:99], a[0:3], a[190:193], 0
    v_mfma_f32_16x16x32_bf16 v[56:59], a[0:3], a[194:197], 0
    v_mfma_f32_16x16x32_bf16 v[96:99], a[0:3], a[198:201], v[96:99]
    v_mfma_f32_16x16x32_bf16 v[56:59], a[0:3], a[202:205], v[56:59]
    v_mfma_f32_16x16x32_bf16 v[96:99], a[0:3], a[206:209], v[96:99]
    v_mfma_f32_16x16x32_bf16 v[56:59], a[0:3], a[210:213], v[56:59]
    v_mfma_f32_16x16x32_bf16 v[96:99], a[0:3], a[214:217], v[96:99]
    v_mfma_f32_16x16x32_bf16 v[56:59], a[0:3], a[218:221], v[56:59]
    v_mfma_f32_16x16x32_bf16 v[96:99], a[0:3], a[222:225], v[96:99]
    v_mfma_f32_16x16x32_bf16 v[56:59], a[0:3], a[226:229], v[56:59]
    v_mfma_f32_16x16x32_bf16 v[96:99], a[0:3], a[230:233], v[96:99]
    v_mfma_f32_16x16x32_bf16 v[56:59], a[0:3], a[234:237], v[56:59]
    v_mfma_f32_16x16x32_bf16 v[96:99], a[0:3], a[238:241], v[96:99]
    v_mfma_f32_16x16x32_bf16 v[56:59], a[0:3], a[242:245], v[56:59]
    v_mfma_f32_16x16x32_bf16 v[96:99], a[0:3], a[246:249], v[96:99]
    v_mfma_f32_16x16x32_bf16 v[56:59], a[0:3], a[250:253], v[56:59]
    s_nop 7
    v_cmp_u_f32 vcc, v96, v56
    s_cbranch_vccz L_gok_14
    s_cmp_lt_u32 s89, 262144
    s_cbranch_scc1 L_gloop_15
    s_branch L_gok_14
L_predo_16:
    s_mov_b32 s89, 0
L_ploop_18:
    buffer_load_dwordx4 v[48:51], v71, s[28:31], 0 offen sc1
    s_mov_b32 s90, 4096
    buffer_load_dwordx4 v[100:103], v71, s[28:31], s90 offen sc1
    s_mov_b32 s90, 8192
    buffer_load_dwordx4 v[104:107], v90, s[28:31], s90 offen sc1
    s_add_u32 s89, s89, 1
    s_waitcnt vmcnt(0)
    v_pk_add_f32 v[48:49], v[48:49], v[100:101]
    v_pk_add_f32 v[50:51], v[50:51], v[102:103]
    v_pk_add_f32 v[48:49], v[48:49], v[104:105]
    v_pk_add_f32 v[50:51], v[50:51], v[106:107]
    s_nop 0
    v_permlane16_swap_b32 v48, v49
    v_permlane16_swap_b32 v50, v51
    v_add_f32 v48, v48, v49
    v_add_f32 v50, v50, v51
    s_nop 1
    v_permlane32_swap_b32 v48, v50
    v_add_f32 v48, v48, v50
    v_cmp_u_f32_e64 vcc, v48, v48
    s_cbranch_vccz L_pok_17
    s_cmp_lt_u32 s89, 262144
    s_cbranch_scc1 L_ploop_18
    s_branch L_pok_17
L_fsp_19:
    s_mov_b32 s89, 0
L_floop_21:
    s_xor_b32 s86, s39, 8192
    s_add_u32 s86, s86, s73
    buffer_load_dwordx4 v[136:139], v2, s[28:31], s86 offen offset:0 sc1
    s_add_u32 s89, s89, 1
    s_waitcnt vmcnt(0)
    v_cmp_eq_u32 vcc, -1, v139
    s_cbranch_vccz L_fagain_22
    s_cmp_lt_u32 s89, 262144
    s_cbranch_scc1 L_floop_21
L_fagain_22:
    s_xor_b32 s86, s39, 8192
    s_add_u32 s86, s86, s73
    buffer_load_dwordx4 v[140:143], v2, s[28:31], s86 offen offset:1024 sc1
    buffer_load_dwordx4 v[144:147], v2, s[28:31], s86 offen offset:2048 sc1
    buffer_load_dwordx4 v[148:151], v2, s[28:31], s86 offen offset:3072 sc1
    s_xor_b32 s86, s39, 12288
    s_add_u32 s86, s86, s73
    buffer_load_dwordx4 v[152:155], v2, s[28:31], s86 offen offset:0 sc1
    buffer_load_dwordx4 v[156:159], v2, s[28:31], s86 offen offset:1024 sc1
    buffer_load_dwordx4 v[160:163], v2, s[28:31], s86 offen offset:2048 sc1
    buffer_load_dwordx4 v[164:167], v2, s[28:31], s86 offen offset:3072 sc1
    s_xor_b32 s86, s40, 16384
    s_add_u32 s86, s86, s73
    buffer_load_dwordx4 v[168:171], v2, s[28:31], s86 offen offset:0 sc1
    buffer_load_dwordx4 v[184:187], v2, s[28:31], s86 offen offset:1024 sc1
    s_branch L_fok_20
L_fsp_23:
    s_mov_b32 s89, 0
L_floop_25:
    s_xor_b32 s86, s39, 8192
    s_add_u32 s86, s86, s73
    buffer_load_dwordx4 v[140:143], v2, s[28:31], s86 offen offset:1024 sc1
    buffer_load_dwordx4 v[144:147], v2, s[28:31], s86 offen offset:2048 sc1
    s_add_u32 s89, s89, 1
    s_waitcnt vmcnt(0)
    v_max_u32 v5, v143, v147
    v_cmp_eq_u32 vcc, -1, v5
    s_cbranch_vccz L_fok_24
    s_cmp_lt_u32 s89, 262144
    s_cbranch_scc1 L_floop_25
    s_branch L_fok_24
L_fsp_26:
    s_mov_b32 s89, 0
L_floop_28:
    s_xor_b32 s86, s39, 8192
    s_add_u32 s86, s86, s73
    buffer_load_dwordx4 v[148:151], v2, s[28:31], s86 offen offset:3072 sc1
    s_xor_b32 s86, s39, 12288
    s_add_u32 s86, s86, s73
    buffer_load_dwordx4 v[152:155], v2, s[28:31], s86 offen offset:0 sc1
    buffer_load_dwordx4 v[156:159], v2, s[28:31], s86 offen offset:1024 sc1
    s_add_u32 s89, s89, 1
    s_waitcnt vmcnt(0)
    v_max3_u32 v5, v151, v155, v159
    v_cmp_eq_u32_e64 vcc, -1, v5
    s_cbranch_vccz L_fok_27
    s_cmp_lt_u32 s89, 262144
    s_cbranch_scc1 L_floop_28
    s_branch L_fok_27
L_fsp_29:
    s_mov_b32 s89, 0
L_floop_31:
    s_xor_b32 s86, s39, 12288
    s_add_u32 s86, s86, s73
    buffer_load_dwordx4 v[160:163], v2, s[28:31], s86 offen offset:2048 sc1
    buffer_load_dwordx4 v[164:167], v2, s[28:31], s86 offen offset:3072 sc1
    s_xor_b32 s86, s40, 16384
    s_add_u32 s86, s86, s73
    buffer_load_dwordx4 v[168:171], v2, s[28:31], s86 offen offset:0 sc1
    s_add_u32 s89, s89, 1
    s_waitcnt vmcnt(0)
    v_max3_u32 v5, v163, v167, v171
    v_cmp_eq_u32_e64 vcc, -1, v5
    s_cbranch_vccz L_fok_30
    s_cmp_lt_u32 s89, 262144
    s_cbranch_scc1 L_floop_31
    s_branch L_fok_30
L_fsp_32:
    s_mov_b32 s89, 0
L_floop_34:
    s_xor_b32 s86, s40, 16384
    s_add_u32 s86, s86, s73
    buffer_load_dwordx4 v[184:187], v2, s[28:31], s86 offen offset:1024 sc1
    s_xor_b32 s86, s40, 18432
    s_add_u32 s86, s86, s73
    buffer_load_dwordx4 v[188:191], v2, s[28:31], s86 offen offset:0 sc1
    buffer_load_dwordx4 v[192:195], v2, s[28:31], s86 offen offset:1024 sc1
    s_add_u32 s89, s89, 1
    s_waitcnt vmcnt(0)
    v_max3_u32 v5, v187, v191, v195
    v_cmp_eq_u32_e64 vcc, -1, v5
    s_cbranch_vccz L_fagain_35
    s_cmp_lt_u32 s89, 262144
    s_cbranch_scc1 L_floop_34
L_fagain_35:
    s_xor_b32 s86, s39, 0
    s_add_u32 s86, s86, s73
    buffer_load_dwordx4 v[40:43], v2, s[28:31], s86 offen offset:0 sc1
    buffer_load_dwordx4 v[56:59], v2, s[28:31], s86 offen offset:1024 sc1
    buffer_load_dwordx4 v[64:67], v2, s[28:31], s86 offen offset:2048 sc1
    buffer_load_dwordx4 v[96:99], v2, s[28:31], s86 offen offset:3072 sc1
    s_xor_b32 s86, s39, 4096
    s_add_u32 s86, s86, s73
    buffer_load_dwordx4 v[120:123], v2, s[28:31], s86 offen offset:0 sc1
    buffer_load_dwordx4 v[124:127], v2, s[28:31], s86 offen offset:1024 sc1
    buffer_load_dwordx4 v[128:131], v2, s[28:31], s86 offen offset:2048 sc1
    buffer_load_dwordx4 v[132:135], v2, s[28:31], s86 offen offset:3072 sc1
    s_branch L_fok_33
L_fsp_36:
    s_mov_b32 s89, 0
L_floop_38:
    s_xor_b32 s86, s39, 0
    s_add_u32 s86, s86, s73
    buffer_load_dwordx4 v[40:43], v2, s[28:31], s86 offen offset:0 sc1
    buffer_load_dwordx4 v[56:59], v2, s[28:31], s86 offen offset:1024 sc1
    buffer_load_dwordx4 v[64:67], v2, s[28:31], s86 offen offset:2048 sc1
    buffer_load_dwordx4 v[96:99], v2, s[28:31], s86 offen offset:3072 sc1
    s_add_u32 s89, s89, 1
    s_waitcnt vmcnt(0)
    v_max3_u32 v5, v43, v59, v67
    v_max_u32 v5, v5, v99
    v_cmp_eq_u32_e64 vcc, -1, v5
    s_cbranch_vccz L_fok_37
    s_cmp_lt_u32 s89, 262144
    s_cbranch_scc1 L_floop_38
    s_branch L_fok_37
L_yl_39:
    v_min_u32_e64 v7, 59, v1
    v_mul_u32_u24 v55, 3277, v7
    v_lshrrev_b32_e64 v55, 16, v55
    v_mul_u32_u24 v54, 20160, v55
    v_lshl_add_u32 v54, v7, 4, v54
    s_add_u32 s90, s78, 0
    buffer_load_dwordx4 v[48:51], v54, s[28:31], s90 offen sc1
    s_add_u32 s90, s90, 2560
    buffer_load_dwordx4 v[100:103], v54, s[28:31], s90 offen sc1
    s_add_u32 s90, s90, 2560
    buffer_load_dwordx4 v[104:107], v54, s[28:31], s90 offen sc1
    s_add_u32 s90, s90, 2560
    buffer_load_dwordx4 v[172:175], v54, s[28:31], s90 offen sc1
    s_add_u32 s90, s90, 2560
    buffer_load_dwordx4 v[176:179], v54, s[28:31], s90 offen sc1
    s_add_u32 s90, s90, 2560
    buffer_load_dwordx4 v[180:183], v54, s[28:31], s90 offen sc1
    s_add_u32 s90, s90, 2560
    buffer_load_dwordx4 v[196:199], v54, s[28:31], s90 offen sc1
    s_add_u32 s90, s90, 2560
    buffer_load_dwordx4 v[200:203], v54, s[28:31], s90 offen sc1
    s_add_u32 s90, s90, 2560
    s_not_b32 s90, s11
    s_and_b32 s91, s11, 0x7fffffff
    s_cmp_lt_i32 s11, 0
    s_cselect_b32 s90, s91, s90
    s_and_b32 s90, s90, 0xffff0000
    v_mov_b32 v60, 0xbfb8aa3b
    v_mul_f32 v60, s90, v60
    v_exp_f32 v60, v60
    v_mul_u32_u24 v55, 20, v55
    v_add_f32 v60, 1.0, v60
    v_rcp_f32 v60, v60
    v_sub_u32 v55, v7, v55
    v_lshl_add_u32 v55, v55, 4, s72
    v_mov_b32 v68, 0
    v_mov_b32 v69, 0
    v_lshl_add_u32 v7, v1, 3, s72
    ds_write_b64 v7, v[68:69] offset:3072
    s_branch L_yldone_40
L_yl_41:
    v_min_u32 v7, 59, v1
    v_mul_u32_u24 v55, 3277, v7
    v_lshrrev_b32_e64 v55, 16, v55
    v_mul_u32_u24 v54, 20160, v55
    v_lshl_add_u32 v54, v7, 4, v54
    s_add_u32 s90, s78, 61440
    buffer_load_dwordx4 v[136:139], v54, s[28:31], s90 offen sc1
    s_add_u32 s90, s90, 2560
    buffer_load_dwordx4 v[140:143], v54, s[28:31], s90 offen sc1
    s_add_u32 s90, s90, 2560
    buffer_load_dwordx4 v[144:147], v54, s[28:31], s90 offen sc1
    s_add_u32 s90, s90, 2560
    buffer_load_dwordx4 v[148:151], v54, s[28:31], s90 offen sc1
    s_add_u32 s90, s90, 2560
    buffer_load_dwordx4 v[152:155], v54, s[28:31], s90 offen sc1
    s_add_u32 s90, s90, 2560
    buffer_load_dwordx4 v[156:159], v54, s[28:31], s90 offen sc1
    s_add_u32 s90, s90, 2560
    buffer_load_dwordx4 v[160:163], v54, s[28:31], s90 offen sc1
    s_add_u32 s90, s90, 2560
    buffer_load_dwordx4 v[164:167], v54, s[28:31], s90 offen sc1
    s_add_u32 s90, s90, 2560
    s_not_b32 s90, s33
    s_and_b32 s91, s33, 0x7fffffff
    s_cmp_lt_i32 s33, 0
    s_cselect_b32 s90, s91, s90
    s_and_b32 s90, s90, 0xffff0000
    v_mov_b32 v61, 0xbfb8aa3b
    v_mul_f32 v61, s90, v61
    v_exp_f32 v61, v61
    v_mul_u32_u24 v55, 20, v55
    v_add_f32 v61, 1.0, v61
    v_rcp_f32 v61, v61
    v_sub_u32_e64 v55, v7, v55
    v_lshl_add_u32 v55, v55, 4, s72
    v_mov_b32 v68, 0
    v_mov_b32 v69, 0
    v_lshl_add_u32 v7, v1, 3, s72
    ds_write_b64 v7, v[68:69] offset:3584
    s_branch L_yldone_42
L_fsp_43:
    s_mov_b32 s89, 0
L_floop_45:
    s_xor_b32 s86, s39, 4096
    s_add_u32 s86, s86, s73
    buffer_load_dwordx4 v[120:123], v2, s[28:31], s86 offen offset:0 sc1
    buffer_load_dwordx4 v[124:127], v2, s[28:31], s86 offen offset:1024 sc1
    buffer_load_dwordx4 v[128:131], v2, s[28:31], s86 offen offset:2048 sc1
    buffer_load_dwordx4 v[132:135], v2, s[28:31], s86 offen offset:3072 sc1
    s_add_u32 s89, s89, 1
    s_waitcnt vmcnt(0)
    v_max3_u32 v5, v123, v127, v131
    v_max_u32 v5, v5, v135
    v_cmp_eq_u32 vcc, -1, v5
    s_cbranch_vccz L_fok_44
    s_cmp_lt_u32 s89, 262144
    s_cbranch_scc1 L_floop_45
    s_branch L_fok_44
L_sel_49:
    s_mov_b32 s89, 0
    s_cmp_lg_u32 s0, 0
    s_cbranch_scc1 L_yagain_53
L_yloop_51:
    s_waitcnt vmcnt(0)
    v_pk_add_f32 v[48:49], v[48:49], v[100:101]
    v_pk_add_f32 v[50:51], v[50:51], v[102:103]
    v_pk_add_f32 v[48:49], v[48:49], v[104:105]
    v_pk_add_f32 v[50:51], v[50:51], v[106:107]
    v_pk_add_f32 v[48:49], v[48:49], v[172:173]
    v_pk_add_f32 v[50:51], v[50:51], v[174:175]
    v_pk_add_f32 v[48:49], v[48:49], v[176:177]
    v_pk_add_f32 v[50:51], v[50:51], v[178:179]
    v_pk_add_f32 v[48:49], v[48:49], v[180:181]
    v_pk_add_f32 v[50:51], v[50:51], v[182:183]
    v_pk_add_f32 v[48:49], v[48:49], v[196:197]
    v_pk_add_f32 v[50:51], v[50:51], v[198:199]
    v_pk_add_f32 v[48:49], v[48:49], v[200:201]
    v_pk_add_f32 v[50:51], v[50:51], v[202:203]
    v_pk_add_f32 v[100:101], v[48:49], v[50:51]
    v_cmp_u_f32_e64 vcc, v100, v101
    s_cbranch_vccz L_yok_52
    s_add_u32 s89, s89, 1
    s_cmp_ge_u32 s89, 262144
    s_cbranch_scc1 L_yok_52
L_yagain_53:
    s_add_u32 s90, s78, 0
    buffer_load_dwordx4 v[48:51], v54, s[28:31], s90 offen sc1
    s_add_u32 s90, s90, 2560
    buffer_load_dwordx4 v[100:103], v54, s[28:31], s90 offen sc1
    s_add_u32 s90, s90, 2560
    buffer_load_dwordx4 v[104:107], v54, s[28:31], s90 offen sc1
    s_add_u32 s90, s90, 2560
    buffer_load_dwordx4 v[172:175], v54, s[28:31], s90 offen sc1
    s_add_u32 s90, s90, 2560
    buffer_load_dwordx4 v[176:179], v54, s[28:31], s90 offen sc1
    s_add_u32 s90, s90, 2560
    buffer_load_dwordx4 v[180:183], v54, s[28:31], s90 offen sc1
    s_add_u32 s90, s90, 2560
    buffer_load_dwordx4 v[196:199], v54, s[28:31], s90 offen sc1
    s_add_u32 s90, s90, 2560
    buffer_load_dwordx4 v[200:203], v54, s[28:31], s90 offen sc1
    s_add_u32 s90, s90, 2560
    s_branch L_yloop_51
L_yok_52:
    s_mov_b32 exec_hi, 0x0fffffff
    v_mul_f32 v48, v48, v60
    ds_add_f32 v55, v48 offset:3072
    v_mul_f32_e64 v49, v49, v60
    ds_add_f32 v55, v49 offset:3076
    v_mul_f32_e64 v50, v50, v60
    ds_add_f32 v55, v50 offset:3080
    v_mul_f32_e64 v51, v51, v60
    ds_add_f32 v55, v51 offset:3084
    s_mov_b32 exec_hi, -1
    v_mul_u32_u24 v6, 80, v4
    v_add_u32 v6, s72, v6
    s_and_b32 s90, s35, 15
    v_cmp_eq_u32 vcc, s90, v3
    s_nop 0
    s_mov_b64 exec, vcc
    ds_read_b128 v[100:103], v6 offset:3072
    ds_read_b128 v[104:107], v6 offset:3088
    ds_read_b128 v[172:175], v6 offset:3104
    ds_read_b128 v[176:179], v6 offset:3120
    ds_read_b128 v[180:183], v6 offset:3136
    s_waitcnt lgkmcnt(4)
    v_pk_add_f32 v[12:13], v[12:13], v[100:101]
    v_pk_add_f32 v[14:15], v[14:15], v[102:103]
    s_waitcnt lgkmcnt(3)
    v_pk_add_f32 v[16:17], v[16:17], v[104:105]
    v_pk_add_f32 v[18:19], v[18:19], v[106:107]
    s_waitcnt lgkmcnt(2)
    v_pk_add_f32 v[20:21], v[20:21], v[172:173]
    v_pk_add_f32 v[22:23], v[22:23], v[174:175]
    s_waitcnt lgkmcnt(1)
    v_pk_add_f32 v[24:25], v[24:25], v[176:177]
    v_pk_add_f32 v[26:27], v[26:27], v[178:179]
    s_waitcnt lgkmcnt(0)
    v_pk_add_f32 v[28:29], v[28:29], v[180:181]
    v_pk_add_f32 v[30:31], v[30:31], v[182:183]
    s_mov_b64 exec, -1
    s_branch L_seldone_50
L_sel_54:
    s_mov_b32 s89, 0
    s_cmp_lg_u32 s0, 0
    s_cbranch_scc1 L_yagain_58
L_yloop_56:
    s_waitcnt vmcnt(0)
    v_pk_add_f32 v[136:137], v[136:137], v[140:141]
    v_pk_add_f32 v[138:139], v[138:139], v[142:143]
    v_pk_add_f32 v[136:137], v[136:137], v[144:145]
    v_pk_add_f32 v[138:139], v[138:139], v[146:147]
    v_pk_add_f32 v[136:137], v[136:137], v[148:149]
    v_pk_add_f32 v[138:139], v[138:139], v[150:151]
    v_pk_add_f32 v[136:137], v[136:137], v[152:153]
    v_pk_add_f32 v[138:139], v[138:139], v[154:155]
    v_pk_add_f32 v[136:137], v[136:137], v[156:157]
    v_pk_add_f32 v[138:139], v[138:139], v[158:159]
    v_pk_add_f32 v[136:137], v[136:137], v[160:161]
    v_pk_add_f32 v[138:139], v[138:139], v[162:163]
    v_pk_add_f32 v[136:137], v[136:137], v[164:165]
    v_pk_add_f32 v[138:139], v[138:139], v[166:167]
    v_pk_add_f32 v[140:141], v[136:137], v[138:139]
    v_cmp_u_f32 vcc, v140, v141
    s_cbranch_vccz L_yok_57
    s_add_u32 s89, s89, 1
    s_cmp_ge_u32 s89, 262144
    s_cbranch_scc1 L_yok_57
L_yagain_58:
    s_add_u32 s90, s78, 61440
    buffer_load_dwordx4 v[136:139], v54, s[28:31], s90 offen sc1
    s_add_u32 s90, s90, 2560
    buffer_load_dwordx4 v[140:143], v54, s[28:31], s90 offen sc1
    s_add_u32 s90, s90, 2560
    buffer_load_dwordx4 v[144:147], v54, s[28:31], s90 offen sc1
    s_add_u32 s90, s90, 2560
    buffer_load_dwordx4 v[148:151], v54, s[28:31], s90 offen sc1
    s_add_u32 s90, s90, 2560
    buffer_load_dwordx4 v[152:155], v54, s[28:31], s90 offen sc1
    s_add_u32 s90, s90, 2560
    buffer_load_dwordx4 v[156:159], v54, s[28:31], s90 offen sc1
    s_add_u32 s90, s90, 2560
    buffer_load_dwordx4 v[160:163], v54, s[28:31], s90 offen sc1
    s_add_u32 s90, s90, 2560
    buffer_load_dwordx4 v[164:167], v54, s[28:31], s90 offen sc1
    s_add_u32 s90, s90, 2560
    s_branch L_yloop_56
L_yok_57:
    s_mov_b32 exec_hi, 0x0fffffff
    v_mul_f32_e64 v136, v136, v61
    ds_add_f32 v55, v136 offset:3584
    v_mul_f32_e64 v137, v137, v61
    ds_add_f32 v55, v137 offset:3588
    v_mul_f32_e64 v138, v138, v61
    ds_add_f32 v55, v138 offset:3592
    v_mul_f32_e64 v139, v139, v61
    ds_add_f32 v55, v139 offset:3596
    s_mov_b32 exec_hi, -1
    v_mul_u32_u24 v6, 80, v4
    v_add_u32 v6, s72, v6
    s_and_b32 s90, s67, 15
    v_cmp_eq_u32 vcc, s90, v3
    s_nop 0
    s_mov_b64 exec, vcc
    ds_read_b128 v[140:143], v6 offset:3584
    ds_read_b128 v[144:147], v6 offset:3600
    ds_read_b128 v[148:151], v6 offset:3616
    ds_read_b128 v[152:155], v6 offset:3632
    ds_read_b128 v[156:159], v6 offset:3648
    s_waitcnt lgkmcnt(4)
    v_pk_add_f32 v[12:13], v[12:13], v[140:141]
    v_pk_add_f32 v[14:15], v[14:15], v[142:143]
    s_waitcnt lgkmcnt(3)
    v_pk_add_f32 v[16:17], v[16:17], v[144:145]
    v_pk_add_f32 v[18:19], v[18:19], v[146:147]
    s_waitcnt lgkmcnt(2)
    v_pk_add_f32 v[20:21], v[20:21], v[148:149]
    v_pk_add_f32 v[22:23], v[22:23], v[150:151]
    s_waitcnt lgkmcnt(1)
    v_pk_add_f32 v[24:25], v[24:25], v[152:153]
    v_pk_add_f32 v[26:27], v[26:27], v[154:155]
    s_waitcnt lgkmcnt(0)
    v_pk_add_f32 v[28:29], v[28:29], v[156:157]
    v_pk_add_f32 v[30:31], v[30:31], v[158:159]
    s_mov_b64 exec, -1
    s_branch L_seldone_55
L_oredo_46:
    s_mov_b32 s89, 0
    s_mov_b32 s0, 1
L_oloop_48:
    s_xor_b32 s90, s39, 8192
    s_add_u32 s90, s90, s73
    buffer_load_dwordx4 v[136:139], v2, s[28:31], s90 offen offset:0 sc1
    buffer_load_dwordx4 v[140:143], v2, s[28:31], s90 offen offset:1024 sc1
    buffer_load_dwordx4 v[144:147], v2, s[28:31], s90 offen offset:2048 sc1
    buffer_load_dwordx4 v[148:151], v2, s[28:31], s90 offen offset:3072 sc1
    s_xor_b32 s90, s39, 12288
    s_add_u32 s90, s90, s73
    buffer_load_dwordx4 v[152:155], v2, s[28:31], s90 offen offset:0 sc1
    buffer_load_dwordx4 v[156:159], v2, s[28:31], s90 offen offset:1024 sc1
    buffer_load_dwordx4 v[160:163], v2, s[28:31], s90 offen offset:2048 sc1
    buffer_load_dwordx4 v[164:167], v2, s[28:31], s90 offen offset:3072 sc1
    s_xor_b32 s90, s40, 16384
    s_add_u32 s90, s90, s73
    buffer_load_dwordx4 v[168:171], v2, s[28:31], s90 offen offset:0 sc1
    buffer_load_dwordx4 v[184:187], v2, s[28:31], s90 offen offset:1024 sc1
    s_xor_b32 s90, s40, 18432
    s_add_u32 s90, s90, s73
    buffer_load_dwordx4 v[188:191], v2, s[28:31], s90 offen offset:0 sc1
    buffer_load_dwordx4 v[192:195], v2, s[28:31], s90 offen offset:1024 sc1
    s_xor_b32 s90, s39, 0
    s_add_u32 s90, s90, s73
    buffer_load_dwordx4 v[40:43], v2, s[28:31], s90 offen offset:0 sc1
    buffer_load_dwordx4 v[56:59], v2, s[28:31], s90 offen offset:1024 sc1
    buffer_load_dwordx4 v[64:67], v2, s[28:31], s90 offen offset:2048 sc1
    buffer_load_dwordx4 v[96:99], v2, s[28:31], s90 offen offset:3072 sc1
    s_xor_b32 s90, s39, 4096
    s_add_u32 s90, s90, s73
    buffer_load_dwordx4 v[120:123], v2, s[28:31], s90 offen offset:0 sc1
    buffer_load_dwordx4 v[124:127], v2, s[28:31], s90 offen offset:1024 sc1
    buffer_load_dwordx4 v[128:131], v2, s[28:31], s90 offen offset:2048 sc1
    buffer_load_dwordx4 v[132:135], v2, s[28:31], s90 offen offset:3072 sc1
    v_lshlrev_b32_e64 v12, 16, v108
    v_and_b32 v13, 0xffff0000, v108
    v_pk_fma_f32 v[12:13], v[12:13], v[38:39], v[38:39] op_sel:[0,0,1] op_sel_hi:[1,0,1] neg_lo:[0,0,1] neg_hi:[0,0,1]
    v_lshlrev_b32_e64 v14, 16, v109
    v_and_b32 v15, 0xffff0000, v109
    v_pk_fma_f32 v[14:15], v[14:15], v[38:39], v[38:39] op_sel:[0,0,1] op_sel_hi:[1,0,1] neg_lo:[0,0,1] neg_hi:[0,0,1]
    v_lshlrev_b32_e64 v16, 16, v110
    v_and_b32 v17, 0xffff0000, v110
    v_pk_fma_f32 v[16:17], v[16:17], v[38:39], v[38:39] op_sel:[0,0,1] op_sel_hi:[1,0,1] neg_lo:[0,0,1] neg_hi:[0,0,1]
    v_lshlrev_b32_e64 v18, 16, v111
    v_and_b32 v19, 0xffff0000, v111
    v_pk_fma_f32 v[18:19], v[18:19], v[38:39], v[38:39] op_sel:[0,0,1] op_sel_hi:[1,0,1] neg_lo:[0,0,1] neg_hi:[0,0,1]
    v_lshlrev_b32_e64 v20, 16, v112
    v_and_b32 v21, 0xffff0000, v112
    v_pk_fma_f32 v[20:21], v[20:21], v[38:39], v[38:39] op_sel:[0,0,1] op_sel_hi:[1,0,1] neg_lo:[0,0,1] neg_hi:[0,0,1]
    v_lshlrev_b32_e64 v22, 16, v113
    v_and_b32 v23, 0xffff0000, v113
    v_pk_fma_f32 v[22:23], v[22:23], v[38:39], v[38:39] op_sel:[0,0,1] op_sel_hi:[1,0,1] neg_lo:[0,0,1] neg_hi:[0,0,1]
    v_lshlrev_b32_e64 v24, 16, v114
    v_and_b32 v25, 0xffff0000, v114
    v_pk_fma_f32 v[24:25], v[24:25], v[38:39], v[38:39] op_sel:[0,0,1] op_sel_hi:[1,0,1] neg_lo:[0,0,1] neg_hi:[0,0,1]
    v_lshlrev_b32_e64 v26, 16, v115
    v_and_b32 v27, 0xffff0000, v115
    v_pk_fma_f32 v[26:27], v[26:27], v[38:39], v[38:39] op_sel:[0,0,1] op_sel_hi:[1,0,1] neg_lo:[0,0,1] neg_hi:[0,0,1]
    v_lshlrev_b32_e64 v28, 16, v116
    v_and_b32 v29, 0xffff0000, v116
    v_pk_fma_f32 v[28:29], v[28:29], v[38:39], v[38:39] op_sel:[0,0,1] op_sel_hi:[1,0,1] neg_lo:[0,0,1] neg_hi:[0,0,1]
    v_lshlrev_b32_e64 v30, 16, v117
    v_and_b32 v31, 0xffff0000, v117
    v_pk_fma_f32 v[30:31], v[30:31], v[38:39], v[38:39] op_sel:[0,0,1] op_sel_hi:[1,0,1] neg_lo:[0,0,1] neg_hi:[0,0,1]
    s_add_u32 s89, s89, 1
    s_waitcnt vmcnt(0)
    ds_read_b128 a[0:3], v2 offset:40960
    ds_read_b128 a[4:7], v2 offset:41984
    ds_read_b128 a[8:11], v2 offset:43008
    ds_read_b128 a[12:15], v2 offset:44032
    ds_read_b128 a[16:19], v2 offset:45056
    s_waitcnt lgkmcnt(0)
    v_mfma_f32_16x16x32_bf16 v[12:15], a[0:3], v[136:139], v[12:15]
    v_mfma_f32_16x16x32_bf16 v[16:19], a[4:7], v[136:139], v[16:19]
    v_mfma_f32_16x16x32_bf16 v[20:23], a[8:11], v[136:139], v[20:23]
    v_mfma_f32_16x16x32_bf16 v[24:27], a[12:15], v[136:139], v[24:27]
    v_mfma_f32_16x16x32_bf16 v[28:31], a[16:19], v[136:139], v[28:31]
    ds_read_b128 a[20:23], v2 offset:46080
    ds_read_b128 a[24:27], v2 offset:47104
    ds_read_b128 a[28:31], v2 offset:48128
    ds_read_b128 a[32:35], v2 offset:49152
    ds_read_b128 a[36:39], v2 offset:50176
    s_waitcnt lgkmcnt(0)
    v_mfma_f32_16x16x32_bf16 v[12:15], a[20:23], v[140:143], v[12:15]
    v_mfma_f32_16x16x32_bf16 v[16:19], a[24:27], v[140:143], v[16:19]
    v_mfma_f32_16x16x32_bf16 v[20:23], a[28:31], v[140:143], v[20:23]
    v_mfma_f32_16x16x32_bf16 v[24:27], a[32:35], v[140:143], v[24:27]
    v_mfma_f32_16x16x32_bf16 v[28:31], a[36:39], v[140:143], v[28:31]
    ds_read_b128 a[40:43], v37 offset:0
    ds_read_b128 a[44:47], v37 offset:1024
    ds_read_b128 a[48:51], v37 offset:2048
    ds_read_b128 a[52:55], v37 offset:3072
    ds_read_b128 a[56:59], v37 offset:4096
    s_waitcnt lgkmcnt(0)
    v_mfma_f32_16x16x32_bf16 v[12:15], a[40:43], v[144:147], v[12:15]
    v_mfma_f32_16x16x32_bf16 v[16:19], a[44:47], v[144:147], v[16:19]
    v_mfma_f32_16x16x32_bf16 v[20:23], a[48:51], v[144:147], v[20:23]
    v_mfma_f32_16x16x32_bf16 v[24:27], a[52:55], v[144:147], v[24:27]
    v_mfma_f32_16x16x32_bf16 v[28:31], a[56:59], v[144:147], v[28:31]
    ds_read_b128 a[60:63], v37 offset:5120
    ds_read_b128 a[64:67], v37 offset:6144
    ds_read_b128 a[68:71], v37 offset:7168
    ds_read_b128 a[72:75], v37 offset:8192
    ds_read_b128 a[76:79], v37 offset:9216
    s_waitcnt lgkmcnt(0)
    v_mfma_f32_16x16x32_bf16 v[12:15], a[60:63], v[148:151], v[12:15]
    v_mfma_f32_16x16x32_bf16 v[16:19], a[64:67], v[148:151], v[16:19]
    v_mfma_f32_16x16x32_bf16 v[20:23], a[68:71], v[148:151], v[20:23]
    v_mfma_f32_16x16x32_bf16 v[24:27], a[72:75], v[148:151], v[24:27]
    v_mfma_f32_16x16x32_bf16 v[28:31], a[76:79], v[148:151], v[28:31]
    ds_read_b128 a[80:83], v37 offset:10240
    ds_read_b128 a[84:87], v37 offset:11264
    ds_read_b128 a[88:91], v37 offset:12288
    ds_read_b128 a[92:95], v37 offset:13312
    ds_read_b128 a[96:99], v37 offset:14336
    s_waitcnt lgkmcnt(0)
    v_mfma_f32_16x16x32_bf16 v[12:15], a[80:83], v[152:155], v[12:15]
    v_mfma_f32_16x16x32_bf16 v[16:19], a[84:87], v[152:155], v[16:19]
    v_mfma_f32_16x16x32_bf16 v[20:23], a[88:91], v[152:155], v[20:23]
    v_mfma_f32_16x16x32_bf16 v[24:27], a[92:95], v[152:155], v[24:27]
    v_mfma_f32_16x16x32_bf16 v[28:31], a[96:99], v[152:155], v[28:31]
    ds_read_b128 a[100:103], v37 offset:15360
    ds_read_b128 a[104:107], v37 offset:16384
    ds_read_b128 a[108:111], v37 offset:17408
    ds_read_b128 a[112:115], v37 offset:18432
    ds_read_b128 a[116:119], v37 offset:19456
    s_waitcnt lgkmcnt(0)
    v_mfma_f32_16x16x32_bf16 v[12:15], a[100:103], v[156:159], v[12:15]
    v_mfma_f32_16x16x32_bf16 v[16:19], a[104:107], v[156:159], v[16:19]
    v_mfma_f32_16x16x32_bf16 v[20:23], a[108:111], v[156:159], v[20:23]
    v_mfma_f32_16x16x32_bf16 v[24:27], a[112:115], v[156:159], v[24:27]
    v_mfma_f32_16x16x32_bf16 v[28:31], a[116:119], v[156:159], v[28:31]
    ds_read_b128 a[120:123], v37 offset:20480
    ds_read_b128 a[124:127], v37 offset:21504
    ds_read_b128 a[128:131], v37 offset:22528
    ds_read_b128 a[132:135], v37 offset:23552
    ds_read_b128 a[136:139], v37 offset:24576
    s_waitcnt lgkmcnt(0)
    v_mfma_f32_16x16x32_bf16 v[12:15], a[120:123], v[160:163], v[12:15]
    v_mfma_f32_16x16x32_bf16 v[16:19], a[124:127], v[160:163], v[16:19]
    v_mfma_f32_16x16x32_bf16 v[20:23], a[128:131], v[160:163], v[20:23]
    v_mfma_f32_16x16x32_bf16 v[24:27], a[132:135], v[160:163], v[24:27]
    v_mfma_f32_16x16x32_bf16 v[28:31], a[136:139], v[160:163], v[28:31]
    ds_read_b128 a[140:143], v37 offset:25600
    ds_read_b128 a[144:147], v37 offset:26624
    ds_read_b128 a[148:151], v37 offset:27648
    ds_read_b128 a[152:155], v37 offset:28672
    ds_read_b128 a[156:159], v37 offset:29696
    s_waitcnt lgkmcnt(0)
    v_mfma_f32_16x16x32_bf16 v[12:15], a[140:143], v[164:167], v[12:15]
    v_mfma_f32_16x16x32_bf16 v[16:19], a[144:147], v[164:167], v[16:19]
    v_mfma_f32_16x16x32_bf16 v[20:23], a[148:151], v[164:167], v[20:23]
    v_mfma_f32_16x16x32_bf16 v[24:27], a[152:155], v[164:167], v[24:27]
    v_mfma_f32_16x16x32_bf16 v[28:31], a[156:159], v[164:167], v[28:31]
    ds_read_b128 a[160:163], v37 offset:30720
    ds_read_b128 a[164:167], v37 offset:31744
    ds_read_b128 a[168:171], v37 offset:32768
    ds_read_b128 a[172:175], v37 offset:33792
    ds_read_b128 a[176:179], v37 offset:34816
    s_waitcnt lgkmcnt(0)
    v_mfma_f32_16x16x32_bf16 v[12:15], a[160:163], v[168:171], v[12:15]
    v_mfma_f32_16x16x32_bf16 v[16:19], a[164:167], v[168:171], v[16:19]
    v_mfma_f32_16x16x32_bf16 v[20:23], a[168:171], v[168:171], v[20:23]
    v_mfma_f32_16x16x32_bf16 v[24:27], a[172:175], v[168:171], v[24:27]
    v_mfma_f32_16x16x32_bf16 v[28:31], a[176:179], v[168:171], v[28:31]
    ds_read_b128 a[188:191], v37 offset:35840
    ds_read_b128 a[192:195], v37 offset:36864
    ds_read_b128 a[196:199], v37 offset:37888
    ds_read_b128 a[200:203], v37 offset:38912
    ds_read_b128 a[204:207], v37 offset:39936
    s_waitcnt lgkmcnt(0)
    v_mfma_f32_16x16x32_bf16 v[12:15], a[188:191], v[184:187], v[12:15]
    v_mfma_f32_16x16x32_bf16 v[16:19], a[192:195], v[184:187], v[16:19]
    v_mfma_f32_16x16x32_bf16 v[20:23], a[196:199], v[184:187], v[20:23]
    v_mfma_f32_16x16x32_bf16 v[24:27], a[200:203], v[184:187], v[24:27]
    v_mfma_f32_16x16x32_bf16 v[28:31], a[204:207], v[184:187], v[28:31]
    ds_read_b128 a[208:211], v37 offset:40960
    ds_read_b128 a[212:215], v37 offset:41984
    ds_read_b128 a[216:219], v37 offset:43008
    ds_read_b128 a[220:223], v37 offset:44032
    ds_read_b128 a[224:227], v37 offset:45056
    s_waitcnt lgkmcnt(0)
    v_mfma_f32_16x16x32_bf16 v[12:15], a[208:211], v[188:191], v[12:15]
    v_mfma_f32_16x16x32_bf16 v[16:19], a[212:215], v[188:191], v[16:19]
    v_mfma_f32_16x16x32_bf16 v[20:23], a[216:219], v[188:191], v[20:23]
    v_mfma_f32_16x16x32_bf16 v[24:27], a[220:223], v[188:191], v[24:27]
    v_mfma_f32_16x16x32_bf16 v[28:31], a[224:227], v[188:191], v[28:31]
    ds_read_b128 a[228:231], v37 offset:46080
    ds_read_b128 a[232:235], v37 offset:47104
    ds_read_b128 a[236:239], v37 offset:48128
    ds_read_b128 a[240:243], v37 offset:49152
    ds_read_b128 a[244:247], v37 offset:50176
    s_waitcnt lgkmcnt(0)
    v_mfma_f32_16x16x32_bf16 v[12:15], a[228:231], v[192:195], v[12:15]
    v_mfma_f32_16x16x32_bf16 v[16:19], a[232:235], v[192:195], v[16:19]
    v_mfma_f32_16x16x32_bf16 v[20:23], a[236:239], v[192:195], v[20:23]
    v_mfma_f32_16x16x32_bf16 v[24:27], a[240:243], v[192:195], v[24:27]
    v_mfma_f32_16x16x32_bf16 v[28:31], a[244:247], v[192:195], v[28:31]
    ds_read_b128 a[0:3], v2 offset:0
    ds_read_b128 a[4:7], v2 offset:1024
    ds_read_b128 a[8:11], v2 offset:2048
    ds_read_b128 a[12:15], v2 offset:3072
    ds_read_b128 a[16:19], v2 offset:4096
    s_waitcnt lgkmcnt(0)
    v_mfma_f32_16x16x32_bf16 v[12:15], a[0:3], v[40:43], v[12:15]
    v_mfma_f32_16x16x32_bf16 v[16:19], a[4:7], v[40:43], v[16:19]
    v_mfma_f32_16x16x32_bf16 v[20:23], a[8:11], v[40:43], v[20:23]
    v_mfma_f32_16x16x32_bf16 v[24:27], a[12:15], v[40:43], v[24:27]
    v_mfma_f32_16x16x32_bf16 v[28:31], a[16:19], v[40:43], v[28:31]
    ds_read_b128 a[20:23], v2 offset:5120
    ds_read_b128 a[24:27], v2 offset:6144
    ds_read_b128 a[28:31], v2 offset:7168
    ds_read_b128 a[32:35], v2 offset:8192
    ds_read_b128 a[36:39], v2 offset:9216
    s_waitcnt lgkmcnt(0)
    v_mfma_f32_16x16x32_bf16 v[12:15], a[20:23], v[56:59], v[12:15]
    v_mfma_f32_16x16x32_bf16 v[16:19], a[24:27], v[56:59], v[16:19]
    v_mfma_f32_16x16x32_bf16 v[20:23], a[28:31], v[56:59], v[20:23]
    v_mfma_f32_16x16x32_bf16 v[24:27], a[32:35], v[56:59], v[24:27]
    v_mfma_f32_16x16x32_bf16 v[28:31], a[36:39], v[56:59], v[28:31]
    ds_read_b128 a[40:43], v2 offset:10240
    ds_read_b128 a[44:47], v2 offset:11264
    ds_read_b128 a[48:51], v2 offset:12288
    ds_read_b128 a[52:55], v2 offset:13312
    ds_read_b128 a[56:59], v2 offset:14336
    s_waitcnt lgkmcnt(0)
    v_mfma_f32_16x16x32_bf16 v[12:15], a[40:43], v[64:67], v[12:15]
    v_mfma_f32_16x16x32_bf16 v[16:19], a[44:47], v[64:67], v[16:19]
    v_mfma_f32_16x16x32_bf16 v[20:23], a[48:51], v[64:67], v[20:23]
    v_mfma_f32_16x16x32_bf16 v[24:27], a[52:55], v[64:67], v[24:27]
    v_mfma_f32_16x16x32_bf16 v[28:31], a[56:59], v[64:67], v[28:31]
    ds_read_b128 a[60:63], v2 offset:15360
    ds_read_b128 a[64:67], v2 offset:16384
    ds_read_b128 a[68:71], v2 offset:17408
    ds_read_b128 a[72:75], v2 offset:18432
    ds_read_b128 a[76:79], v2 offset:19456
    s_waitcnt lgkmcnt(0)
    v_mfma_f32_16x16x32_bf16 v[12:15], a[60:63], v[96:99], v[12:15]
    v_mfma_f32_16x16x32_bf16 v[16:19], a[64:67], v[96:99], v[16:19]
    v_mfma_f32_16x16x32_bf16 v[20:23], a[68:71], v[96:99], v[20:23]
    v_mfma_f32_16x16x32_bf16 v[24:27], a[72:75], v[96:99], v[24:27]
    v_mfma_f32_16x16x32_bf16 v[28:31], a[76:79], v[96:99], v[28:31]
    ds_read_b128 a[80:83], v2 offset:20480
    ds_read_b128 a[84:87], v2 offset:21504
    ds_read_b128 a[88:91], v2 offset:22528
    ds_read_b128 a[92:95], v2 offset:23552
    ds_read_b128 a[96:99], v2 offset:24576
    s_waitcnt lgkmcnt(0)
    v_mfma_f32_16x16x32_bf16 v[12:15], a[80:83], v[120:123], v[12:15]
    v_mfma_f32_16x16x32_bf16 v[16:19], a[84:87], v[120:123], v[16:19]
    v_mfma_f32_16x16x32_bf16 v[20:23], a[88:91], v[120:123], v[20:23]
    v_mfma_f32_16x16x32_bf16 v[24:27], a[92:95], v[120:123], v[24:27]
    v_mfma_f32_16x16x32_bf16 v[28:31], a[96:99], v[120:123], v[28:31]
    ds_read_b128 a[100:103], v2 offset:25600
    ds_read_b128 a[104:107], v2 offset:26624
    ds_read_b128 a[108:111], v2 offset:27648
    ds_read_b128 a[112:115], v2 offset:28672
    ds_read_b128 a[116:119], v2 offset:29696
    s_waitcnt lgkmcnt(0)
    v_mfma_f32_16x16x32_bf16 v[12:15], a[100:103], v[124:127], v[12:15]
    v_mfma_f32_16x16x32_bf16 v[16:19], a[104:107], v[124:127], v[16:19]
    v_mfma_f32_16x16x32_bf16 v[20:23], a[108:111], v[124:127], v[20:23]
    v_mfma_f32_16x16x32_bf16 v[24:27], a[112:115], v[124:127], v[24:27]
    v_mfma_f32_16x16x32_bf16 v[28:31], a[116:119], v[124:127], v[28:31]
    ds_read_b128 a[120:123], v2 offset:30720
    ds_read_b128 a[124:127], v2 offset:31744
    ds_read_b128 a[128:131], v2 offset:32768
    ds_read_b128 a[132:135], v2 offset:33792
    ds_read_b128 a[136:139], v2 offset:34816
    s_waitcnt lgkmcnt(0)
    v_mfma_f32_16x16x32_bf16 v[12:15], a[120:123], v[128:131], v[12:15]
    v_mfma_f32_16x16x32_bf16 v[16:19], a[124:127], v[128:131], v[16:19]
    v_mfma_f32_16x16x32_bf16 v[20:23], a[128:131], v[128:131], v[20:23]
    v_mfma_f32_16x16x32_bf16 v[24:27], a[132:135], v[128:131], v[24:27]
    v_mfma_f32_16x16x32_bf16 v[28:31], a[136:139], v[128:131], v[28:31]
    ds_read_b128 a[140:143], v2 offset:35840
    ds_read_b128 a[144:147], v2 offset:36864
    ds_read_b128 a[148:151], v2 offset:37888
    ds_read_b128 a[152:155], v2 offset:38912
    ds_read_b128 a[156:159], v2 offset:39936
    s_waitcnt lgkmcnt(0)
    v_mfma_f32_16x16x32_bf16 v[12:15], a[140:143], v[132:135], v[12:15]
    v_mfma_f32_16x16x32_bf16 v[16:19], a[144:147], v[132:135], v[16:19]
    v_mfma_f32_16x16x32_bf16 v[20:23], a[148:151], v[132:135], v[20:23]
    v_mfma_f32_16x16x32_bf16 v[24:27], a[152:155], v[132:135], v[24:27]
    v_mfma_f32_16x16x32_bf16 v[28:31], a[156:159], v[132:135], v[28:31]
    s_nop 7
    v_cmp_u_f32_e64 vcc, v12, v12
    s_cbranch_vccz L_ook_47
    s_cmp_lt_u32 s89, 32768
    s_cbranch_scc1 L_oloop_48
    s_branch L_ook_47
.p2align 7
.type L_table,@object
L_table:
.long 2752512,3604736,65536,65536,212992,212992,15,8192,0,688128,688128,4849664,158720,0,1048576,1069056,1089536,1110016,1130496,2752512,2772992,2793472,143360,3604480,0,0,7471104,7733248,156,7946240,3735424,3735936,4849664,4866048,7864320,0,9216,7864320,0,0,102400,4849664,262144,3735552,7471104,0,7733248,158720
.long 2755072,3605120,16777216,66560,98304,98304,15,8192,0,16777216,688640,4852224,158848,5120,1053696,1074176,1094656,1115136,1135616,2757632,2778112,2795520,145408,3606016,49152,20480,7471360,7733312,20636,7951360,3736192,3737216,4890624,4907008,7869440,5120,14336,7864576,1,20480,106496,4870144,262144,3736576,7471360,0,7733248,158784
.long 2803712,3612416,16777216,67584,16777216,215040,15,8192,0,16777216,689152,4854784,158976,10240,1058816,1079296,1099776,1120256,1140736,2762752,2783232,2798592,148480,3607552,98304,40960,7471616,7733376,41116,7956480,3737344,3737856,4931584,4947968,7874560,20480,45056,7946240,2,40960,110592,4890624,262144,3737600,7471616,0,7733248,158848
.long 2806272,3612800,16777216,68352,163840,163840,9,8192,0,16777216,689664,4857344,159104,15360,1063936,1084416,1104896,1125376,1145856,2767872,2788352,2800640,150528,3609088,147456,61440,7471872,7733440,61596,7961600,3738112,3739136,4972544,4988928,7879680,16797696,16822272,24723456,3,61440,114688,4911104,262144,3738624,7471872,0,7733248,158912
.long 2957312,3635456,73728,65536,221184,212992,15,8192,0,696320,696320,5505024,158720,0,1048576,1069056,1089536,1110016,1130496,2752512,2772992,2793472,143360,3604480,768,491520,7532544,7748608,655516,7946240,3751808,3752320,5505024,5521408,7864320,320,9536,8069120,32,655360,102400,5505024,262144,3751936,7532544,0,7733248,158720
.long 2959872,3635840,16777216,66560,98816,98304,15,8192,0,16777216,696832,5507584,158848,5120,1053696,1074176,1094656,1115136,1135616,2757632,2778112,2795520,145408,3606016,49920,512000,7532800,7748672,675996,7951360,3752576,3753600,5545984,5562368,7869440,5440,14656,8069376,33,675840,106496,5525504,262144,3752960,7532800,0,7733248,158784
.long 3008512,3643136,16777216,67584,16777216,215040,15,8192,0,16777216,697344,5510144,158976,10240,1058816,1079296,1099776,1120256,1140736,2762752,2783232,2798592,148480,3607552,99072,532480,7533056,7748736,696476,7956480,3753728,3754240,5586944,5603328,7874560,20800,45376,8151040,34,696320,110592,5545984,262144,3753984,7533056,0,7733248,158848
.long 3011072,3643520,16777216,68352,176128,176128,9,8192,0,16777216,697856,5512704,159104,15360,1063936,1084416,1104896,1125376,1145856,2767872,2788352,2800640,150528,3609088,148224,552960,7533312,7748800,716956,7961600,3754496,3755520,5627904,5644288,7879680,16798016,16822592,24928256,35,716800,114688,5566464,262144,3755008,7533312,0,7733248,158912
.long 2778112,3608576,66176,65536,229376,212992,15,8192,0,704512,704512,6160384,158720,0,1048576,1069056,1089536,1110016,1130496,2752512,2772992,2793472,143360,3604480,1536,983040,7593984,7763968,1310876,7946240,3768192,3768704,6160384,6176768,7864320,640,9856,8273920,64,1310720,102400,6160384,262144,3768320,7593984,0,7733248,158720
.long 2780672,3608960,16777216,66560,99328,98304,15,8192,0,16777216,705024,6162944,158848,5120,1053696,1074176,1094656,1115136,1135616,2757632,2778112,2795520,145408,3606016,50688,1003520,7594240,7764032,1331356,7951360,3768960,3769984,6201344,6217728,7869440,5760,14976,8274176,65,1331200,106496,6180864,262144,3769344,7594240,0,7733248,158784
.long 2829312,3616256,16777216,67584,16777216,215040,15,8192,0,16777216,705536,6165504,158976,10240,1058816,1079296,1099776,1120256,1140736,2762752,2783232,2798592,148480,3607552,99840,1024000,7594496,7764096,1351836,7956480,3770112,3770624,6242304,6258688,7874560,21120,45696,8355840,66,1351680,110592,6201344,262144,3770368,7594496,0,7733248,158848
.long 2831872,3616640,16777216,68352,188416,188416,9,8192,0,16777216,706048,6168064,159104,15360,1063936,1084416,1104896,1125376,1145856,2767872,2788352,2800640,150528,3609088,148992,1044480,7594752,7764160,1372316,7961600,3770880,3771904,6283264,6299648,7879680,16798336,16822912,25133056,67,1372160,114688,6221824,262144,3771392,7594752,0,7733248,158912
.long 2982912,3639296,74368,65536,237568,212992,15,8192,0,712704,712704,6815744,158720,0,1048576,1069056,1089536,1110016,1130496,2752512,2772992,2793472,143360,3604480,2304,1474560,7655424,7779328,1966236,7946240,3784576,3785088,6815744,6832128,7864320,960,10176,8478720,96,1966080,102400,6815744,262144,3784704,7655424,0,7733248,158720
.long 2985472,3639680,16777216,66560,99840,98304,15,8192,0,16777216,713216,6818304,158848,5120,1053696,1074176,1094656,1115136,1135616,2757632,2778112,2795520,145408,3606016,51456,1495040,7655680,7779392,1986716,7951360,3785344,3786368,6856704,6873088,7869440,6080,15296,8478976,97,1986560,106496,6836224,262144,3785728,7655680,0,7733248,158784
.long 3034112,3646976,16777216,67584,16777216,215040,15,8192,0,16777216,713728,6820864,158976,10240,1058816,1079296,1099776,1120256,1140736,2762752,2783232,2798592,148480,3607552,100608,1515520,7655936,7779456,2007196,7956480,3786496,3787008,6897664,6914048,7874560,21440,46016,8560640,98,2007040,110592,6856704,262144,3786752,7655936,0,7733248,158848
.long 3036672,3647360,16777216,68352,200704,200704,9,8192,0,16777216,714240,6823424,159104,15360,1063936,1084416,1104896,1125376,1145856,2767872,2788352,2800640,150528,3609088,149760,1536000,7656192,7779520,2027676,7961600,3787264,3788288,6938624,6955008,7879680,16798656,16823232,25337856,99,2027520,114688,6877184,262144,3787776,7656192,0,7733248,158912
.long 3162112,3666176,81920,81920,217088,212992,15,0,2048,689152,688128,4931584,158720,0,1867776,1888256,1908736,1929216,1949696,3162112,3182592,3203072,143360,3665920,384,245760,7501824,7740928,82076,7956480,4259712,4260224,4857856,4868096,7864320,160,9376,7966720,4,81920,102400,4931584,278528,4259840,7501824,0,7733248,158976
.long 3164672,3666560,16777216,82944,114688,114688,15,0,2048,16777216,688640,4934144,158848,5120,1872896,1893376,1913856,1934336,1954816,3167232,3187712,3205120,145408,3667456,49536,266240,7502080,7740992,102556,7961600,4260480,4261504,4898816,4909056,7869440,5280,14496,7966976,5,102400,106496,4952064,278528,4260864,7502080,0,7733248,159040
.long 3213312,3673856,16777216,83968,16777216,215040,15,0,2048,16777216,689152,4936704,158976,10240,1878016,1898496,1918976,1939456,1959936,3172352,3192832,3208192,148480,3668992,98688,286720,7502336,7741056,123036,7946240,4261632,4262144,4939776,4950016,7874560,20640,45216,8048640,6,122880,110592,4972544,278528,4261888,7502336,0,7733248,159104
.long 3215872,3674240,16777216,84736,169984,169984,9,0,2048,16777216,689664,4939264,159104,15360,1883136,1903616,1924096,1944576,1965056,3177472,3197952,3210240,150528,3670528,147840,307200,7502592,7741120,143516,7951360,4262400,4263424,4980736,4990976,7879680,16797856,16822432,24825856,7,143360,114688,4993024,278528,4262912,7502592,0,7733248,159168
.long 3366912,3696896,90112,81920,225280,212992,15,0,2048,697344,696320,5586944,158720,0,1867776,1888256,1908736,1929216,1949696,3162112,3182592,3203072,143360,3665920,1152,737280,7563264,7756288,737436,7956480,4276096,4276608,5513216,5523456,7864320,480,9696,8171520,36,737280,102400,5586944,278528,4276224,7563264,0,7733248,158976
.long 3369472,3697280,16777216,82944,115200,114688,15,0,2048,16777216,696832,5589504,158848,5120,1872896,1893376,1913856,1934336,1954816,3167232,3187712,3205120,145408,3667456,50304,757760,7563520,7756352,757916,7961600,4276864,4277888,5554176,5564416,7869440,5600,14816,8171776,37,757760,106496,5607424,278528,4277248,7563520,0,7733248,159040
.long 3418112,3704576,16777216,83968,16777216,215040,15,0,2048,16777216,697344,5592064,158976,10240,1878016,1898496,1918976,1939456,1959936,3172352,3192832,3208192,148480,3668992,99456,778240,7563776,7756416,778396,7946240,4278016,4278528,5595136,5605376,7874560,20960,45536,8253440,38,778240,110592,5627904,278528,4278272,7563776,0,7733248,159104
.long 3420672,3704960,16777216,84736,182272,182272,9,0,2048,16777216,697856,5594624,159104,15360,1883136,1903616,1924096,1944576,1965056,3177472,3197952,3210240,150528,3670528,148608,798720,7564032,7756480,798876,7951360,4278784,4279808,5636096,5646336,7879680,16798176,16822752,25030656,39,798720,114688,5648384,278528,4279296,7564032,0,7733248,159168
.long 3187712,3670016,82560,81920,233472,212992,15,0,2048,705536,704512,6242304,158720,0,1867776,1888256,1908736,1929216,1949696,3162112,3182592,3203072,143360,3665920,1920,1228800,7624704,7771648,1392796,7956480,4292480,4292992,6168576,6178816,7864320,800,10016,8376320,68,1392640,102400,6242304,278528,4292608,7624704,0,7733248,158976
.long 3190272,3670400,16777216,82944,115712,114688,15,0,2048,16777216,705024,6244864,158848,5120,1872896,1893376,1913856,1934336,1954816,3167232,3187712,3205120,145408,3667456,51072,1249280,7624960,7771712,1413276,7961600,4293248,4294272,6209536,6219776,7869440,5920,15136,8376576,69,1413120,106496,6262784,278528,4293632,7624960,0,7733248,159040
.long 3238912,3677696,16777216,83968,16777216,215040,15,0,2048,16777216,705536,6247424,158976,10240,1878016,1898496,1918976,1939456,1959936,3172352,3192832,3208192,148480,3668992,100224,1269760,7625216,7771776,1433756,7946240,4294400,4294912,6250496,6260736,7874560,21280,45856,8458240,70,1433600,110592,6283264,278528,4294656,7625216,0,7733248,159104
.long 3241472,3678080,16777216,84736,194560,194560,9,0,2048,16777216,706048,6249984,159104,15360,1883136,1903616,1924096,1944576,1965056,3177472,3197952,3210240,150528,3670528,149376,1290240,7625472,7771840,1454236,7951360,4295168,4296192,6291456,6301696,7879680,16798496,16823072,25235456,71,1454080,114688,6303744,278528,4295680,7625472,0,7733248,159168
.long 3392512,3700736,90752,81920,241664,212992,15,0,2048,713728,712704,6897664,158720,0,1867776,1888256,1908736,1929216,1949696,3162112,3182592,3203072,143360,3665920,2688,1720320,7686144,7787008,2048156,7956480,4308864,4309376,6823936,6834176,7864320,1120,10336,8581120,100,2048000,102400,6897664,278528,4308992,7686144,0,7733248,158976
.long 3395072,3701120,16777216,82944,116224,114688,15,0,2048,16777216,713216,6900224,158848,5120,1872896,1893376,1913856,1934336,1954816,3167232,3187712,3205120,145408,3667456,51840,1740800,7686400,7787072,2068636,7961600,4309632,4310656,6864896,6875136,7869440,6240,15456,8581376,101,2068480,106496,6918144,278528,4310016,7686400,0,7733248,159040
.long 3443712,3708416,16777216,83968,16777216,215040,15,0,2048,16777216,713728,6902784,158976,10240,1878016,1898496,1918976,1939456,1959936,3172352,3192832,3208192,148480,3668992,100992,1761280,7686656,7787136,2089116,7946240,4310784,4311296,6905856,6916096,7874560,21600,46176,8663040,102,2088960,110592,6938624,278528,4311040,7686656,0,7733248,159104
.long 3446272,3708800,16777216,84736,206848,206848,9,0,2048,16777216,714240,6905344,159104,15360,1883136,1903616,1924096,1944576,1965056,3177472,3197952,3210240,150528,3670528,150144,1781760,7686912,7787200,2109596,7951360,4311552,4312576,6946816,6957056,7879680,16798816,16823392,25440256,103,2109440,114688,6959104,278528,4312064,7686912,0,7733248,159168
.long 2854912,3620096,69632,65536,217216,217088,15,8192,0,688256,688128,4859904,158720,0,1171456,1150976,1212416,1191936,1243136,2813952,2834432,2849792,143360,3612160,196608,128,7472128,7733504,10396,8048640,3800960,3801472,4850688,4866304,7966720,25760,34976,7967232,0,160,102400,4849664,264192,3801088,7471104,128,7733568,158720
.long 2857472,3620480,16777216,66560,100352,100352,15,8192,0,16777216,688640,4862464,158848,5120,1176576,1156096,1217536,1197056,1248256,2819072,2839552,2851840,145408,3613696,245760,20608,7472384,7733568,30876,8053760,3801728,3802752,4891648,4907264,7971840,30880,40096,7967488,1,20640,106496,4870144,264192,3802112,7471360,128,7733568,158784
.long 2906112,3627776,16777216,67584,16777216,219136,15,8192,0,16777216,689152,4865024,158976,10240,1181696,1161216,1222656,1202176,1232896,2803712,2824192,2844672,148480,3615232,294912,41088,7472640,7733632,51356,8058880,3802880,3803392,4932608,4948224,7976960,16797856,16822432,24825856,2,41120,110592,4890624,264192,3803136,7471616,128,7733568,158848
.long 2908672,3628160,16777216,68352,163968,163840,9,8192,0,16777216,689664,4867584,159104,15360,1186816,1166336,1227776,1207296,1238016,2808832,2829312,2846720,150528,3616768,344064,61568,7472896,7733696,71836,8064000,3803648,3804672,4973568,4989184,7982080,16797856,16822432,24825856,3,61600,114688,4911104,264192,3804160,7471872,128,7733568,158912
.long 3059712,3650816,77824,65536,225408,217088,15,8192,0,696448,696320,5515264,158720,0,1171456,1150976,1212416,1191936,1243136,2813952,2834432,2849792,143360,3612160,197376,491648,7533568,7748864,665756,8048640,3817344,3817856,5506048,5521664,7966720,26080,35296,8172032,32,655520,102400,5505024,264192,3817472,7532544,128,7733568,158720
.long 3062272,3651200,16777216,66560,100864,100352,15,8192,0,16777216,696832,5517824,158848,5120,1176576,1156096,1217536,1197056,1248256,2819072,2839552,2851840,145408,3613696,246528,512128,7533824,7748928,686236,8053760,3818112,3819136,5547008,5562624,7971840,31200,40416,8172288,33,676000,106496,5525504,264192,3818496,7532800,128,7733568,158784
.long 3110912,3658496,16777216,67584,16777216,219136,15,8192,0,16777216,697344,5520384,158976,10240,1181696,1161216,1222656,1202176,1232896,2803712,2824192,2844672,148480,3615232,295680,532608,7534080,7748992,706716,8058880,3819264,3819776,5587968,5603584,7976960,16798176,16822752,25030656,34,696480,110592,5545984,264192,3819520,7533056,128,7733568,158848
.long 3113472,3658880,16777216,68352,176256,176128,9,8192,0,16777216,697856,5522944,159104,15360,1186816,1166336,1227776,1207296,1238016,2808832,2829312,2846720,150528,3616768,344832,553088,7534336,7749056,727196,8064000,3820032,3821056,5628928,5644544,7982080,16798176,16822752,25030656,35,716960,114688,5566464,264192,3820544,7533312,128,7733568,158912
.long 2880512,3623936,70272,65536,233600,217088,15,8192,0,704640,704512,6170624,158720,0,1171456,1150976,1212416,1191936,1243136,2813952,2834432,2849792,143360,3612160,198144,983168,7595008,7764224,1321116,8048640,3833728,3834240,6161408,6177024,7966720,26400,35616,8376832,64,1310880,102400,6160384,264192,3833856,7593984,128,7733568,158720
.long 2883072,3624320,16777216,66560,101376,100352,15,8192,0,16777216,705024,6173184,158848,5120,1176576,1156096,1217536,1197056,1248256,2819072,2839552,2851840,145408,3613696,247296,1003648,7595264,7764288,1341596,8053760,3834496,3835520,6202368,6217984,7971840,31520,40736,8377088,65,1331360,106496,6180864,264192,3834880,7594240,128,7733568,158784
.long 2931712,3631616,16777216,67584,16777216,219136,15,8192,0,16777216,705536,6175744,158976,10240,1181696,1161216,1222656,1202176,1232896,2803712,2824192,2844672,148480,3615232,296448,1024128,7595520,7764352,1362076,8058880,3835648,3836160,6243328,6258944,7976960,16798496,16823072,25235456,66,1351840,110592,6201344,264192,3835904,7594496,128,7733568,158848
.long 2934272,3632000,16777216,68352,188544,188416,9,8192,0,16777216,706048,6178304,159104,15360,1186816,1166336,1227776,1207296,1238016,2808832,2829312,2846720,150528,3616768,345600,1044608,7595776,7764416,1382556,8064000,3836416,3837440,6284288,6299904,7982080,16798496,16823072,25235456,67,1372320,114688,6221824,264192,3836928,7594752,128,7733568,158912
.long 3085312,3654656,78464,65536,241792,217088,15,8192,0,712832,712704,6825984,158720,0,1171456,1150976,1212416,1191936,1243136,2813952,2834432,2849792,143360,3612160,198912,1474688,7656448,7779584,1976476,8048640,3850112,3850624,6816768,6832384,7966720,26720,35936,8581632,96,1966240,102400,6815744,264192,3850240,7655424,128,7733568,158720
.long 3087872,3655040,16777216,66560,101888,100352,15,8192,0,16777216,713216,6828544,158848,5120,1176576,1156096,1217536,1197056,1248256,2819072,2839552,2851840,145408,3613696,248064,1495168,7656704,7779648,1996956,8053760,3850880,3851904,6857728,6873344,7971840,31840,41056,8581888,97,1986720,106496,6836224,264192,3851264,7655680,128,7733568,158784
.long 3136512,3662336,16777216,67584,16777216,219136,15,8192,0,16777216,713728,6831104,158976,10240,1181696,1161216,1222656,1202176,1232896,2803712,2824192,2844672,148480,3615232,297216,1515648,7656960,7779712,2017436,8058880,3852032,3852544,6898688,6914304,7976960,16798816,16823392,25440256,98,2007200,110592,6856704,264192,3852288,7655936,128,7733568,158848
.long 3139072,3662720,16777216,68352,200832,200704,9,8192,0,16777216,714240,6833664,159104,15360,1186816,1166336,1227776,1207296,1238016,2808832,2829312,2846720,150528,3616768,346368,1536128,7657216,7779776,2037916,8064000,3852800,3853824,6939648,6955264,7982080,16798816,16823392,25440256,99,2027680,114688,6877184,264192,3853312,7656192,128,7733568,158912
.long 3264512,3681536,86016,81920,221312,217088,15,0,2048,689280,688128,4941824,158720,0,1990656,1970176,2031616,2011136,2062336,3223552,3244032,3259392,143360,3673600,196992,245888,7502848,7741184,92316,8058880,4325248,4325760,4858880,4868352,7966720,25920,35136,8069632,4,82080,102400,4931584,280576,4325376,7501824,128,7733568,158976
.long 3267072,3681920,16777216,82944,116736,116736,15,0,2048,16777216,688640,4944384,158848,5120,1995776,1975296,2036736,2016256,2067456,3228672,3249152,3261440,145408,3675136,246144,266368,7503104,7741248,112796,8064000,4326016,4327040,4899840,4909312,7971840,31040,40256,8069888,5,102560,106496,4952064,280576,4326400,7502080,128,7733568,159040
.long 3315712,3689216,16777216,83968,16777216,219136,15,0,2048,16777216,689152,4946944,158976,10240,2000896,1980416,2041856,2021376,2052096,3213312,3233792,3254272,148480,3676672,295296,286848,7503360,7741312,133276,8048640,4327168,4327680,4940800,4950272,7976960,16798016,16822592,24928256,6,123040,110592,4972544,280576,4327424,7502336,128,7733568,159104
.long 3318272,3689600,16777216,84736,170112,169984,9,0,2048,16777216,689664,4949504,159104,15360,2006016,1985536,2046976,2026496,2057216,3218432,3238912,3256320,150528,3678208,344448,307328,7503616,7741376,153756,8053760,4327936,4328960,4981760,4991232,7982080,16798016,16822592,24928256,7,143520,114688,4993024,280576,4328448,7502592,128,7733568,159168
.long 3469312,3712256,94208,81920,229504,217088,15,0,2048,697472,696320,5597184,158720,0,1990656,1970176,2031616,2011136,2062336,3223552,3244032,3259392,143360,3673600,197760,737408,7564288,7756544,747676,8058880,4341632,4342144,5514240,5523712,7966720,26240,35456,8274432,36,737440,102400,5586944,280576,4341760,7563264,128,7733568,158976
.long 3471872,3712640,16777216,82944,117248,116736,15,0,2048,16777216,696832,5599744,158848,5120,1995776,1975296,2036736,2016256,2067456,3228672,3249152,3261440,145408,3675136,246912,757888,7564544,7756608,768156,8064000,4342400,4343424,5555200,5564672,7971840,31360,40576,8274688,37,757920,106496,5607424,280576,4342784,7563520,128,7733568,159040
.long 3520512,3719936,16777216,83968,16777216,219136,15,0,2048,16777216,697344,5602304,158976,10240,2000896,1980416,2041856,2021376,2052096,3213312,3233792,3254272,148480,3676672,296064,778368,7564800,7756672,788636,8048640,4343552,4344064,5596160,5605632,7976960,16798336,16822912,25133056,38,778400,110592,5627904,280576,4343808,7563776,128,7733568,159104
.long 3523072,3720320,16777216,84736,182400,182272,9,0,2048,16777216,697856,5604864,159104,15360,2006016,1985536,2046976,2026496,2057216,3218432,3238912,3256320,150528,3678208,345216,798848,7565056,7756736,809116,8053760,4344320,4345344,5637120,5646592,7982080,16798336,16822912,25133056,39,798880,114688,5648384,280576,4344832,7564032,128,7733568,159168
.long 3290112,3685376,86656,81920,237696,217088,15,0,2048,705664,704512,6252544,158720,0,1990656,1970176,2031616,2011136,2062336,3223552,3244032,3259392,143360,3673600,198528,1228928,7625728,7771904,1403036,8058880,4358016,4358528,6169600,6179072,7966720,26560,35776,8479232,68,1392800,102400,6242304,280576,4358144,7624704,128,7733568,158976
.long 3292672,3685760,16777216,82944,117760,116736,15,0,2048,16777216,705024,6255104,158848,5120,1995776,1975296,2036736,2016256,2067456,3228672,3249152,3261440,145408,3675136,247680,1249408,7625984,7771968,1423516,8064000,4358784,4359808,6210560,6220032,7971840,31680,40896,8479488,69,1413280,106496,6262784,280576,4359168,7624960,128,7733568,159040
.long 3341312,3693056,16777216,83968,16777216,219136,15,0,2048,16777216,705536,6257664,158976,10240,2000896,1980416,2041856,2021376,2052096,3213312,3233792,3254272,148480,3676672,296832,1269888,7626240,7772032,1443996,8048640,4359936,4360448,6251520,6260992,7976960,16798656,16823232,25337856,70,1433760,110592,6283264,280576,4360192,7625216,128,7733568,159104
.long 3343872,3693440,16777216,84736,194688,194560,9,0,2048,16777216,706048,6260224,159104,15360,2006016,1985536,2046976,2026496,2057216,3218432,3238912,3256320,150528,3678208,345984,1290368,7626496,7772096,1464476,8053760,4360704,4361728,6292480,6301952,7982080,16798656,16823232,25337856,71,1454240,114688,6303744,280576,4361216,7625472,128,7733568,159168
.long 3494912,3716096,94848,81920,213120,217088,15,0,2048,713856,712704,6907904,158720,0,1990656,1970176,2031616,2011136,2062336,3223552,3244032,3259392,143360,3673600,199296,1720448,7687168,7787264,2058396,8058880,4374400,4374912,6824960,6834432,7966720,25600,34816,7864832,100,2048160,102400,6897664,280576,4374528,7686144,128,7733568,158976
.long 3497472,3716480,16777216,82944,118272,116736,15,0,2048,16777216,713216,6910464,158848,5120,1995776,1975296,2036736,2016256,2067456,3228672,3249152,3261440,145408,3675136,248448,1740928,7687424,7787328,2078876,8064000,4375168,4376192,6865920,6875392,7971840,30720,39936,7865088,101,2068640,106496,6918144,280576,4375552,7686400,128,7733568,159040
.long 3546112,3723776,16777216,83968,16777216,219136,15,0,2048,16777216,713728,6913024,158976,10240,2000896,1980416,2041856,2021376,2052096,3213312,3233792,3254272,148480,3676672,297600,1761408,7687680,7787392,2099356,8048640,4376320,4376832,6906880,6916352,7976960,16797696,16822272,24723456,102,2089120,110592,6938624,280576,4376576,7686656,128,7733568,159104
.long 3548672,3724160,16777216,84736,206976,206848,9,0,2048,16777216,714240,6915584,159104,15360,2006016,1985536,2046976,2026496,2057216,3218432,3238912,3256320,150528,3678208,346752,1781888,7687936,7787456,2119836,8053760,4377088,4378112,6947840,6957312,7982080,16797696,16822272,24723456,103,2109600,114688,6959104,280576,4377600,7686912,128,7733568,159168
.long 2757632,3605504,65664,69632,221440,221184,15,8192,0,688384,688128,4870144,158720,0,1294336,1314816,1253376,1273856,1335296,2875392,2854912,2895872,143360,3619840,393216,256,7473152,7733760,476,8151040,3866496,3867008,4851712,4866560,8069120,51520,60736,8074240,0,320,102400,4849664,266240,3866624,7471104,256,7733888,158720
.long 2760192,3605888,16777216,70656,102400,102400,15,8192,0,16777216,688640,4872704,158848,5120,1299456,1319936,1258496,1278976,1340416,2880512,2860032,2897920,145408,3621376,442368,20736,7473408,7733824,20956,8156160,3867264,3868288,4892672,4907520,8074240,56640,65856,8074496,1,20800,106496,4870144,266240,3867648,7471360,256,7733888,158784
.long 2808832,3613184,16777216,71680,16777216,223232,15,8192,0,16777216,689152,4875264,158976,10240,1304576,1325056,1263616,1284096,1345536,2885632,2865152,2900992,148480,3622912,491520,41216,7473664,7733888,41436,8161280,3868416,3868928,4933632,4948480,8079360,72000,96576,8151296,2,41280,110592,4890624,266240,3868672,7471616,256,7733888,158848
.long 2811392,3613568,16777216,72448,164096,163840,9,8192,0,16777216,689664,4877824,159104,15360,1309696,1330176,1268736,1289216,1350656,2890752,2870272,2903040,150528,3624448,540672,61696,7473920,7733952,61916,8166400,3869184,3870208,4974592,4989440,8084480,16849216,16873792,24928512,3,61760,114688,4911104,266240,3869696,7471872,256,7733888,158912
.long 2962432,3636224,73856,69632,229632,221184,15,8192,0,696576,696320,5525504,158720,0,1294336,1314816,1253376,1273856,1335296,2875392,2854912,2895872,143360,3619840,393984,491776,7534592,7749120,655836,8151040,3882880,3883392,5507072,5521920,8069120,51840,61056,8279040,32,655680,102400,5505024,266240,3883008,7532544,256,7733888,158720
.long 2964992,3636608,16777216,70656,102912,102400,15,8192,0,16777216,696832,5528064,158848,5120,1299456,1319936,1258496,1278976,1340416,2880512,2860032,2897920,145408,3621376,443136,512256,7534848,7749184,676316,8156160,3883648,3884672,5548032,5562880,8074240,56960,66176,8279296,33,676160,106496,5525504,266240,3884032,7532800,256,7733888,158784
.long 3013632,3643904,16777216,71680,16777216,223232,15,8192,0,16777216,697344,5530624,158976,10240,1304576,1325056,1263616,1284096,1345536,2885632,2865152,2900992,148480,3622912,492288,532736,7535104,7749248,696796,8161280,3884800,3885312,5588992,5603840,8079360,72320,96896,8356096,34,696640,110592,5545984,266240,3885056,7533056,256,7733888,158848
.long 3016192,3644288,16777216,72448,176384,176128,9,8192,0,16777216,697856,5533184,159104,15360,1309696,1330176,1268736,1289216,1350656,2890752,2870272,2903040,150528,3624448,541440,553216,7535360,7749312,717276,8166400,3885568,3886592,5629952,5644800,8084480,16849536,16874112,25133312,35,717120,114688,5566464,266240,3886080,7533312,256,7733888,158912
.long 2783232,3609344,66304,69632,237824,221184,15,8192,0,704768,704512,6180864,158720,0,1294336,1314816,1253376,1273856,1335296,2875392,2854912,2895872,143360,3619840,394752,983296,7596032,7764480,1311196,8151040,3899264,3899776,6162432,6177280,8069120,52160,61376,8483840,64,1311040,102400,6160384,266240,3899392,7593984,256,7733888,158720
.long 2785792,3609728,16777216,70656,103424,102400,15,8192,0,16777216,705024,6183424,158848,5120,1299456,1319936,1258496,1278976,1340416,2880512,2860032,2897920,145408,3621376,443904,1003776,7596288,7764544,1331676,8156160,3900032,3901056,6203392,6218240,8074240,57280,66496,8484096,65,1331520,106496,6180864,266240,3900416,7594240,256,7733888,158784
.long 2834432,3617024,16777216,71680,16777216,223232,15,8192,0,16777216,705536,6185984,158976,10240,1304576,1325056,1263616,1284096,1345536,2885632,2865152,2900992,148480,3622912,493056,1024256,7596544,7764608,1352156,8161280,3901184,3901696,6244352,6259200,8079360,72640,97216,8560896,66,1352000,110592,6201344,266240,3901440,7594496,256,7733888,158848
.long 2836992,3617408,16777216,72448,188672,188416,9,8192,0,16777216,706048,6188544,159104,15360,1309696,1330176,1268736,1289216,1350656,2890752,2870272,2903040,150528,3624448,542208,1044736,7596800,7764672,1372636,8166400,3901952,3902976,6285312,6300160,8084480,16849856,16874432,25338112,67,1372480,114688,6221824,266240,3902464,7594752,256,7733888,158912
.long 2988032,3640064,74496,69632,213248,221184,15,8192,0,712960,712704,6836224,158720,0,1294336,1314816,1253376,1273856,1335296,2875392,2854912,2895872,143360,3619840,395520,1474816,7657472,7779840,1966556,8151040,3915648,3916160,6817792,6832640,8069120,51200,60416,7869440,96,1966400,102400,6815744,266240,3915776,7655424,256,7733888,158720
.long 2990592,3640448,16777216,70656,103936,102400,15,8192,0,16777216,713216,6838784,158848,5120,1299456,1319936,1258496,1278976,1340416,2880512,2860032,2897920,145408,3621376,444672,1495296,7657728,7779904,1987036,8156160,3916416,3917440,6858752,6873600,8074240,56320,65536,7869696,97,1986880,106496,6836224,266240,3916800,7655680,256,7733888,158784
.long 3039232,3647744,16777216,71680,16777216,223232,15,8192,0,16777216,713728,6841344,158976,10240,1304576,1325056,1263616,1284096,1345536,2885632,2865152,2900992,148480,3622912,493824,1515776,7657984,7779968,2007516,8161280,3917568,3918080,6899712,6914560,8079360,71680,96256,7946496,98,2007360,110592,6856704,266240,3917824,7655936,256,7733888,158848
.long 3041792,3648128,16777216,72448,200960,200704,9,8192,0,16777216,714240,6843904,159104,15360,1309696,1330176,1268736,1289216,1350656,2890752,2870272,2903040,150528,3624448,542976,1536256,7658240,7780032,2027996,8166400,3918336,3919360,6940672,6955520,8084480,16848896,16873472,24723712,99,2027840,114688,6877184,266240,3918848,7656192,256,7733888,158912
.long 3167232,3666944,82048,86016,225536,221184,15,0,2048,689408,688128,4952064,158720,0,2113536,2134016,2072576,2093056,2154496,3284992,3264512,3305472,143360,3681280,393600,246016,7503872,7741440,82396,8161280,4390784,4391296,4859904,4868608,8069120,51680,60896,8176640,4,82240,102400,4931584,282624,4390912,7501824,256,7733888,158976
.long 3169792,3667328,16777216,87040,118784,118784,15,0,2048,16777216,688640,4954624,158848,5120,2118656,2139136,2077696,2098176,2159616,3290112,3269632,3307520,145408,3682816,442752,266496,7504128,7741504,102876,8166400,4391552,4392576,4900864,4909568,8074240,56800,66016,8176896,5,102720,106496,4952064,282624,4391936,7502080,256,7733888,159040
.long 3218432,3674624,16777216,88064,16777216,223232,15,0,2048,16777216,689152,4957184,158976,10240,2123776,2144256,2082816,2103296,2164736,3295232,3274752,3310592,148480,3684352,491904,286976,7504384,7741568,123356,8151040,4392704,4393216,4941824,4950528,8079360,72160,96736,8253696,6,123200,110592,4972544,282624,4392960,7502336,256,7733888,159104
.long 3220992,3675008,16777216,88832,170240,169984,9,0,2048,16777216,689664,4959744,159104,15360,2128896,2149376,2087936,2108416,2169856,3300352,3279872,3312640,150528,3685888,541056,307456,7504640,7741632,143836,8156160,4393472,4394496,4982784,4991488,8084480,16849376,16873952,25030912,7,143680,114688,4993024,282624,4393984,7502592,256,7733888,159168
.long 3372032,3697664,90240,86016,233728,221184,15,0,2048,697600,696320,5607424,158720,0,2113536,2134016,2072576,2093056,2154496,3284992,3264512,3305472,143360,3681280,394368,737536,7565312,7756800,737756,8161280,4407168,4407680,5515264,5523968,8069120,52000,61216,8381440,36,737600,102400,5586944,282624,4407296,7563264,256,7733888,158976
.long 3374592,3698048,16777216,87040,119296,118784,15,0,2048,16777216,696832,5609984,158848,5120,2118656,2139136,2077696,2098176,2159616,3290112,3269632,3307520,145408,3682816,443520,758016,7565568,7756864,758236,8166400,4407936,4408960,5556224,5564928,8074240,57120,66336,8381696,37,758080,106496,5607424,282624,4408320,7563520,256,7733888,159040
.long 3423232,3705344,16777216,88064,16777216,223232,15,0,2048,16777216,697344,5612544,158976,10240,2123776,2144256,2082816,2103296,2164736,3295232,3274752,3310592,148480,3684352,492672,778496,7565824,7756928,778716,8151040,4409088,4409600,5597184,5605888,8079360,72480,97056,8458496,38,778560,110592,5627904,282624,4409344,7563776,256,7733888,159104
.long 3425792,3705728,16777216,88832,182528,182272,9,0,2048,16777216,697856,5615104,159104,15360,2128896,2149376,2087936,2108416,2169856,3300352,3279872,3312640,150528,3685888,541824,798976,7566080,7756992,799196,8156160,4409856,4410880,5638144,5646848,8084480,16849696,16874272,25235712,39,799040,114688,5648384,282624,4410368,7564032,256,7733888,159168
.long 3192832,3670784,82688,86016,241920,221184,15,0,2048,705792,704512,6262784,158720,0,2113536,2134016,2072576,2093056,2154496,3284992,3264512,3305472,143360,3681280,395136,1229056,7626752,7772160,1393116,8161280,4423552,4424064,6170624,6179328,8069120,52320,61536,8586240,68,1392960,102400,6242304,282624,4423680,7624704,256,7733888,158976
.long 3195392,3671168,16777216,87040,119808,118784,15,0,2048,16777216,705024,6265344,158848,5120,2118656,2139136,2077696,2098176,2159616,3290112,3269632,3307520,145408,3682816,444288,1249536,7627008,7772224,1413596,8166400,4424320,4425344,6211584,6220288,8074240,57440,66656,8586496,69,1413440,106496,6262784,282624,4424704,7624960,256,7733888,159040
.long 3244032,3678464,16777216,88064,16777216,223232,15,0,2048,16777216,705536,6267904,158976,10240,2123776,2144256,2082816,2103296,2164736,3295232,3274752,3310592,148480,3684352,493440,1270016,7627264,7772288,1434076,8151040,4425472,4425984,6252544,6261248,8079360,72800,97376,8663296,70,1433920,110592,6283264,282624,4425728,7625216,256,7733888,159104
.long 3246592,3678848,16777216,88832,194816,194560,9,0,2048,16777216,706048,6270464,159104,15360,2128896,2149376,2087936,2108416,2169856,3300352,3279872,3312640,150528,3685888,542592,1290496,7627520,7772352,1454556,8156160,4426240,4427264,6293504,6302208,8084480,16850016,16874592,25440512,71,1454400,114688,6303744,282624,4426752,7625472,256,7733888,159168
.long 3397632,3701504,90880,86016,217344,221184,15,0,2048,713984,712704,6918144,158720,0,2113536,2134016,2072576,2093056,2154496,3284992,3264512,3305472,143360,3681280,395904,1720576,7688192,7787520,2048476,8161280,4439936,4440448,6825984,6834688,8069120,51360,60576,7971840,100,2048320,102400,6897664,282624,4440064,7686144,256,7733888,158976
.long 3400192,3701888,16777216,87040,120320,118784,15,0,2048,16777216,713216,6920704,158848,5120,2118656,2139136,2077696,2098176,2159616,3290112,3269632,3307520,145408,3682816,445056,1741056,7688448,7787584,2068956,8166400,4440704,4441728,6866944,6875648,8074240,56480,65696,7972096,101,2068800,106496,6918144,282624,4441088,7686400,256,7733888,159040
.long 3448832,3709184,16777216,88064,16777216,223232,15,0,2048,16777216,713728,6923264,158976,10240,2123776,2144256,2082816,2103296,2164736,3295232,3274752,3310592,148480,3684352,494208,1761536,7688704,7787648,2089436,8151040,4441856,4442368,6907904,6916608,8079360,71840,96416,8048896,102,2089280,110592,6938624,282624,4442112,7686656,256,7733888,159104
.long 3451392,3709568,16777216,88832,207104,206848,9,0,2048,16777216,714240,6925824,159104,15360,2128896,2149376,2087936,2108416,2169856,3300352,3279872,3312640,150528,3685888,543360,1782016,7688960,7787712,2109916,8156160,4442624,4443648,6948864,6957568,8084480,16849056,16873632,24826112,103,2109760,114688,6959104,282624,4443136,7686912,256,7733888,159168
.long 2860032,3620864,69760,69632,225664,225280,15,8192,0,688512,688128,4880384,158720,0,1417216,1396736,1376256,1355776,1447936,2936832,2916352,2952192,143360,3627520,589824,384,7474176,7734016,10716,8253440,3932032,3932544,4852736,4866816,8171520,77280,86496,8177152,0,480,102400,4849664,268288,3932160,7471104,384,7734208,158720
.long 2862592,3621248,16777216,70656,104448,104448,15,8192,0,16777216,688640,4882944,158848,5120,1422336,1401856,1381376,1360896,1453056,2941952,2921472,2954240,145408,3629056,638976,20864,7474432,7734080,31196,8258560,3932800,3933824,4893696,4907776,8176640,82400,91616,8177408,1,20960,106496,4870144,268288,3933184,7471360,384,7734208,158784
.long 2911232,3628544,16777216,71680,16777216,227328,15,8192,0,16777216,689152,4885504,158976,10240,1427456,1406976,1386496,1366016,1437696,2926592,2906112,2947072,148480,3630592,688128,41344,7474688,7734144,51676,8263680,3933952,3934464,4934656,4948736,8181760,16849376,16873952,25030912,2,41440,110592,4890624,268288,3934208,7471616,384,7734208,158848
.long 2913792,3628928,16777216,72448,164224,163840,9,8192,0,16777216,689664,4888064,159104,15360,1432576,1412096,1391616,1371136,1442816,2931712,2911232,2949120,150528,3632128,737280,61824,7474944,7734208,72156,8268800,3934720,3935744,4975616,4989696,8186880,16849376,16873952,25030912,3,61920,114688,4911104,268288,3935232,7471872,384,7734208,158912
.long 3064832,3651584,77952,69632,233856,225280,15,8192,0,696704,696320,5535744,158720,0,1417216,1396736,1376256,1355776,1447936,2936832,2916352,2952192,143360,3627520,590592,491904,7535616,7749376,666076,8253440,3948416,3948928,5508096,5522176,8171520,77600,86816,8381952,32,655840,102400,5505024,268288,3948544,7532544,384,7734208,158720
.long 3067392,3651968,16777216,70656,104960,104448,15,8192,0,16777216,696832,5538304,158848,5120,1422336,1401856,1381376,1360896,1453056,2941952,2921472,2954240,145408,3629056,639744,512384,7535872,7749440,686556,8258560,3949184,3950208,5549056,5563136,8176640,82720,91936,8382208,33,676320,106496,5525504,268288,3949568,7532800,384,7734208,158784
.long 3116032,3659264,16777216,71680,16777216,227328,15,8192,0,16777216,697344,5540864,158976,10240,1427456,1406976,1386496,1366016,1437696,2926592,2906112,2947072,148480,3630592,688896,532864,7536128,7749504,707036,8263680,3950336,3950848,5590016,5604096,8181760,16849696,16874272,25235712,34,696800,110592,5545984,268288,3950592,7533056,384,7734208,158848
.long 3118592,3659648,16777216,72448,176512,176128,9,8192,0,16777216,697856,5543424,159104,15360,1432576,1412096,1391616,1371136,1442816,2931712,2911232,2949120,150528,3632128,738048,553344,7536384,7749568,727516,8268800,3951104,3952128,5630976,5645056,8186880,16849696,16874272,25235712,35,717280,114688,5566464,268288,3951616,7533312,384,7734208,158912
.long 2885632,3624704,70400,69632,242048,225280,15,8192,0,704896,704512,6191104,158720,0,1417216,1396736,1376256,1355776,1447936,2936832,2916352,2952192,143360,3627520,591360,983424,7597056,7764736,1321436,8253440,3964800,3965312,6163456,6177536,8171520,77920,87136,8586752,64,1311200,102400,6160384,268288,3964928,7593984,384,7734208,158720
.long 2888192,3625088,16777216,70656,105472,104448,15,8192,0,16777216,705024,6193664,158848,5120,1422336,1401856,1381376,1360896,1453056,2941952,2921472,2954240,145408,3629056,640512,1003904,7597312,7764800,1341916,8258560,3965568,3966592,6204416,6218496,8176640,83040,92256,8587008,65,1331680,106496,6180864,268288,3965952,7594240,384,7734208,158784
.long 2936832,3632384,16777216,71680,16777216,227328,15,8192,0,16777216,705536,6196224,158976,10240,1427456,1406976,1386496,1366016,1437696,2926592,2906112,2947072,148480,3630592,689664,1024384,7597568,7764864,1362396,8263680,3966720,3967232,6245376,6259456,8181760,16850016,16874592,25440512,66,1352160,110592,6201344,268288,3966976,7594496,384,7734208,158848
.long 2939392,3632768,16777216,72448,188800,188416,9,8192,0,16777216,706048,6198784,159104,15360,1432576,1412096,1391616,1371136,1442816,2931712,2911232,2949120,150528,3632128,738816,1044864,7597824,7764928,1382876,8268800,3967488,3968512,6286336,6300416,8186880,16850016,16874592,25440512,67,1372640,114688,6221824,268288,3968000,7594752,384,7734208,158912
.long 3090432,3655424,78592,69632,217472,225280,15,8192,0,713088,712704,6846464,158720,0,1417216,1396736,1376256,1355776,1447936,2936832,2916352,2952192,143360,3627520,592128,1474944,7658496,7780096,1976796,8253440,3981184,3981696,6818816,6832896,8171520,76960,86176,7972352,96,1966560,102400,6815744,268288,3981312,7655424,384,7734208,158720
.long 3092992,3655808,16777216,70656,105984,104448,15,8192,0,16777216,713216,6849024,158848,5120,1422336,1401856,1381376,1360896,1453056,2941952,2921472,2954240,145408,3629056,641280,1495424,7658752,7780160,1997276,8258560,3981952,3982976,6859776,6873856,8176640,82080,91296,7972608,97,1987040,106496,6836224,268288,3982336,7655680,384,7734208,158784
.long 3141632,3663104,16777216,71680,16777216,227328,15,8192,0,16777216,713728,6851584,158976,10240,1427456,1406976,1386496,1366016,1437696,2926592,2906112,2947072,148480,3630592,690432,1515904,7659008,7780224,2017756,8263680,3983104,3983616,6900736,6914816,8181760,16849056,16873632,24826112,98,2007520,110592,6856704,268288,3983360,7655936,384,7734208,158848
.long 3144192,3663488,16777216,72448,201088,200704,9,8192,0,16777216,714240,6854144,159104,15360,1432576,1412096,1391616,1371136,1442816,2931712,2911232,2949120,150528,3632128,739584,1536384,7659264,7780288,2038236,8268800,3983872,3984896,6941696,6955776,8186880,16849056,16873632,24826112,99,2028000,114688,6877184,268288,3984384,7656192,384,7734208,158912
.long 3269632,3682304,86144,86016,229760,225280,15,0,2048,689536,688128,4962304,158720,0,2236416,2215936,2195456,2174976,2267136,3346432,3325952,3361792,143360,3688960,590208,246144,7504896,7741696,92636,8263680,4456320,4456832,4860928,4868864,8171520,77440,86656,8279552,4,82400,102400,4931584,284672,4456448,7501824,384,7734208,158976
.long 3272192,3682688,16777216,87040,120832,120832,15,0,2048,16777216,688640,4964864,158848,5120,2241536,2221056,2200576,2180096,2272256,3351552,3331072,3363840,145408,3690496,639360,266624,7505152,7741760,113116,8268800,4457088,4458112,4901888,4909824,8176640,82560,91776,8279808,5,102880,106496,4952064,284672,4457472,7502080,384,7734208,159040
.long 3320832,3689984,16777216,88064,16777216,227328,15,0,2048,16777216,689152,4967424,158976,10240,2246656,2226176,2205696,2185216,2256896,3336192,3315712,3356672,148480,3692032,688512,287104,7505408,7741824,133596,8253440,4458240,4458752,4942848,4950784,8181760,16849536,16874112,25133312,6,123360,110592,4972544,284672,4458496,7502336,384,7734208,159104
.long 3323392,3690368,16777216,88832,170368,169984,9,0,2048,16777216,689664,4969984,159104,15360,2251776,2231296,2210816,2190336,2262016,3341312,3320832,3358720,150528,3693568,737664,307584,7505664,7741888,154076,8258560,4459008,4460032,4983808,4991744,8186880,16849536,16874112,25133312,7,143840,114688,4993024,284672,4459520,7502592,384,7734208,159168
.long 3474432,3713024,94336,86016,237952,225280,15,0,2048,697728,696320,5617664,158720,0,2236416,2215936,2195456,2174976,2267136,3346432,3325952,3361792,143360,3688960,590976,737664,7566336,7757056,747996,8263680,4472704,4473216,5516288,5524224,8171520,77760,86976,8484352,36,737760,102400,5586944,284672,4472832,7563264,384,7734208,158976
.long 3476992,3713408,16777216,87040,121344,120832,15,0,2048,16777216,696832,5620224,158848,5120,2241536,2221056,2200576,2180096,2272256,3351552,3331072,3363840,145408,3690496,640128,758144,7566592,7757120,768476,8268800,4473472,4474496,5557248,5565184,8176640,82880,92096,8484608,37,758240,106496,5607424,284672,4473856,7563520,384,7734208,159040
.long 3525632,3720704,16777216,88064,16777216,227328,15,0,2048,16777216,697344,5622784,158976,10240,2246656,2226176,2205696,2185216,2256896,3336192,3315712,3356672,148480,3692032,689280,778624,7566848,7757184,788956,8253440,4474624,4475136,5598208,5606144,8181760,16849856,16874432,25338112,38,778720,110592,5627904,284672,4474880,7563776,384,7734208,159104
.long 3528192,3721088,16777216,88832,182656,182272,9,0,2048,16777216,697856,5625344,159104,15360,2251776,2231296,2210816,2190336,2262016,3341312,3320832,3358720,150528,3693568,738432,799104,7567104,7757248,809436,8258560,4475392,4476416,5639168,5647104,8186880,16849856,16874432,25338112,39,799200,114688,5648384,284672,4475904,7564032,384,7734208,159168
.long 3295232,3686144,86784,86016,213376,225280,15,0,2048,705920,704512,6273024,158720,0,2236416,2215936,2195456,2174976,2267136,3346432,3325952,3361792,143360,3688960,591744,1229184,7627776,7772416,1403356,8263680,4489088,4489600,6171648,6179584,8171520,76800,86016,7869952,68,1393120,102400,6242304,284672,4489216,7624704,384,7734208,158976
.long 3297792,3686528,16777216,87040,121856,120832,15,0,2048,16777216,705024,6275584,158848,5120,2241536,2221056,2200576,2180096,2272256,3351552,3331072,3363840,145408,3690496,640896,1249664,7628032,7772480,1423836,8268800,4489856,4490880,6212608,6220544,8176640,81920,91136,7870208,69,1413600,106496,6262784,284672,4490240,7624960,384,7734208,159040
.long 3346432,3693824,16777216,88064,16777216,227328,15,0,2048,16777216,705536,6278144,158976,10240,2246656,2226176,2205696,2185216,2256896,3336192,3315712,3356672,148480,3692032,690048,1270144,7628288,7772544,1444316,8253440,4491008,4491520,6253568,6261504,8181760,16848896,16873472,24723712,70,1434080,110592,6283264,284672,4491264,7625216,384,7734208,159104
.long 3348992,3694208,16777216,88832,194944,194560,9,0,2048,16777216,706048,6280704,159104,15360,2251776,2231296,2210816,2190336,2262016,3341312,3320832,3358720,150528,3693568,739200,1290624,7628544,7772608,1464796,8258560,4491776,4492800,6294528,6302464,8186880,16848896,16873472,24723712,71,1454560,114688,6303744,284672,4492288,7625472,384,7734208,159168
.long 3500032,3716864,94976,86016,221568,225280,15,0,2048,714112,712704,6928384,158720,0,2236416,2215936,2195456,2174976,2267136,3346432,3325952,3361792,143360,3688960,592512,1720704,7689216,7787776,2058716,8263680,4505472,4505984,6827008,6834944,8171520,77120,86336,8074752,100,2048480,102400,6897664,284672,4505600,7686144,384,7734208,158976
.long 3502592,3717248,16777216,87040,122368,120832,15,0,2048,16777216,713216,6930944,158848,5120,2241536,2221056,2200576,2180096,2272256,3351552,3331072,3363840,145408,3690496,641664,1741184,7689472,7787840,2079196,8268800,4506240,4507264,6867968,6875904,8176640,82240,91456,8075008,101,2068960,106496,6918144,284672,4506624,7686400,384,7734208,159040
.long 3551232,3724544,16777216,88064,16777216,227328,15,0,2048,16777216,713728,6933504,158976,10240,2246656,2226176,2205696,2185216,2256896,3336192,3315712,3356672,148480,3692032,690816,1761664,7689728,7787904,2099676,8253440,4507392,4507904,6908928,6916864,8181760,16849216,16873792,24928512,102,2089440,110592,6938624,284672,4507648,7686656,384,7734208,159104
.long 3553792,3724928,16777216,88832,207232,206848,9,0,2048,16777216,714240,6936064,159104,15360,2251776,2231296,2210816,2190336,2262016,3341312,3320832,3358720,150528,3693568,739968,1782144,7689984,7787968,2120156,8258560,4508160,4509184,6949888,6957824,8186880,16849216,16873792,24928512,103,2109920,114688,6959104,284672,4508672,7686912,384,7734208,159168
.long 2762752,3606272,65792,73728,229888,229376,15,8192,0,688640,688128,4890624,158720,0,1458176,1478656,1499136,1519616,1540096,2957312,2977792,2998272,143360,3635200,786432,512,7475200,7734272,796,8355840,3997568,3998080,4853760,4867072,8273920,103040,112256,8284160,0,640,102400,4849664,270336,3997696,7471104,512,7734528,158720
.long 2765312,3606656,16777216,74752,106496,106496,15,8192,0,16777216,688640,4893184,158848,5120,1463296,1483776,1504256,1524736,1545216,2962432,2982912,3000320,145408,3636736,835584,20992,7475456,7734336,21276,8360960,3998336,3999360,4894720,4908032,8279040,108160,117376,8284416,1,21120,106496,4870144,270336,3998720,7471360,512,7734528,158784
.long 2813952,3613952,16777216,75776,16777216,231424,15,8192,0,16777216,689152,4895744,158976,10240,1468416,1488896,1509376,1529856,1550336,2967552,2988032,3003392,148480,3638272,884736,41472,7475712,7734400,41756,8366080,3999488,4000000,4935680,4948992,8284160,123520,148096,8356352,2,41600,110592,4890624,270336,3999744,7471616,512,7734528,158848
.long 2816512,3614336,16777216,76544,164352,163840,9,8192,0,16777216,689664,4898304,159104,15360,1473536,1494016,1514496,1534976,1555456,2972672,2993152,3005440,150528,3639808,933888,61952,7475968,7734464,62236,8371200,4000256,4001280,4976640,4989952,8289280,16900736,16925312,25133568,3,62080,114688,4911104,270336,4000768,7471872,512,7734528,158912
.long 2967552,3636992,73984,73728,238080,229376,15,8192,0,696832,696320,5545984,158720,0,1458176,1478656,1499136,1519616,1540096,2957312,2977792,2998272,143360,3635200,787200,492032,7536640,7749632,656156,8355840,4013952,4014464,5509120,5522432,8273920,103360,112576,8488960,32,656000,102400,5505024,270336,4014080,7532544,512,7734528,158720
.long 2970112,3637376,16777216,74752,107008,106496,15,8192,0,16777216,696832,5548544,158848,5120,1463296,1483776,1504256,1524736,1545216,2962432,2982912,3000320,145408,3636736,836352,512512,7536896,7749696,676636,8360960,4014720,4015744,5550080,5563392,8279040,108480,117696,8489216,33,676480,106496,5525504,270336,4015104,7532800,512,7734528,158784
.long 3018752,3644672,16777216,75776,16777216,231424,15,8192,0,16777216,697344,5551104,158976,10240,1468416,1488896,1509376,1529856,1550336,2967552,2988032,3003392,148480,3638272,885504,532992,7537152,7749760,697116,8366080,4015872,4016384,5591040,5604352,8284160,123840,148416,8561152,34,696960,110592,5545984,270336,4016128,7533056,512,7734528,158848
.long 3021312,3645056,16777216,76544,176640,176128,9,8192,0,16777216,697856,5553664,159104,15360,1473536,1494016,1514496,1534976,1555456,2972672,2993152,3005440,150528,3639808,934656,553472,7537408,7749824,717596,8371200,4016640,4017664,5632000,5645312,8289280,16901056,16925632,25338368,35,717440,114688,5566464,270336,4017152,7533312,512,7734528,158912
.long 2788352,3610112,66432,73728,213504,229376,15,8192,0,705024,704512,6201344,158720,0,1458176,1478656,1499136,1519616,1540096,2957312,2977792,2998272,143360,3635200,787968,983552,7598080,7764992,1311516,8355840,4030336,4030848,6164480,6177792,8273920,102400,111616,7874560,64,1311360,102400,6160384,270336,4030464,7593984,512,7734528,158720
.long 2790912,3610496,16777216,74752,107520,106496,15,8192,0,16777216,705024,6203904,158848,5120,1463296,1483776,1504256,1524736,1545216,2962432,2982912,3000320,145408,3636736,837120,1004032,7598336,7765056,1331996,8360960,4031104,4032128,6205440,6218752,8279040,107520,116736,7874816,65,1331840,106496,6180864,270336,4031488,7594240,512,7734528,158784
.long 2839552,3617792,16777216,75776,16777216,231424,15,8192,0,16777216,705536,6206464,158976,10240,1468416,1488896,1509376,1529856,1550336,2967552,2988032,3003392,148480,3638272,886272,1024512,7598592,7765120,1352476,8366080,4032256,4032768,6246400,6259712,8284160,122880,147456,7946752,66,1352320,110592,6201344,270336,4032512,7594496,512,7734528,158848
.long 2842112,3618176,16777216,76544,188928,188416,9,8192,0,16777216,706048,6209024,159104,15360,1473536,1494016,1514496,1534976,1555456,2972672,2993152,3005440,150528,3639808,935424,1044992,7598848,7765184,1372956,8371200,4033024,4034048,6287360,6300672,8289280,16900096,16924672,24723968,67,1372800,114688,6221824,270336,4033536,7594752,512,7734528,158912
.long 2993152,3640832,74624,73728,221696,229376,15,8192,0,713216,712704,6856704,158720,0,1458176,1478656,1499136,1519616,1540096,2957312,2977792,2998272,143360,3635200,788736,1475072,7659520,7780352,1966876,8355840,4046720,4047232,6819840,6833152,8273920,102720,111936,8079360,96,1966720,102400,6815744,270336,4046848,7655424,512,7734528,158720
.long 2995712,3641216,16777216,74752,108032,106496,15,8192,0,16777216,713216,6859264,158848,5120,1463296,1483776,1504256,1524736,1545216,2962432,2982912,3000320,145408,3636736,837888,1495552,7659776,7780416,1987356,8360960,4047488,4048512,6860800,6874112,8279040,107840,117056,8079616,97,1987200,106496,6836224,270336,4047872,7655680,512,7734528,158784
.long 3044352,3648512,16777216,75776,16777216,231424,15,8192,0,16777216,713728,6861824,158976,10240,1468416,1488896,1509376,1529856,1550336,2967552,2988032,3003392,148480,3638272,887040,1516032,7660032,7780480,2007836,8366080,4048640,4049152,6901760,6915072,8284160,123200,147776,8151552,98,2007680,110592,6856704,270336,4048896,7655936,512,7734528,158848
.long 3046912,3648896,16777216,76544,201216,200704,9,8192,0,16777216,714240,6864384,159104,15360,1473536,1494016,1514496,1534976,1555456,2972672,2993152,3005440,150528,3639808,936192,1536512,7660288,7780544,2028316,8371200,4049408,4050432,6942720,6956032,8289280,16900416,16924992,24928768,99,2028160,114688,6877184,270336,4049920,7656192,512,7734528,158912
.long 3172352,3667712,82176,90112,233984,229376,15,0,2048,689664,688128,4972544,158720,0,2277376,2297856,2318336,2338816,2359296,3366912,3387392,3407872,143360,3696640,786816,246272,7505920,7741952,82716,8366080,4521856,4522368,4861952,4869120,8273920,103200,112416,8386560,4,82560,102400,4931584,286720,4521984,7501824,512,7734528,158976
.long 3174912,3668096,16777216,91136,122880,122880,15,0,2048,16777216,688640,4975104,158848,5120,2282496,2302976,2323456,2343936,2364416,3372032,3392512,3409920,145408,3698176,835968,266752,7506176,7742016,103196,8371200,4522624,4523648,4902912,4910080,8279040,108320,117536,8386816,5,103040,106496,4952064,286720,4523008,7502080,512,7734528,159040
.long 3223552,3675392,16777216,92160,16777216,231424,15,0,2048,16777216,689152,4977664,158976,10240,2287616,2308096,2328576,2349056,2369536,3377152,3397632,3412992,148480,3699712,885120,287232,7506432,7742080,123676,8355840,4523776,4524288,4943872,4951040,8284160,123680,148256,8458752,6,123520,110592,4972544,286720,4524032,7502336,512,7734528,159104
.long 3226112,3675776,16777216,92928,170496,169984,9,0,2048,16777216,689664,4980224,159104,15360,2292736,2313216,2333696,2354176,2374656,3382272,3402752,3415040,150528,3701248,934272,307712,7506688,7742144,144156,8360960,4524544,4525568,4984832,4992000,8289280,16900896,16925472,25235968,7,144000,114688,4993024,286720,4525056,7502592,512,7734528,159168
.long 3377152,3698432,90368,90112,242176,229376,15,0,2048,697856,696320,5627904,158720,0,2277376,2297856,2318336,2338816,2359296,3366912,3387392,3407872,143360,3696640,787584,737792,7567360,7757312,738076,8366080,4538240,4538752,5517312,5524480,8273920,103520,112736,8591360,36,737920,102400,5586944,286720,4538368,7563264,512,7734528,158976
.long 3379712,3698816,16777216,91136,123392,122880,15,0,2048,16777216,696832,5630464,158848,5120,2282496,2302976,2323456,2343936,2364416,3372032,3392512,3409920,145408,3698176,836736,758272,7567616,7757376,758556,8371200,4539008,4540032,5558272,5565440,8279040,108640,117856,8591616,37,758400,106496,5607424,286720,4539392,7563520,512,7734528,159040
.long 3428352,3706112,16777216,92160,16777216,231424,15,0,2048,16777216,697344,5633024,158976,10240,2287616,2308096,2328576,2349056,2369536,3377152,3397632,3412992,148480,3699712,885888,778752,7567872,7757440,779036,8355840,4540160,4540672,5599232,5606400,8284160,124000,148576,8663552,38,778880,110592,5627904,286720,4540416,7563776,512,7734528,159104
.long 3430912,3706496,16777216,92928,182784,182272,9,0,2048,16777216,697856,5635584,159104,15360,2292736,2313216,2333696,2354176,2374656,3382272,3402752,3415040,150528,3701248,935040,799232,7568128,7757504,799516,8360960,4540928,4541952,5640192,5647360,8289280,16901216,16925792,25440768,39,799360,114688,5648384,286720,4541440,7564032,512,7734528,159168
.long 3197952,3671552,82816,90112,217600,229376,15,0,2048,706048,704512,6283264,158720,0,2277376,2297856,2318336,2338816,2359296,3366912,3387392,3407872,143360,3696640,788352,1229312,7628800,7772672,1393436,8366080,4554624,4555136,6172672,6179840,8273920,102560,111776,7976960,68,1393280,102400,6242304,286720,4554752,7624704,512,7734528,158976
.long 3200512,3671936,16777216,91136,123904,122880,15,0,2048,16777216,705024,6285824,158848,5120,2282496,2302976,2323456,2343936,2364416,3372032,3392512,3409920,145408,3698176,837504,1249792,7629056,7772736,1413916,8371200,4555392,4556416,6213632,6220800,8279040,107680,116896,7977216,69,1413760,106496,6262784,286720,4555776,7624960,512,7734528,159040
.long 3249152,3679232,16777216,92160,16777216,231424,15,0,2048,16777216,705536,6288384,158976,10240,2287616,2308096,2328576,2349056,2369536,3377152,3397632,3412992,148480,3699712,886656,1270272,7629312,7772800,1434396,8355840,4556544,4557056,6254592,6261760,8284160,123040,147616,8049152,70,1434240,110592,6283264,286720,4556800,7625216,512,7734528,159104
.long 3251712,3679616,16777216,92928,195072,194560,9,0,2048,16777216,706048,6290944,159104,15360,2292736,2313216,2333696,2354176,2374656,3382272,3402752,3415040,150528,3701248,935808,1290752,7629568,7772864,1454876,8360960,4557312,4558336,6295552,6302720,8289280,16900256,16924832,24826368,71,1454720,114688,6303744,286720,4557824,7625472,512,7734528,159168
.long 3402752,3702272,91008,90112,225792,229376,15,0,2048,714240,712704,6938624,158720,0,2277376,2297856,2318336,2338816,2359296,3366912,3387392,3407872,143360,3696640,789120,1720832,7690240,7788032,2048796,8366080,4571008,4571520,6828032,6835200,8273920,102880,112096,8181760,100,2048640,102400,6897664,286720,4571136,7686144,512,7734528,158976
.long 3405312,3702656,16777216,91136,124416,122880,15,0,2048,16777216,713216,6941184,158848,5120,2282496,2302976,2323456,2343936,2364416,3372032,3392512,3409920,145408,3698176,838272,1741312,7690496,7788096,2069276,8371200,4571776,4572800,6868992,6876160,8279040,108000,117216,8182016,101,2069120,106496,6918144,286720,4572160,7686400,512,7734528,159040
.long 3453952,3709952,16777216,92160,16777216,231424,15,0,2048,16777216,713728,6943744,158976,10240,2287616,2308096,2328576,2349056,2369536,3377152,3397632,3412992,148480,3699712,887424,1761792,7690752,7788160,2089756,8355840,4572928,4573440,6909952,6917120,8284160,123360,147936,8253952,102,2089600,110592,6938624,286720,4573184,7686656,512,7734528,159104
.long 3456512,3710336,16777216,92928,207360,206848,9,0,2048,16777216,714240,6946304,159104,15360,2292736,2313216,2333696,2354176,2374656,3382272,3402752,3415040,150528,3701248,936576,1782272,7691008,7788224,2110236,8360960,4573696,4574720,6950912,6958080,8289280,16900576,16925152,25031168,103,2110080,114688,6959104,286720,4574208,7686912,512,7734528,159168
.long 2865152,3621632,69888,73728,234112,233472,15,8192,0,688768,688128,4900864,158720,0,1581056,1560576,1622016,1601536,1652736,3018752,3039232,3054592,143360,3642880,983040,640,7476224,7734528,11036,8458240,4063104,4063616,4854784,4867328,8376320,128800,138016,8387072,0,800,102400,4849664,272384,4063232,7471104,640,7734848,158720
.long 2867712,3622016,16777216,74752,108544,108544,15,8192,0,16777216,688640,4903424,158848,5120,1586176,1565696,1627136,1606656,1657856,3023872,3044352,3056640,145408,3644416,1032192,21120,7476480,7734592,31516,8463360,4063872,4064896,4895744,4908288,8381440,133920,143136,8387328,1,21280,106496,4870144,272384,4064256,7471360,640,7734848,158784
.long 2916352,3629312,16777216,75776,16777216,235520,15,8192,0,16777216,689152,4905984,158976,10240,1591296,1570816,1632256,1611776,1642496,3008512,3028992,3049472,148480,3645952,1081344,41600,7476736,7734656,51996,8468480,4065024,4065536,4936704,4949248,8386560,16900896,16925472,25235968,2,41760,110592,4890624,272384,4065280,7471616,640,7734848,158848
.long 2918912,3629696,16777216,76544,164480,163840,9,8192,0,16777216,689664,4908544,159104,15360,1596416,1575936,1637376,1616896,1647616,3013632,3034112,3051520,150528,3647488,1130496,62080,7476992,7734720,72476,8473600,4065792,4066816,4977664,4990208,8391680,16900896,16925472,25235968,3,62240,114688,4911104,272384,4066304,7471872,640,7734848,158912
.long 3069952,3652352,78080,73728,242304,233472,15,8192,0,696960,696320,5556224,158720,0,1581056,1560576,1622016,1601536,1652736,3018752,3039232,3054592,143360,3642880,983808,492160,7537664,7749888,666396,8458240,4079488,4080000,5510144,5522688,8376320,129120,138336,8591872,32,656160,102400,5505024,272384,4079616,7532544,640,7734848,158720
.long 3072512,3652736,16777216,74752,109056,108544,15,8192,0,16777216,696832,5558784,158848,5120,1586176,1565696,1627136,1606656,1657856,3023872,3044352,3056640,145408,3644416,1032960,512640,7537920,7749952,686876,8463360,4080256,4081280,5551104,5563648,8381440,134240,143456,8592128,33,676640,106496,5525504,272384,4080640,7532800,640,7734848,158784
.long 3121152,3660032,16777216,75776,16777216,235520,15,8192,0,16777216,697344,5561344,158976,10240,1591296,1570816,1632256,1611776,1642496,3008512,3028992,3049472,148480,3645952,1082112,533120,7538176,7750016,707356,8468480,4081408,4081920,5592064,5604608,8386560,16901216,16925792,25440768,34,697120,110592,5545984,272384,4081664,7533056,640,7734848,158848
.long 3123712,3660416,16777216,76544,176768,176128,9,8192,0,16777216,697856,5563904,159104,15360,1596416,1575936,1637376,1616896,1647616,3013632,3034112,3051520,150528,3647488,1131264,553600,7538432,7750080,727836,8473600,4082176,4083200,5633024,5645568,8391680,16901216,16925792,25440768,35,717600,114688,5566464,272384,4082688,7533312,640,7734848,158912
.long 2890752,3625472,70528,73728,217728,233472,15,8192,0,705152,704512,6211584,158720,0,1581056,1560576,1622016,1601536,1652736,3018752,3039232,3054592,143360,3642880,984576,983680,7599104,7765248,1321756,8458240,4095872,4096384,6165504,6178048,8376320,128160,137376,7977472,64,1311520,102400,6160384,272384,4096000,7593984,640,7734848,158720
.long 2893312,3625856,16777216,74752,109568,108544,15,8192,0,16777216,705024,6214144,158848,5120,1586176,1565696,1627136,1606656,1657856,3023872,3044352,3056640,145408,3644416,1033728,1004160,7599360,7765312,1342236,8463360,4096640,4097664,6206464,6219008,8381440,133280,142496,7977728,65,1332000,106496,6180864,272384,4097024,7594240,640,7734848,158784
.long 2941952,3633152,16777216,75776,16777216,235520,15,8192,0,16777216,705536,6216704,158976,10240,1591296,1570816,1632256,1611776,1642496,3008512,3028992,3049472,148480,3645952,1082880,1024640,7599616,7765376,1362716,8468480,4097792,4098304,6247424,6259968,8386560,16900256,16924832,24826368,66,1352480,110592,6201344,272384,4098048,7594496,640,7734848,158848
.long 2944512,3633536,16777216,76544,189056,188416,9,8192,0,16777216,706048,6219264,159104,15360,1596416,1575936,1637376,1616896,1647616,3013632,3034112,3051520,150528,3647488,1132032,1045120,7599872,7765440,1383196,8473600,4098560,4099584,6288384,6300928,8391680,16900256,16924832,24826368,67,1372960,114688,6221824,272384,4099072,7594752,640,7734848,158912
.long 3095552,3656192,78720,73728,225920,233472,15,8192,0,713344,712704,6866944,158720,0,1581056,1560576,1622016,1601536,1652736,3018752,3039232,3054592,143360,3642880,985344,1475200,7660544,7780608,1977116,8458240,4112256,4112768,6820864,6833408,8376320,128480,137696,8182272,96,1966880,102400,6815744,272384,4112384,7655424,640,7734848,158720
.long 3098112,3656576,16777216,74752,110080,108544,15,8192,0,16777216,713216,6869504,158848,5120,1586176,1565696,1627136,1606656,1657856,3023872,3044352,3056640,145408,3644416,1034496,1495680,7660800,7780672,1997596,8463360,4113024,4114048,6861824,6874368,8381440,133600,142816,8182528,97,1987360,106496,6836224,272384,4113408,7655680,640,7734848,158784
.long 3146752,3663872,16777216,75776,16777216,235520,15,8192,0,16777216,713728,6872064,158976,10240,1591296,1570816,1632256,1611776,1642496,3008512,3028992,3049472,148480,3645952,1083648,1516160,7661056,7780736,2018076,8468480,4114176,4114688,6902784,6915328,8386560,16900576,16925152,25031168,98,2007840,110592,6856704,272384,4114432,7655936,640,7734848,158848
.long 3149312,3664256,16777216,76544,201344,200704,9,8192,0,16777216,714240,6874624,159104,15360,1596416,1575936,1637376,1616896,1647616,3013632,3034112,3051520,150528,3647488,1132800,1536640,7661312,7780800,2038556,8473600,4114944,4115968,6943744,6956288,8391680,16900576,16925152,25031168,99,2028320,114688,6877184,272384,4115456,7656192,640,7734848,158912
.long 3274752,3683072,86272,90112,238208,233472,15,0,2048,689792,688128,4982784,158720,0,2400256,2379776,2441216,2420736,2471936,3428352,3448832,3464192,143360,3704320,983424,246400,7506944,7742208,92956,8468480,4587392,4587904,4862976,4869376,8376320,128960,138176,8489472,4,82720,102400,4931584,288768,4587520,7501824,640,7734848,158976
.long 3277312,3683456,16777216,91136,124928,124928,15,0,2048,16777216,688640,4985344,158848,5120,2405376,2384896,2446336,2425856,2477056,3433472,3453952,3466240,145408,3705856,1032576,266880,7507200,7742272,113436,8473600,4588160,4589184,4903936,4910336,8381440,134080,143296,8489728,5,103200,106496,4952064,288768,4588544,7502080,640,7734848,159040
.long 3325952,3690752,16777216,92160,16777216,235520,15,0,2048,16777216,689152,4987904,158976,10240,2410496,2390016,2451456,2430976,2461696,3418112,3438592,3459072,148480,3707392,1081728,287360,7507456,7742336,133916,8458240,4589312,4589824,4944896,4951296,8386560,16901056,16925632,25338368,6,123680,110592,4972544,288768,4589568,7502336,640,7734848,159104
.long 3328512,3691136,16777216,92928,170624,169984,9,0,2048,16777216,689664,4990464,159104,15360,2415616,2395136,2456576,2436096,2466816,3423232,3443712,3461120,150528,3708928,1130880,307840,7507712,7742400,154396,8463360,4590080,4591104,4985856,4992256,8391680,16901056,16925632,25338368,7,144160,114688,4993024,288768,4590592,7502592,640,7734848,159168
.long 3479552,3713792,94464,90112,213632,233472,15,0,2048,697984,696320,5638144,158720,0,2400256,2379776,2441216,2420736,2471936,3428352,3448832,3464192,143360,3704320,984192,737920,7568384,7757568,748316,8468480,4603776,4604288,5518336,5524736,8376320,128000,137216,7875072,36,738080,102400,5586944,288768,4603904,7563264,640,7734848,158976
.long 3482112,3714176,16777216,91136,125440,124928,15,0,2048,16777216,696832,5640704,158848,5120,2405376,2384896,2446336,2425856,2477056,3433472,3453952,3466240,145408,3705856,1033344,758400,7568640,7757632,768796,8473600,4604544,4605568,5559296,5565696,8381440,133120,142336,7875328,37,758560,106496,5607424,288768,4604928,7563520,640,7734848,159040
.long 3530752,3721472,16777216,92160,16777216,235520,15,0,2048,16777216,697344,5643264,158976,10240,2410496,2390016,2451456,2430976,2461696,3418112,3438592,3459072,148480,3707392,1082496,778880,7568896,7757696,789276,8458240,4605696,4606208,5600256,5606656,8386560,16900096,16924672,24723968,38,779040,110592,5627904,288768,4605952,7563776,640,7734848,159104
.long 3533312,3721856,16777216,92928,182912,182272,9,0,2048,16777216,697856,5645824,159104,15360,2415616,2395136,2456576,2436096,2466816,3423232,3443712,3461120,150528,3708928,1131648,799360,7569152,7757760,809756,8463360,4606464,4607488,5641216,5647616,8391680,16900096,16924672,24723968,39,799520,114688,5648384,288768,4606976,7564032,640,7734848,159168
.long 3300352,3686912,86912,90112,221824,233472,15,0,2048,706176,704512,6293504,158720,0,2400256,2379776,2441216,2420736,2471936,3428352,3448832,3464192,143360,3704320,984960,1229440,7629824,7772928,1403676,8468480,4620160,4620672,6173696,6180096,8376320,128320,137536,8079872,68,1393440,102400,6242304,288768,4620288,7624704,640,7734848,158976
.long 3302912,3687296,16777216,91136,125952,124928,15,0,2048,16777216,705024,6296064,158848,5120,2405376,2384896,2446336,2425856,2477056,3433472,3453952,3466240,145408,3705856,1034112,1249920,7630080,7772992,1424156,8473600,4620928,4621952,6214656,6221056,8381440,133440,142656,8080128,69,1413920,106496,6262784,288768,4621312,7624960,640,7734848,159040
.long 3351552,3694592,16777216,92160,16777216,235520,15,0,2048,16777216,705536,6298624,158976,10240,2410496,2390016,2451456,2430976,2461696,3418112,3438592,3459072,148480,3707392,1083264,1270400,7630336,7773056,1444636,8458240,4622080,4622592,6255616,6262016,8386560,16900416,16924992,24928768,70,1434400,110592,6283264,288768,4622336,7625216,640,7734848,159104
.long 3354112,3694976,16777216,92928,195200,194560,9,0,2048,16777216,706048,6301184,159104,15360,2415616,2395136,2456576,2436096,2466816,3423232,3443712,3461120,150528,3708928,1132416,1290880,7630592,7773120,1465116,8463360,4622848,4623872,6296576,6302976,8391680,16900416,16924992,24928768,71,1454880,114688,6303744,288768,4623360,7625472,640,7734848,159168
.long 3505152,3717632,95104,90112,230016,233472,15,0,2048,714368,712704,6948864,158720,0,2400256,2379776,2441216,2420736,2471936,3428352,3448832,3464192,143360,3704320,985728,1720960,7691264,7788288,2059036,8468480,4636544,4637056,6829056,6835456,8376320,128640,137856,8284672,100,2048800,102400,6897664,288768,4636672,7686144,640,7734848,158976
.long 3507712,3718016,16777216,91136,126464,124928,15,0,2048,16777216,713216,6951424,158848,5120,2405376,2384896,2446336,2425856,2477056,3433472,3453952,3466240,145408,3705856,1034880,1741440,7691520,7788352,2079516,8473600,4637312,4638336,6870016,6876416,8381440,133760,142976,8284928,101,2069280,106496,6918144,288768,4637696,7686400,640,7734848,159040
.long 3556352,3725312,16777216,92160,16777216,235520,15,0,2048,16777216,713728,6953984,158976,10240,2410496,2390016,2451456,2430976,2461696,3418112,3438592,3459072,148480,3707392,1084032,1761920,7691776,7788416,2099996,8458240,4638464,4638976,6910976,6917376,8386560,16900736,16925312,25133568,102,2089760,110592,6938624,288768,4638720,7686656,640,7734848,159104
.long 3558912,3725696,16777216,92928,207488,206848,9,0,2048,16777216,714240,6956544,159104,15360,2415616,2395136,2456576,2436096,2466816,3423232,3443712,3461120,150528,3708928,1133184,1782400,7692032,7788480,2120476,8463360,4639232,4640256,6951936,6958336,8391680,16900736,16925312,25133568,103,2110240,114688,6959104,288768,4639744,7686912,640,7734848,159168
.long 2767872,3607040,65920,77824,238336,237568,15,8192,0,688896,688128,4911104,158720,0,1703936,1724416,1662976,1683456,1744896,3080192,3059712,3100672,143360,3650560,1179648,768,7477248,7734784,1116,8560640,4128640,4129152,4855808,4867584,8478720,154560,163776,8494080,0,960,102400,4849664,274432,4128768,7471104,768,7735168,158720
.long 2770432,3607424,16777216,78848,110592,110592,15,8192,0,16777216,688640,4913664,158848,5120,1709056,1729536,1668096,1688576,1750016,3085312,3064832,3102720,145408,3652096,1228800,21248,7477504,7734848,21596,8565760,4129408,4130432,4896768,4908544,8483840,159680,168896,8494336,1,21440,106496,4870144,274432,4129792,7471360,768,7735168,158784
.long 2819072,3614720,16777216,79872,16777216,239616,15,8192,0,16777216,689152,4916224,158976,10240,1714176,1734656,1673216,1693696,1755136,3090432,3069952,3105792,148480,3653632,1277952,41728,7477760,7734912,42076,8570880,4130560,4131072,4937728,4949504,8488960,175040,199616,8561408,2,41920,110592,4890624,274432,4130816,7471616,768,7735168,158848
.long 2821632,3615104,16777216,80640,164608,163840,9,8192,0,16777216,689664,4918784,159104,15360,1719296,1739776,1678336,1698816,1760256,3095552,3075072,3107840,150528,3655168,1327104,62208,7478016,7734976,62556,8576000,4131328,4132352,4978688,4990464,8494080,16952256,16976832,25338624,3,62400,114688,4911104,274432,4131840,7471872,768,7735168,158912
.long 2972672,3637760,74112,77824,213760,237568,15,8192,0,697088,696320,5566464,158720,0,1703936,1724416,1662976,1683456,1744896,3080192,3059712,3100672,143360,3650560,1180416,492288,7538688,7750144,656476,8560640,4145024,4145536,5511168,5522944,8478720,153600,162816,7879680,32,656320,102400,5505024,274432,4145152,7532544,768,7735168,158720
.long 2975232,3638144,16777216,78848,111104,110592,15,8192,0,16777216,696832,5569024,158848,5120,1709056,1729536,1668096,1688576,1750016,3085312,3064832,3102720,145408,3652096,1229568,512768,7538944,7750208,676956,8565760,4145792,4146816,5552128,5563904,8483840,158720,167936,7879936,33,676800,106496,5525504,274432,4146176,7532800,768,7735168,158784
.long 3023872,3645440,16777216,79872,16777216,239616,15,8192,0,16777216,697344,5571584,158976,10240,1714176,1734656,1673216,1693696,1755136,3090432,3069952,3105792,148480,3653632,1278720,533248,7539200,7750272,697436,8570880,4146944,4147456,5593088,5604864,8488960,174080,198656,7947008,34,697280,110592,5545984,274432,4147200,7533056,768,7735168,158848
.long 3026432,3645824,16777216,80640,176896,176128,9,8192,0,16777216,697856,5574144,159104,15360,1719296,1739776,1678336,1698816,1760256,3095552,3075072,3107840,150528,3655168,1327872,553728,7539456,7750336,717916,8576000,4147712,4148736,5634048,5645824,8494080,16951296,16975872,24724224,35,717760,114688,5566464,274432,4148224,7533312,768,7735168,158912
.long 2793472,3610880,66560,77824,221952,237568,15,8192,0,705280,704512,6221824,158720,0,1703936,1724416,1662976,1683456,1744896,3080192,3059712,3100672,143360,3650560,1181184,983808,7600128,7765504,1311836,8560640,4161408,4161920,6166528,6178304,8478720,153920,163136,8084480,64,1311680,102400,6160384,274432,4161536,7593984,768,7735168,158720
.long 2796032,3611264,16777216,78848,111616,110592,15,8192,0,16777216,705024,6224384,158848,5120,1709056,1729536,1668096,1688576,1750016,3085312,3064832,3102720,145408,3652096,1230336,1004288,7600384,7765568,1332316,8565760,4162176,4163200,6207488,6219264,8483840,159040,168256,8084736,65,1332160,106496,6180864,274432,4162560,7594240,768,7735168,158784
.long 2844672,3618560,16777216,79872,16777216,239616,15,8192,0,16777216,705536,6226944,158976,10240,1714176,1734656,1673216,1693696,1755136,3090432,3069952,3105792,148480,3653632,1279488,1024768,7600640,7765632,1352796,8570880,4163328,4163840,6248448,6260224,8488960,174400,198976,8151808,66,1352640,110592,6201344,274432,4163584,7594496,768,7735168,158848
.long 2847232,3618944,16777216,80640,189184,188416,9,8192,0,16777216,706048,6229504,159104,15360,1719296,1739776,1678336,1698816,1760256,3095552,3075072,3107840,150528,3655168,1328640,1045248,7600896,7765696,1373276,8576000,4164096,4165120,6289408,6301184,8494080,16951616,16976192,24929024,67,1373120,114688,6221824,274432,4164608,7594752,768,7735168,158912
.long 2998272,3641600,74752,77824,230144,237568,15,8192,0,713472,712704,6877184,158720,0,1703936,1724416,1662976,1683456,1744896,3080192,3059712,3100672,143360,3650560,1181952,1475328,7661568,7780864,1967196,8560640,4177792,4178304,6821888,6833664,8478720,154240,163456,8289280,96,1967040,102400,6815744,274432,4177920,7655424,768,7735168,158720
.long 3000832,3641984,16777216,78848,112128,110592,15,8192,0,16777216,713216,6879744,158848,5120,1709056,1729536,1668096,1688576,1750016,3085312,3064832,3102720,145408,3652096,1231104,1495808,7661824,7780928,1987676,8565760,4178560,4179584,6862848,6874624,8483840,159360,168576,8289536,97,1987520,106496,6836224,274432,4178944,7655680,768,7735168,158784
.long 3049472,3649280,16777216,79872,16777216,239616,15,8192,0,16777216,713728,6882304,158976,10240,1714176,1734656,1673216,1693696,1755136,3090432,3069952,3105792,148480,3653632,1280256,1516288,7662080,7780992,2008156,8570880,4179712,4180224,6903808,6915584,8488960,174720,199296,8356608,98,2008000,110592,6856704,274432,4179968,7655936,768,7735168,158848
.long 3052032,3649664,16777216,80640,201472,200704,9,8192,0,16777216,714240,6884864,159104,15360,1719296,1739776,1678336,1698816,1760256,3095552,3075072,3107840,150528,3655168,1329408,1536768,7662336,7781056,2028636,8576000,4180480,4181504,6944768,6956544,8494080,16951936,16976512,25133824,99,2028480,114688,6877184,274432,4180992,7656192,768,7735168,158912
.long 3177472,3668480,82304,94208,242432,237568,15,0,2048,689920,688128,4993024,158720,0,2523136,2543616,2482176,2502656,2564096,3489792,3469312,3510272,143360,3712000,1180032,246528,7507968,7742464,83036,8570880,4652928,4653440,4864000,4869632,8478720,154720,163936,8596480,4,82880,102400,4931584,290816,4653056,7501824,768,7735168,158976
.long 3180032,3668864,16777216,95232,126976,126976,15,0,2048,16777216,688640,4995584,158848,5120,2528256,2548736,2487296,2507776,2569216,3494912,3474432,3512320,145408,3713536,1229184,267008,7508224,7742528,103516,8576000,4653696,4654720,4904960,4910592,8483840,159840,169056,8596736,5,103360,106496,4952064,290816,4654080,7502080,768,7735168,159040
.long 3228672,3676160,16777216,96256,16777216,239616,15,0,2048,16777216,689152,4998144,158976,10240,2533376,2553856,2492416,2512896,2574336,3500032,3479552,3515392,148480,3715072,1278336,287488,7508480,7742592,123996,8560640,4654848,4655360,4945920,4951552,8488960,175200,199776,8663808,6,123840,110592,4972544,290816,4655104,7502336,768,7735168,159104
.long 3231232,3676544,16777216,97024,170752,169984,9,0,2048,16777216,689664,5000704,159104,15360,2538496,2558976,2497536,2518016,2579456,3505152,3484672,3517440,150528,3716608,1327488,307968,7508736,7742656,144476,8565760,4655616,4656640,4986880,4992512,8494080,16952416,16976992,25441024,7,144320,114688,4993024,290816,4656128,7502592,768,7735168,159168
.long 3382272,3699200,90496,94208,217856,237568,15,0,2048,698112,696320,5648384,158720,0,2523136,2543616,2482176,2502656,2564096,3489792,3469312,3510272,143360,3712000,1180800,738048,7569408,7757824,738396,8570880,4669312,4669824,5519360,5524992,8478720,153760,162976,7982080,36,738240,102400,5586944,290816,4669440,7563264,768,7735168,158976
.long 3384832,3699584,16777216,95232,127488,126976,15,0,2048,16777216,696832,5650944,158848,5120,2528256,2548736,2487296,2507776,2569216,3494912,3474432,3512320,145408,3713536,1229952,758528,7569664,7757888,758876,8576000,4670080,4671104,5560320,5565952,8483840,158880,168096,7982336,37,758720,106496,5607424,290816,4670464,7563520,768,7735168,159040
.long 3433472,3706880,16777216,96256,16777216,239616,15,0,2048,16777216,697344,5653504,158976,10240,2533376,2553856,2492416,2512896,2574336,3500032,3479552,3515392,148480,3715072,1279104,779008,7569920,7757952,779356,8560640,4671232,4671744,5601280,5606912,8488960,174240,198816,8049408,38,779200,110592,5627904,290816,4671488,7563776,768,7735168,159104
.long 3436032,3707264,16777216,97024,183040,182272,9,0,2048,16777216,697856,5656064,159104,15360,2538496,2558976,2497536,2518016,2579456,3505152,3484672,3517440,150528,3716608,1328256,799488,7570176,7758016,799836,8565760,4672000,4673024,5642240,5647872,8494080,16951456,16976032,24826624,39,799680,114688,5648384,290816,4672512,7564032,768,7735168,159168
.long 3203072,3672320,82944,94208,226048,237568,15,0,2048,706304,704512,6303744,158720,0,2523136,2543616,2482176,2502656,2564096,3489792,3469312,3510272,143360,3712000,1181568,1229568,7630848,7773184,1393756,8570880,4685696,4686208,6174720,6180352,8478720,154080,163296,8186880,68,1393600,102400,6242304,290816,4685824,7624704,768,7735168,158976
.long 3205632,3672704,16777216,95232,128000,126976,15,0,2048,16777216,705024,6306304,158848,5120,2528256,2548736,2487296,2507776,2569216,3494912,3474432,3512320,145408,3713536,1230720,1250048,7631104,7773248,1414236,8576000,4686464,4687488,6215680,6221312,8483840,159200,168416,8187136,69,1414080,106496,6262784,290816,4686848,7624960,768,7735168,159040
.long 3254272,3680000,16777216,96256,16777216,239616,15,0,2048,16777216,705536,6308864,158976,10240,2533376,2553856,2492416,2512896,2574336,3500032,3479552,3515392,148480,3715072,1279872,1270528,7631360,7773312,1434716,8560640,4687616,4688128,6256640,6262272,8488960,174560,199136,8254208,70,1434560,110592,6283264,290816,4687872,7625216,768,7735168,159104
.long 3256832,3680384,16777216,97024,195328,194560,9,0,2048,16777216,706048,6311424,159104,15360,2538496,2558976,2497536,2518016,2579456,3505152,3484672,3517440,150528,3716608,1329024,1291008,7631616,7773376,1455196,8565760,4688384,4689408,6297600,6303232,8494080,16951776,16976352,25031424,71,1455040,114688,6303744,290816,4688896,7625472,768,7735168,159168
.long 3407872,3703040,91136,94208,234240,237568,15,0,2048,714496,712704,6959104,158720,0,2523136,2543616,2482176,2502656,2564096,3489792,3469312,3510272,143360,3712000,1182336,1721088,7692288,7788544,2049116,8570880,4702080,4702592,6830080,6835712,8478720,154400,163616,8391680,100,2048960,102400,6897664,290816,4702208,7686144,768,7735168,158976
.long 3410432,3703424,16777216,95232,128512,126976,15,0,2048,16777216,713216,6961664,158848,5120,2528256,2548736,2487296,2507776,2569216,3494912,3474432,3512320,145408,3713536,1231488,1741568,7692544,7788608,2069596,8576000,4702848,4703872,6871040,6876672,8483840,159520,168736,8391936,101,2069440,106496,6918144,290816,4703232,7686400,768,7735168,159040
.long 3459072,3710720,16777216,96256,16777216,239616,15,0,2048,16777216,713728,6964224,158976,10240,2533376,2553856,2492416,2512896,2574336,3500032,3479552,3515392,148480,3715072,1280640,1762048,7692800,7788672,2090076,8560640,4704000,4704512,6912000,6917632,8488960,174880,199456,8459008,102,2089920,110592,6938624,290816,4704256,7686656,768,7735168,159104
.long 3461632,3711104,16777216,97024,207616,206848,9,0,2048,16777216,714240,6966784,159104,15360,2538496,2558976,2497536,2518016,2579456,3505152,3484672,3517440,150528,3716608,1329792,1782528,7693056,7788736,2110556,8565760,4704768,4705792,6952960,6958592,8494080,16952096,16976672,25236224,103,2110400,114688,6959104,290816,4705280,7686912,768,7735168,159168
.long 2870272,3622400,70016,77824,242560,241664,15,8192,0,689024,688128,4921344,158720,0,1826816,1806336,1785856,1765376,1857536,3141632,3121152,3156992,143360,3658240,1376256,896,7478272,7735040,11356,8663040,4194176,4194688,4856832,4867840,8581120,180320,189536,8596992,0,1120,102400,4849664,276480,4194304,7471104,896,7735488,158720
.long 2872832,3622784,16777216,78848,112640,112640,15,8192,0,16777216,688640,4923904,158848,5120,1831936,1811456,1790976,1770496,1862656,3146752,3126272,3159040,145408,3659776,1425408,21376,7478528,7735104,31836,8668160,4194944,4195968,4897792,4908800,8586240,185440,194656,8597248,1,21600,106496,4870144,276480,4195328,7471360,896,7735488,158784
.long 2921472,3630080,16777216,79872,16777216,243712,15,8192,0,16777216,689152,4926464,158976,10240,1837056,1816576,1796096,1775616,1847296,3131392,3110912,3151872,148480,3661312,1474560,41856,7478784,7735168,52316,8673280,4196096,4196608,4938752,4949760,8591360,16952416,16976992,25441024,2,42080,110592,4890624,276480,4196352,7471616,896,7735488,158848
.long 2924032,3630464,16777216,80640,164736,163840,9,8192,0,16777216,689664,4929024,159104,15360,1842176,1821696,1801216,1780736,1852416,3136512,3116032,3153920,150528,3662848,1523712,62336,7479040,7735232,72796,8678400,4196864,4197888,4979712,4990720,8596480,16952416,16976992,25441024,3,62560,114688,4911104,276480,4197376,7471872,896,7735488,158912
.long 3075072,3653120,78208,77824,217984,241664,15,8192,0,697216,696320,5576704,158720,0,1826816,1806336,1785856,1765376,1857536,3141632,3121152,3156992,143360,3658240,1377024,492416,7539712,7750400,666716,8663040,4210560,4211072,5512192,5523200,8581120,179360,188576,7982592,32,656480,102400,5505024,276480,4210688,7532544,896,7735488,158720
.long 3077632,3653504,16777216,78848,113152,112640,15,8192,0,16777216,696832,5579264,158848,5120,1831936,1811456,1790976,1770496,1862656,3146752,3126272,3159040,145408,3659776,1426176,512896,7539968,7750464,687196,8668160,4211328,4212352,5553152,5564160,8586240,184480,193696,7982848,33,676960,106496,5525504,276480,4211712,7532800,896,7735488,158784
.long 3126272,3660800,16777216,79872,16777216,243712,15,8192,0,16777216,697344,5581824,158976,10240,1837056,1816576,1796096,1775616,1847296,3131392,3110912,3151872,148480,3661312,1475328,533376,7540224,7750528,707676,8673280,4212480,4212992,5594112,5605120,8591360,16951456,16976032,24826624,34,697440,110592,5545984,276480,4212736,7533056,896,7735488,158848
.long 3128832,3661184,16777216,80640,177024,176128,9,8192,0,16777216,697856,5584384,159104,15360,1842176,1821696,1801216,1780736,1852416,3136512,3116032,3153920,150528,3662848,1524480,553856,7540480,7750592,728156,8678400,4213248,4214272,5635072,5646080,8596480,16951456,16976032,24826624,35,717920,114688,5566464,276480,4213760,7533312,896,7735488,158912
.long 2895872,3626240,70656,77824,226176,241664,15,8192,0,705408,704512,6232064,158720,0,1826816,1806336,1785856,1765376,1857536,3141632,3121152,3156992,143360,3658240,1377792,983936,7601152,7765760,1322076,8663040,4226944,4227456,6167552,6178560,8581120,179680,188896,8187392,64,1311840,102400,6160384,276480,4227072,7593984,896,7735488,158720
.long 2898432,3626624,16777216,78848,113664,112640,15,8192,0,16777216,705024,6234624,158848,5120,1831936,1811456,1790976,1770496,1862656,3146752,3126272,3159040,145408,3659776,1426944,1004416,7601408,7765824,1342556,8668160,4227712,4228736,6208512,6219520,8586240,184800,194016,8187648,65,1332320,106496,6180864,276480,4228096,7594240,896,7735488,158784
.long 2947072,3633920,16777216,79872,16777216,243712,15,8192,0,16777216,705536,6237184,158976,10240,1837056,1816576,1796096,1775616,1847296,3131392,3110912,3151872,148480,3661312,1476096,1024896,7601664,7765888,1363036,8673280,4228864,4229376,6249472,6260480,8591360,16951776,16976352,25031424,66,1352800,110592,6201344,276480,4229120,7594496,896,7735488,158848
.long 2949632,3634304,16777216,80640,189312,188416,9,8192,0,16777216,706048,6239744,159104,15360,1842176,1821696,1801216,1780736,1852416,3136512,3116032,3153920,150528,3662848,1525248,1045376,7601920,7765952,1383516,8678400,4229632,4230656,6290432,6301440,8596480,16951776,16976352,25031424,67,1373280,114688,6221824,276480,4230144,7594752,896,7735488,158912
.long 3100672,3656960,78848,77824,234368,241664,15,8192,0,713600,712704,6887424,158720,0,1826816,1806336,1785856,1765376,1857536,3141632,3121152,3156992,143360,3658240,1378560,1475456,7662592,7781120,1977436,8663040,4243328,4243840,6822912,6833920,8581120,180000,189216,8392192,96,1967200,102400,6815744,276480,4243456,7655424,896,7735488,158720
.long 3103232,3657344,16777216,78848,114176,112640,15,8192,0,16777216,713216,6889984,158848,5120,1831936,1811456,1790976,1770496,1862656,3146752,3126272,3159040,145408,3659776,1427712,1495936,7662848,7781184,1997916,8668160,4244096,4245120,6863872,6874880,8586240,185120,194336,8392448,97,1987680,106496,6836224,276480,4244480,7655680,896,7735488,158784
.long 3151872,3664640,16777216,79872,16777216,243712,15,8192,0,16777216,713728,6892544,158976,10240,1837056,1816576,1796096,1775616,1847296,3131392,3110912,3151872,148480,3661312,1476864,1516416,7663104,7781248,2018396,8673280,4245248,4245760,6904832,6915840,8591360,16952096,16976672,25236224,98,2008160,110592,6856704,276480,4245504,7655936,896,7735488,158848
.long 3154432,3665024,16777216,80640,201600,200704,9,8192,0,16777216,714240,6895104,159104,15360,1842176,1821696,1801216,1780736,1852416,3136512,3116032,3153920,150528,3662848,1526016,1536896,7663360,7781312,2038876,8678400,4246016,4247040,6945792,6956800,8596480,16952096,16976672,25236224,99,2028640,114688,6877184,276480,4246528,7656192,896,7735488,158912
.long 3279872,3683840,86400,94208,213888,241664,15,0,2048,690048,688128,5003264,158720,0,2646016,2625536,2605056,2584576,2676736,3551232,3530752,3566592,143360,3719680,1376640,246656,7508992,7742720,93276,8673280,4718464,4718976,4865024,4869888,8581120,179200,188416,7880192,4,83040,102400,4931584,292864,4718592,7501824,896,7735488,158976
.long 3282432,3684224,16777216,95232,129024,129024,15,0,2048,16777216,688640,5005824,158848,5120,2651136,2630656,2610176,2589696,2681856,3556352,3535872,3568640,145408,3721216,1425792,267136,7509248,7742784,113756,8678400,4719232,4720256,4905984,4910848,8586240,184320,193536,7880448,5,103520,106496,4952064,292864,4719616,7502080,896,7735488,159040
.long 3331072,3691520,16777216,96256,16777216,243712,15,0,2048,16777216,689152,5008384,158976,10240,2656256,2635776,2615296,2594816,2666496,3540992,3520512,3561472,148480,3722752,1474944,287616,7509504,7742848,134236,8663040,4720384,4720896,4946944,4951808,8591360,16951296,16975872,24724224,6,124000,110592,4972544,292864,4720640,7502336,896,7735488,159104
.long 3333632,3691904,16777216,97024,170880,169984,9,0,2048,16777216,689664,5010944,159104,15360,2661376,2640896,2620416,2599936,2671616,3546112,3525632,3563520,150528,3724288,1524096,308096,7509760,7742912,154716,8668160,4721152,4722176,4987904,4992768,8596480,16951296,16975872,24724224,7,144480,114688,4993024,292864,4721664,7502592,896,7735488,159168
.long 3484672,3714560,94592,94208,222080,241664,15,0,2048,698240,696320,5658624,158720,0,2646016,2625536,2605056,2584576,2676736,3551232,3530752,3566592,143360,3719680,1377408,738176,7570432,7758080,748636,8673280,4734848,4735360,5520384,5525248,8581120,179520,188736,8084992,36,738400,102400,5586944,292864,4734976,7563264,896,7735488,158976
.long 3487232,3714944,16777216,95232,129536,129024,15,0,2048,16777216,696832,5661184,158848,5120,2651136,2630656,2610176,2589696,2681856,3556352,3535872,3568640,145408,3721216,1426560,758656,7570688,7758144,769116,8678400,4735616,4736640,5561344,5566208,8586240,184640,193856,8085248,37,758880,106496,5607424,292864,4736000,7563520,896,7735488,159040
.long 3535872,3722240,16777216,96256,16777216,243712,15,0,2048,16777216,697344,5663744,158976,10240,2656256,2635776,2615296,2594816,2666496,3540992,3520512,3561472,148480,3722752,1475712,779136,7570944,7758208,789596,8663040,4736768,4737280,5602304,5607168,8591360,16951616,16976192,24929024,38,779360,110592,5627904,292864,4737024,7563776,896,7735488,159104
.long 3538432,3722624,16777216,97024,183168,182272,9,0,2048,16777216,697856,5666304,159104,15360,2661376,2640896,2620416,2599936,2671616,3546112,3525632,3563520,150528,3724288,1524864,799616,7571200,7758272,810076,8668160,4737536,4738560,5643264,5648128,8596480,16951616,16976192,24929024,39,799840,114688,5648384,292864,4738048,7564032,896,7735488,159168
.long 3305472,3687680,87040,94208,230272,241664,15,0,2048,706432,704512,6313984,158720,0,2646016,2625536,2605056,2584576,2676736,3551232,3530752,3566592,143360,3719680,1378176,1229696,7631872,7773440,1403996,8673280,4751232,4751744,6175744,6180608,8581120,179840,189056,8289792,68,1393760,102400,6242304,292864,4751360,7624704,896,7735488,158976
.long 3308032,3688064,16777216,95232,130048,129024,15,0,2048,16777216,705024,6316544,158848,5120,2651136,2630656,2610176,2589696,2681856,3556352,3535872,3568640,145408,3721216,1427328,1250176,7632128,7773504,1424476,8678400,4752000,4753024,6216704,6221568,8586240,184960,194176,8290048,69,1414240,106496,6262784,292864,4752384,7624960,896,7735488,159040
.long 3356672,3695360,16777216,96256,16777216,243712,15,0,2048,16777216,705536,6319104,158976,10240,2656256,2635776,2615296,2594816,2666496,3540992,3520512,3561472,148480,3722752,1476480,1270656,7632384,7773568,1444956,8663040,4753152,4753664,6257664,6262528,8591360,16951936,16976512,25133824,70,1434720,110592,6283264,292864,4753408,7625216,896,7735488,159104
.long 3359232,3695744,16777216,97024,195456,194560,9,0,2048,16777216,706048,6321664,159104,15360,2661376,2640896,2620416,2599936,2671616,3546112,3525632,3563520,150528,3724288,1525632,1291136,7632640,7773632,1465436,8668160,4753920,4754944,6298624,6303488,8596480,16951936,16976512,25133824,71,1455200,114688,6303744,292864,4754432,7625472,896,7735488,159168
.long 3510272,3718400,95232,94208,238464,241664,15,0,2048,714624,712704,6969344,158720,0,2646016,2625536,2605056,2584576,2676736,3551232,3530752,3566592,143360,3719680,1378944,1721216,7693312,7788800,2059356,8673280,4767616,4768128,6831104,6835968,8581120,180160,189376,8494592,100,2049120,102400,6897664,292864,4767744,7686144,896,7735488,158976
.long 3512832,3718784,16777216,95232,130560,129024,15,0,2048,16777216,713216,6971904,158848,5120,2651136,2630656,2610176,2589696,2681856,3556352,3535872,3568640,145408,3721216,1428096,1741696,7693568,7788864,2079836,8678400,4768384,4769408,6872064,6876928,8586240,185280,194496,8494848,101,2069600,106496,6918144,292864,4768768,7686400,896,7735488,159040
.long 3561472,3726080,16777216,96256,16777216,243712,15,0,2048,16777216,713728,6974464,158976,10240,2656256,2635776,2615296,2594816,2666496,3540992,3520512,3561472,148480,3722752,1477248,1762176,7693824,7788928,2100316,8663040,4769536,4770048,6913024,6917888,8591360,16952256,16976832,25338624,102,2090080,110592,6938624,292864,4769792,7686656,896,7735488,159104
.long 3564032,3726464,16777216,97024,207744,206848,9,0,2048,16777216,714240,6977024,159104,15360,2661376,2640896,2620416,2599936,2671616,3546112,3525632,3563520,150528,3724288,1526400,1782656,7694080,7788992,2120796,8668160,4770304,4771328,6953984,6958848,8596480,16952256,16976832,25338624,103,2110560,114688,6959104,292864,4770816,7686912,896,7735488,159168
.long 2772992,3607808,66048,65536,214016,212992,15,8192,0,690176,690176,5013504,158720,0,1048576,1069056,1089536,1110016,1130496,2752512,2772992,2793472,143360,3604480,1572864,1024,7479296,7735296,163996,7946240,3739520,3740032,5013504,5029888,7864320,204800,214016,7884800,8,163840,102400,5013504,262144,3739648,7471104,1024,7733248,158720
.long 2775552,3608192,16777216,66560,98432,98304,15,8192,0,16777216,690688,5016064,158848,5120,1053696,1074176,1094656,1115136,1135616,2757632,2778112,2795520,145408,3606016,1622016,21504,7479552,7735360,184476,7951360,3740288,3741312,5054464,5070848,7869440,209920,219136,7885056,9,184320,106496,5033984,262144,3740672,7471360,1024,7733248,158784
.long 2824192,3615488,16777216,67584,16777216,215040,15,8192,0,16777216,691200,5018624,158976,10240,1058816,1079296,1099776,1120256,1140736,2762752,2783232,2798592,148480,3607552,1671168,41984,7479808,7735424,204956,7956480,3741440,3741952,5095424,5111808,7874560,225280,249856,7951360,10,204800,110592,5054464,262144,3741696,7471616,1024,7733248,158848
.long 2826752,3615872,16777216,68352,164864,163840,9,8192,0,16777216,691712,5021184,159104,15360,1063936,1084416,1104896,1125376,1145856,2767872,2788352,2800640,150528,3609088,1720320,62464,7480064,7735488,225436,7961600,3742208,3743232,5136384,5152768,7879680,17002496,17027072,24728576,11,225280,114688,5074944,262144,3742720,7471872,1024,7733248,158912
.long 2977792,3638528,74240,65536,222208,212992,15,8192,0,698368,698368,5668864,158720,0,1048576,1069056,1089536,1110016,1130496,2752512,2772992,2793472,143360,3604480,1573632,492544,7540736,7750656,819356,7946240,3755904,3756416,5668864,5685248,7864320,205120,214336,8089600,40,819200,102400,5668864,262144,3756032,7532544,1024,7733248,158720
.long 2980352,3638912,16777216,66560,98944,98304,15,8192,0,16777216,698880,5671424,158848,5120,1053696,1074176,1094656,1115136,1135616,2757632,2778112,2795520,145408,3606016,1622784,513024,7540992,7750720,839836,7951360,3756672,3757696,5709824,5726208,7869440,210240,219456,8089856,41,839680,106496,5689344,262144,3757056,7532800,1024,7733248,158784
.long 3028992,3646208,16777216,67584,16777216,215040,15,8192,0,16777216,699392,5673984,158976,10240,1058816,1079296,1099776,1120256,1140736,2762752,2783232,2798592,148480,3607552,1671936,533504,7541248,7750784,860316,7956480,3757824,3758336,5750784,5767168,7874560,225600,250176,8156160,42,860160,110592,5709824,262144,3758080,7533056,1024,7733248,158848
.long 3031552,3646592,16777216,68352,177152,176128,9,8192,0,16777216,699904,5676544,159104,15360,1063936,1084416,1104896,1125376,1145856,2767872,2788352,2800640,150528,3609088,1721088,553984,7541504,7750848,880796,7961600,3758592,3759616,5791744,5808128,7879680,17002816,17027392,24933376,43,880640,114688,5730304,262144,3759104,7533312,1024,7733248,158912
.long 2798592,3611648,66688,65536,230400,212992,15,8192,0,706560,706560,6324224,158720,0,1048576,1069056,1089536,1110016,1130496,2752512,2772992,2793472,143360,3604480,1574400,984064,7602176,7766016,1474716,7946240,3772288,3772800,6324224,6340608,7864320,205440,214656,8294400,72,1474560,102400,6324224,262144,3772416,7593984,1024,7733248,158720
.long 2801152,3612032,16777216,66560,99456,98304,15,8192,0,16777216,707072,6326784,158848,5120,1053696,1074176,1094656,1115136,1135616,2757632,2778112,2795520,145408,3606016,1623552,1004544,7602432,7766080,1495196,7951360,3773056,3774080,6365184,6381568,7869440,210560,219776,8294656,73,1495040,106496,6344704,262144,3773440,7594240,1024,7733248,158784
.long 2849792,3619328,16777216,67584,16777216,215040,15,8192,0,16777216,707584,6329344,158976,10240,1058816,1079296,1099776,1120256,1140736,2762752,2783232,2798592,148480,3607552,1672704,1025024,7602688,7766144,1515676,7956480,3774208,3774720,6406144,6422528,7874560,225920,250496,8360960,74,1515520,110592,6365184,262144,3774464,7594496,1024,7733248,158848
.long 2852352,3619712,16777216,68352,189440,188416,9,8192,0,16777216,708096,6331904,159104,15360,1063936,1084416,1104896,1125376,1145856,2767872,2788352,2800640,150528,3609088,1721856,1045504,7602944,7766208,1536156,7961600,3774976,3776000,6447104,6463488,7879680,17003136,17027712,25138176,75,1536000,114688,6385664,262144,3775488,7594752,1024,7733248,158912
.long 3003392,3642368,74880,65536,238592,212992,15,8192,0,714752,714752,6979584,158720,0,1048576,1069056,1089536,1110016,1130496,2752512,2772992,2793472,143360,3604480,1575168,1475584,7663616,7781376,2130076,7946240,3788672,3789184,6979584,6995968,7864320,205760,214976,8499200,104,2129920,102400,6979584,262144,3788800,7655424,1024,7733248,158720
.long 3005952,3642752,16777216,66560,99968,98304,15,8192,0,16777216,715264,6982144,158848,5120,1053696,1074176,1094656,1115136,1135616,2757632,2778112,2795520,145408,3606016,1624320,1496064,7663872,7781440,2150556,7951360,3789440,3790464,7020544,7036928,7869440,210880,220096,8499456,105,2150400,106496,7000064,262144,3789824,7655680,1024,7733248,158784
.long 3054592,3650048,16777216,67584,16777216,215040,15,8192,0,16777216,715776,6984704,158976,10240,1058816,1079296,1099776,1120256,1140736,2762752,2783232,2798592,148480,3607552,1673472,1516544,7664128,7781504,2171036,7956480,3790592,3791104,7061504,7077888,7874560,226240,250816,8565760,106,2170880,110592,7020544,262144,3790848,7655936,1024,7733248,158848
.long 3057152,3650432,16777216,68352,201728,200704,9,8192,0,16777216,716288,6987264,159104,15360,1063936,1084416,1104896,1125376,1145856,2767872,2788352,2800640,150528,3609088,1722624,1537024,7664384,7781568,2191516,7961600,3791360,3792384,7102464,7118848,7879680,17003456,17028032,25342976,107,2191360,114688,7041024,262144,3791872,7656192,1024,7733248,158912
.long 3182592,3669248,82432,81920,218112,212992,15,0,2048,691200,690176,5095424,158720,0,1867776,1888256,1908736,1929216,1949696,3162112,3182592,3203072,143360,3665920,1573248,246784,7510016,7742976,245916,7956480,4263808,4264320,5021696,5031936,7864320,204960,214176,7987200,12,245760,102400,5095424,278528,4263936,7501824,1024,7733248,158976
.long 3185152,3669632,16777216,82944,114816,114688,15,0,2048,16777216,690688,5097984,158848,5120,1872896,1893376,1913856,1934336,1954816,3167232,3187712,3205120,145408,3667456,1622400,267264,7510272,7743040,266396,7961600,4264576,4265600,5062656,5072896,7869440,210080,219296,7987456,13,266240,106496,5115904,278528,4264960,7502080,1024,7733248,159040
.long 3233792,3676928,16777216,83968,16777216,215040,15,0,2048,16777216,691200,5100544,158976,10240,1878016,1898496,1918976,1939456,1959936,3172352,3192832,3208192,148480,3668992,1671552,287744,7510528,7743104,286876,7946240,4265728,4266240,5103616,5113856,7874560,225440,250016,8053760,14,286720,110592,5136384,278528,4265984,7502336,1024,7733248,159104
.long 3236352,3677312,16777216,84736,171008,169984,9,0,2048,16777216,691712,5103104,159104,15360,1883136,1903616,1924096,1944576,1965056,3177472,3197952,3210240,150528,3670528,1720704,308224,7510784,7743168,307356,7951360,4266496,4267520,5144576,5154816,7879680,17002656,17027232,24830976,15,307200,114688,5156864,278528,4267008,7502592,1024,7733248,159168
.long 3387392,3699968,90624,81920,226304,212992,15,0,2048,699392,698368,5750784,158720,0,1867776,1888256,1908736,1929216,1949696,3162112,3182592,3203072,143360,3665920,1574016,738304,7571456,7758336,901276,7956480,4280192,4280704,5677056,5687296,7864320,205280,214496,8192000,44,901120,102400,5750784,278528,4280320,7563264,1024,7733248,158976
.long 3389952,3700352,16777216,82944,115328,114688,15,0,2048,16777216,698880,5753344,158848,5120,1872896,1893376,1913856,1934336,1954816,3167232,3187712,3205120,145408,3667456,1623168,758784,7571712,7758400,921756,7961600,4280960,4281984,5718016,5728256,7869440,210400,219616,8192256,45,921600,106496,5771264,278528,4281344,7563520,1024,7733248,159040
.long 3438592,3707648,16777216,83968,16777216,215040,15,0,2048,16777216,699392,5755904,158976,10240,1878016,1898496,1918976,1939456,1959936,3172352,3192832,3208192,148480,3668992,1672320,779264,7571968,7758464,942236,7946240,4282112,4282624,5758976,5769216,7874560,225760,250336,8258560,46,942080,110592,5791744,278528,4282368,7563776,1024,7733248,159104
.long 3441152,3708032,16777216,84736,183296,182272,9,0,2048,16777216,699904,5758464,159104,15360,1883136,1903616,1924096,1944576,1965056,3177472,3197952,3210240,150528,3670528,1721472,799744,7572224,7758528,962716,7951360,4282880,4283904,5799936,5810176,7879680,17002976,17027552,25035776,47,962560,114688,5812224,278528,4283392,7564032,1024,7733248,159168
.long 3208192,3673088,83072,81920,234496,212992,15,0,2048,707584,706560,6406144,158720,0,1867776,1888256,1908736,1929216,1949696,3162112,3182592,3203072,143360,3665920,1574784,1229824,7632896,7773696,1556636,7956480,4296576,4297088,6332416,6342656,7864320,205600,214816,8396800,76,1556480,102400,6406144,278528,4296704,7624704,1024,7733248,158976
.long 3210752,3673472,16777216,82944,115840,114688,15,0,2048,16777216,707072,6408704,158848,5120,1872896,1893376,1913856,1934336,1954816,3167232,3187712,3205120,145408,3667456,1623936,1250304,7633152,7773760,1577116,7961600,4297344,4298368,6373376,6383616,7869440,210720,219936,8397056,77,1576960,106496,6426624,278528,4297728,7624960,1024,7733248,159040
.long 3259392,3680768,16777216,83968,16777216,215040,15,0,2048,16777216,707584,6411264,158976,10240,1878016,1898496,1918976,1939456,1959936,3172352,3192832,3208192,148480,3668992,1673088,1270784,7633408,7773824,1597596,7946240,4298496,4299008,6414336,6424576,7874560,226080,250656,8463360,78,1597440,110592,6447104,278528,4298752,7625216,1024,7733248,159104
.long 3261952,3681152,16777216,84736,195584,194560,9,0,2048,16777216,708096,6413824,159104,15360,1883136,1903616,1924096,1944576,1965056,3177472,3197952,3210240,150528,3670528,1722240,1291264,7633664,7773888,1618076,7951360,4299264,4300288,6455296,6465536,7879680,17003296,17027872,25240576,79,1617920,114688,6467584,278528,4299776,7625472,1024,7733248,159168
.long 3412992,3703808,91264,81920,242688,212992,15,0,2048,715776,714752,7061504,158720,0,1867776,1888256,1908736,1929216,1949696,3162112,3182592,3203072,143360,3665920,1575552,1721344,7694336,7789056,2211996,7956480,4312960,4313472,6987776,6998016,7864320,205920,215136,8601600,108,2211840,102400,7061504,278528,4313088,7686144,1024,7733248,158976
.long 3415552,3704192,16777216,82944,116352,114688,15,0,2048,16777216,715264,7064064,158848,5120,1872896,1893376,1913856,1934336,1954816,3167232,3187712,3205120,145408,3667456,1624704,1741824,7694592,7789120,2232476,7961600,4313728,4314752,7028736,7038976,7869440,211040,220256,8601856,109,2232320,106496,7081984,278528,4314112,7686400,1024,7733248,159040
.long 3464192,3711488,16777216,83968,16777216,215040,15,0,2048,16777216,715776,7066624,158976,10240,1878016,1898496,1918976,1939456,1959936,3172352,3192832,3208192,148480,3668992,1673856,1762304,7694848,7789184,2252956,7946240,4314880,4315392,7069696,7079936,7874560,226400,250976,8668160,110,2252800,110592,7102464,278528,4315136,7686656,1024,7733248,159104
.long 3466752,3711872,16777216,84736,207872,206848,9,0,2048,16777216,716288,7069184,159104,15360,1883136,1903616,1924096,1944576,1965056,3177472,3197952,3210240,150528,3670528,1723008,1782784,7695104,7789248,2273436,7951360,4315648,4316672,7110656,7120896,7879680,17003616,17028192,25445376,111,2273280,114688,7122944,278528,4316160,7686912,1024,7733248,159168
.long 2875392,3623168,70144,65536,218240,217088,15,8192,0,690304,690176,5023744,158720,0,1171456,1150976,1212416,1191936,1243136,2813952,2834432,2849792,143360,3612160,1769472,1152,7480320,7735552,174236,8048640,3805056,3805568,5014528,5030144,7966720,230560,239776,7987712,8,164000,102400,5013504,264192,3805184,7471104,1152,7733568,158720
.long 2877952,3623552,16777216,66560,100480,100352,15,8192,0,16777216,690688,5026304,158848,5120,1176576,1156096,1217536,1197056,1248256,2819072,2839552,2851840,145408,3613696,1818624,21632,7480576,7735616,194716,8053760,3805824,3806848,5055488,5071104,7971840,235680,244896,7987968,9,184480,106496,5033984,264192,3806208,7471360,1152,7733568,158784
.long 2926592,3630848,16777216,67584,16777216,219136,15,8192,0,16777216,691200,5028864,158976,10240,1181696,1161216,1222656,1202176,1232896,2803712,2824192,2844672,148480,3615232,1867776,42112,7480832,7735680,215196,8058880,3806976,3807488,5096448,5112064,7976960,17002656,17027232,24830976,10,204960,110592,5054464,264192,3807232,7471616,1152,7733568,158848
.long 2929152,3631232,16777216,68352,164992,163840,9,8192,0,16777216,691712,5031424,159104,15360,1186816,1166336,1227776,1207296,1238016,2808832,2829312,2846720,150528,3616768,1916928,62592,7481088,7735744,235676,8064000,3807744,3808768,5137408,5153024,7982080,17002656,17027232,24830976,11,225440,114688,5074944,264192,3808256,7471872,1152,7733568,158912
.long 3080192,3653888,78336,65536,226432,217088,15,8192,0,698496,698368,5679104,158720,0,1171456,1150976,1212416,1191936,1243136,2813952,2834432,2849792,143360,3612160,1770240,492672,7541760,7750912,829596,8048640,3821440,3821952,5669888,5685504,7966720,230880,240096,8192512,40,819360,102400,5668864,264192,3821568,7532544,1152,7733568,158720
.long 3082752,3654272,16777216,66560,100992,100352,15,8192,0,16777216,698880,5681664,158848,5120,1176576,1156096,1217536,1197056,1248256,2819072,2839552,2851840,145408,3613696,1819392,513152,7542016,7750976,850076,8053760,3822208,3823232,5710848,5726464,7971840,236000,245216,8192768,41,839840,106496,5689344,264192,3822592,7532800,1152,7733568,158784
.long 3131392,3661568,16777216,67584,16777216,219136,15,8192,0,16777216,699392,5684224,158976,10240,1181696,1161216,1222656,1202176,1232896,2803712,2824192,2844672,148480,3615232,1868544,533632,7542272,7751040,870556,8058880,3823360,3823872,5751808,5767424,7976960,17002976,17027552,25035776,42,860320,110592,5709824,264192,3823616,7533056,1152,7733568,158848
.long 3133952,3661952,16777216,68352,177280,176128,9,8192,0,16777216,699904,5686784,159104,15360,1186816,1166336,1227776,1207296,1238016,2808832,2829312,2846720,150528,3616768,1917696,554112,7542528,7751104,891036,8064000,3824128,3825152,5792768,5808384,7982080,17002976,17027552,25035776,43,880800,114688,5730304,264192,3824640,7533312,1152,7733568,158912
.long 2900992,3627008,70784,65536,234624,217088,15,8192,0,706688,706560,6334464,158720,0,1171456,1150976,1212416,1191936,1243136,2813952,2834432,2849792,143360,3612160,1771008,984192,7603200,7766272,1484956,8048640,3837824,3838336,6325248,6340864,7966720,231200,240416,8397312,72,1474720,102400,6324224,264192,3837952,7593984,1152,7733568,158720
.long 2903552,3627392,16777216,66560,101504,100352,15,8192,0,16777216,707072,6337024,158848,5120,1176576,1156096,1217536,1197056,1248256,2819072,2839552,2851840,145408,3613696,1820160,1004672,7603456,7766336,1505436,8053760,3838592,3839616,6366208,6381824,7971840,236320,245536,8397568,73,1495200,106496,6344704,264192,3838976,7594240,1152,7733568,158784
.long 2952192,3634688,16777216,67584,16777216,219136,15,8192,0,16777216,707584,6339584,158976,10240,1181696,1161216,1222656,1202176,1232896,2803712,2824192,2844672,148480,3615232,1869312,1025152,7603712,7766400,1525916,8058880,3839744,3840256,6407168,6422784,7976960,17003296,17027872,25240576,74,1515680,110592,6365184,264192,3840000,7594496,1152,7733568,158848
.long 2954752,3635072,16777216,68352,189568,188416,9,8192,0,16777216,708096,6342144,159104,15360,1186816,1166336,1227776,1207296,1238016,2808832,2829312,2846720,150528,3616768,1918464,1045632,7603968,7766464,1546396,8064000,3840512,3841536,6448128,6463744,7982080,17003296,17027872,25240576,75,1536160,114688,6385664,264192,3841024,7594752,1152,7733568,158912
.long 3105792,3657728,78976,65536,242816,217088,15,8192,0,714880,714752,6989824,158720,0,1171456,1150976,1212416,1191936,1243136,2813952,2834432,2849792,143360,3612160,1771776,1475712,7664640,7781632,2140316,8048640,3854208,3854720,6980608,6996224,7966720,231520,240736,8602112,104,2130080,102400,6979584,264192,3854336,7655424,1152,7733568,158720
.long 3108352,3658112,16777216,66560,102016,100352,15,8192,0,16777216,715264,6992384,158848,5120,1176576,1156096,1217536,1197056,1248256,2819072,2839552,2851840,145408,3613696,1820928,1496192,7664896,7781696,2160796,8053760,3854976,3856000,7021568,7037184,7971840,236640,245856,8602368,105,2150560,106496,7000064,264192,3855360,7655680,1152,7733568,158784
.long 3156992,3665408,16777216,67584,16777216,219136,15,8192,0,16777216,715776,6994944,158976,10240,1181696,1161216,1222656,1202176,1232896,2803712,2824192,2844672,148480,3615232,1870080,1516672,7665152,7781760,2181276,8058880,3856128,3856640,7062528,7078144,7976960,17003616,17028192,25445376,106,2171040,110592,7020544,264192,3856384,7655936,1152,7733568,158848
.long 3159552,3665792,16777216,68352,201856,200704,9,8192,0,16777216,716288,6997504,159104,15360,1186816,1166336,1227776,1207296,1238016,2808832,2829312,2846720,150528,3616768,1919232,1537152,7665408,7781824,2201756,8064000,3856896,3857920,7103488,7119104,7982080,17003616,17028192,25445376,107,2191520,114688,7041024,264192,3857408,7656192,1152,7733568,158912
.long 3284992,3684608,86528,81920,222336,217088,15,0,2048,691328,690176,5105664,158720,0,1990656,1970176,2031616,2011136,2062336,3223552,3244032,3259392,143360,3673600,1769856,246912,7511040,7743232,256156,8058880,4329344,4329856,5022720,5032192,7966720,230720,239936,8090112,12,245920,102400,5095424,280576,4329472,7501824,1152,7733568,158976
.long 3287552,3684992,16777216,82944,116864,116736,15,0,2048,16777216,690688,5108224,158848,5120,1995776,1975296,2036736,2016256,2067456,3228672,3249152,3261440,145408,3675136,1819008,267392,7511296,7743296,276636,8064000,4330112,4331136,5063680,5073152,7971840,235840,245056,8090368,13,266400,106496,5115904,280576,4330496,7502080,1152,7733568,159040
.long 3336192,3692288,16777216,83968,16777216,219136,15,0,2048,16777216,691200,5110784,158976,10240,2000896,1980416,2041856,2021376,2052096,3213312,3233792,3254272,148480,3676672,1868160,287872,7511552,7743360,297116,8048640,4331264,4331776,5104640,5114112,7976960,17002816,17027392,24933376,14,286880,110592,5136384,280576,4331520,7502336,1152,7733568,159104
.long 3338752,3692672,16777216,84736,171136,169984,9,0,2048,16777216,691712,5113344,159104,15360,2006016,1985536,2046976,2026496,2057216,3218432,3238912,3256320,150528,3678208,1917312,308352,7511808,7743424,317596,8053760,4332032,4333056,5145600,5155072,7982080,17002816,17027392,24933376,15,307360,114688,5156864,280576,4332544,7502592,1152,7733568,159168
.long 3489792,3715328,94720,81920,230528,217088,15,0,2048,699520,698368,5761024,158720,0,1990656,1970176,2031616,2011136,2062336,3223552,3244032,3259392,143360,3673600,1770624,738432,7572480,7758592,911516,8058880,4345728,4346240,5678080,5687552,7966720,231040,240256,8294912,44,901280,102400,5750784,280576,4345856,7563264,1152,7733568,158976
.long 3492352,3715712,16777216,82944,117376,116736,15,0,2048,16777216,698880,5763584,158848,5120,1995776,1975296,2036736,2016256,2067456,3228672,3249152,3261440,145408,3675136,1819776,758912,7572736,7758656,931996,8064000,4346496,4347520,5719040,5728512,7971840,236160,245376,8295168,45,921760,106496,5771264,280576,4346880,7563520,1152,7733568,159040
.long 3540992,3723008,16777216,83968,16777216,219136,15,0,2048,16777216,699392,5766144,158976,10240,2000896,1980416,2041856,2021376,2052096,3213312,3233792,3254272,148480,3676672,1868928,779392,7572992,7758720,952476,8048640,4347648,4348160,5760000,5769472,7976960,17003136,17027712,25138176,46,942240,110592,5791744,280576,4347904,7563776,1152,7733568,159104
.long 3543552,3723392,16777216,84736,183424,182272,9,0,2048,16777216,699904,5768704,159104,15360,2006016,1985536,2046976,2026496,2057216,3218432,3238912,3256320,150528,3678208,1918080,799872,7573248,7758784,972956,8053760,4348416,4349440,5800960,5810432,7982080,17003136,17027712,25138176,47,962720,114688,5812224,280576,4348928,7564032,1152,7733568,159168
.long 3310592,3688448,87168,81920,238720,217088,15,0,2048,707712,706560,6416384,158720,0,1990656,1970176,2031616,2011136,2062336,3223552,3244032,3259392,143360,3673600,1771392,1229952,7633920,7773952,1566876,8058880,4362112,4362624,6333440,6342912,7966720,231360,240576,8499712,76,1556640,102400,6406144,280576,4362240,7624704,1152,7733568,158976
.long 3313152,3688832,16777216,82944,117888,116736,15,0,2048,16777216,707072,6418944,158848,5120,1995776,1975296,2036736,2016256,2067456,3228672,3249152,3261440,145408,3675136,1820544,1250432,7634176,7774016,1587356,8064000,4362880,4363904,6374400,6383872,7971840,236480,245696,8499968,77,1577120,106496,6426624,280576,4363264,7624960,1152,7733568,159040
.long 3361792,3696128,16777216,83968,16777216,219136,15,0,2048,16777216,707584,6421504,158976,10240,2000896,1980416,2041856,2021376,2052096,3213312,3233792,3254272,148480,3676672,1869696,1270912,7634432,7774080,1607836,8048640,4364032,4364544,6415360,6424832,7976960,17003456,17028032,25342976,78,1597600,110592,6447104,280576,4364288,7625216,1152,7733568,159104
.long 3364352,3696512,16777216,84736,195712,194560,9,0,2048,16777216,708096,6424064,159104,15360,2006016,1985536,2046976,2026496,2057216,3218432,3238912,3256320,150528,3678208,1918848,1291392,7634688,7774144,1628316,8053760,4364800,4365824,6456320,6465792,7982080,17003456,17028032,25342976,79,1618080,114688,6467584,280576,4365312,7625472,1152,7733568,159168
.long 3515392,3719168,95360,81920,214144,217088,15,0,2048,715904,714752,7071744,158720,0,1990656,1970176,2031616,2011136,2062336,3223552,3244032,3259392,143360,3673600,1772160,1721472,7695360,7789312,2222236,8058880,4378496,4379008,6988800,6998272,7966720,230400,239616,7885312,108,2212000,102400,7061504,280576,4378624,7686144,1152,7733568,158976
.long 3517952,3719552,16777216,82944,118400,116736,15,0,2048,16777216,715264,7074304,158848,5120,1995776,1975296,2036736,2016256,2067456,3228672,3249152,3261440,145408,3675136,1821312,1741952,7695616,7789376,2242716,8064000,4379264,4380288,7029760,7039232,7971840,235520,244736,7885568,109,2232480,106496,7081984,280576,4379648,7686400,1152,7733568,159040
.long 3566592,3726848,16777216,83968,16777216,219136,15,0,2048,16777216,715776,7076864,158976,10240,2000896,1980416,2041856,2021376,2052096,3213312,3233792,3254272,148480,3676672,1870464,1762432,7695872,7789440,2263196,8048640,4380416,4380928,7070720,7080192,7976960,17002496,17027072,24728576,110,2252960,110592,7102464,280576,4380672,7686656,1152,7733568,159104
.long 3569152,3727232,16777216,84736,208000,206848,9,0,2048,16777216,716288,7079424,159104,15360,2006016,1985536,2046976,2026496,2057216,3218432,3238912,3256320,150528,3678208,1919616,1782912,7696128,7789504,2283676,8053760,4381184,4382208,7111680,7121152,7982080,17002496,17027072,24728576,111,2273440,114688,7122944,280576,4381696,7686912,1152,7733568,159168
.long 1048576,3604480,66816,69632,222464,221184,15,8192,0,690432,690176,5033984,158720,0,1294336,1314816,1253376,1273856,1335296,2875392,2854912,2895872,143360,3619840,128,81920,7481344,7735808,164316,8151040,3870592,3871104,5015552,5030400,8069120,256320,265536,8094720,8,164160,102400,5013504,266240,3870720,7481344,0,7733888,158720
.long 1053696,3604864,16777216,70656,102528,102400,15,8192,0,16777216,690688,5036544,158848,5120,1299456,1319936,1258496,1278976,1340416,2880512,2860032,2897920,145408,3621376,49280,102400,7481600,7735872,184796,8156160,3871360,3872384,5056512,5071360,8074240,261440,270656,8094976,9,184640,106496,5033984,266240,3871744,7481600,0,7733888,158784
.long 1150976,3612160,16777216,71680,16777216,223232,15,8192,0,16777216,691200,5039104,158976,10240,1304576,1325056,1263616,1284096,1345536,2885632,2865152,2900992,148480,3622912,98432,122880,7481856,7735936,205276,8161280,3872512,3873024,5097472,5112320,8079360,276800,301376,8156416,10,205120,110592,5054464,266240,3872768,7481856,0,7733888,158848
.long 1156096,3612544,16777216,72448,165888,165888,9,8192,0,16777216,691712,5041664,159104,15360,1309696,1330176,1268736,1289216,1350656,2890752,2870272,2903040,150528,3624448,147584,143360,7482112,7736000,225756,8166400,3873280,3874304,5138432,5153280,8084480,17054016,17078592,24933632,11,225600,114688,5074944,266240,3873792,7482112,0,7733888,158912
.long 1458176,3635200,75008,69632,230656,221184,15,8192,0,698624,698368,5689344,158720,0,1294336,1314816,1253376,1273856,1335296,2875392,2854912,2895872,143360,3619840,896,573440,7542784,7751168,819676,8151040,3886976,3887488,5670912,5685760,8069120,256640,265856,8299520,40,819520,102400,5668864,266240,3887104,7542784,0,7733888,158720
.long 1463296,3635584,16777216,70656,103040,102400,15,8192,0,16777216,698880,5691904,158848,5120,1299456,1319936,1258496,1278976,1340416,2880512,2860032,2897920,145408,3621376,50048,593920,7543040,7751232,840156,8156160,3887744,3888768,5711872,5726720,8074240,261760,270976,8299776,41,840000,106496,5689344,266240,3888128,7543040,0,7733888,158784
.long 1560576,3642880,16777216,71680,16777216,223232,15,8192,0,16777216,699392,5694464,158976,10240,1304576,1325056,1263616,1284096,1345536,2885632,2865152,2900992,148480,3622912,99200,614400,7543296,7751296,860636,8161280,3888896,3889408,5752832,5767680,8079360,277120,301696,8361216,42,860480,110592,5709824,266240,3889152,7543296,0,7733888,158848
.long 1565696,3643264,16777216,72448,178176,178176,9,8192,0,16777216,699904,5697024,159104,15360,1309696,1330176,1268736,1289216,1350656,2890752,2870272,2903040,150528,3624448,148352,634880,7543552,7751360,881116,8166400,3889664,3890688,5793792,5808640,8084480,17054336,17078912,25138432,43,880960,114688,5730304,266240,3890176,7543552,0,7733888,158912
.long 1099776,3608320,67456,69632,238848,221184,15,8192,0,706816,706560,6344704,158720,0,1294336,1314816,1253376,1273856,1335296,2875392,2854912,2895872,143360,3619840,1664,1064960,7604224,7766528,1475036,8151040,3903360,3903872,6326272,6341120,8069120,256960,266176,8504320,72,1474880,102400,6324224,266240,3903488,7604224,0,7733888,158720
.long 1104896,3608704,16777216,70656,103552,102400,15,8192,0,16777216,707072,6347264,158848,5120,1299456,1319936,1258496,1278976,1340416,2880512,2860032,2897920,145408,3621376,50816,1085440,7604480,7766592,1495516,8156160,3904128,3905152,6367232,6382080,8074240,262080,271296,8504576,73,1495360,106496,6344704,266240,3904512,7604480,0,7733888,158784
.long 1202176,3616000,16777216,71680,16777216,223232,15,8192,0,16777216,707584,6349824,158976,10240,1304576,1325056,1263616,1284096,1345536,2885632,2865152,2900992,148480,3622912,99968,1105920,7604736,7766656,1515996,8161280,3905280,3905792,6408192,6423040,8079360,277440,302016,8566016,74,1515840,110592,6365184,266240,3905536,7604736,0,7733888,158848
.long 1207296,3616384,16777216,72448,190464,190464,9,8192,0,16777216,708096,6352384,159104,15360,1309696,1330176,1268736,1289216,1350656,2890752,2870272,2903040,150528,3624448,149120,1126400,7604992,7766720,1536476,8166400,3906048,3907072,6449152,6464000,8084480,17054656,17079232,25343232,75,1536320,114688,6385664,266240,3906560,7604992,0,7733888,158912
.long 1509376,3639040,75648,69632,214272,221184,15,8192,0,715008,714752,7000064,158720,0,1294336,1314816,1253376,1273856,1335296,2875392,2854912,2895872,143360,3619840,2432,1556480,7665664,7781888,2130396,8151040,3919744,3920256,6981632,6996480,8069120,256000,265216,7889920,104,2130240,102400,6979584,266240,3919872,7665664,0,7733888,158720
.long 1514496,3639424,16777216,70656,104064,102400,15,8192,0,16777216,715264,7002624,158848,5120,1299456,1319936,1258496,1278976,1340416,2880512,2860032,2897920,145408,3621376,51584,1576960,7665920,7781952,2150876,8156160,3920512,3921536,7022592,7037440,8074240,261120,270336,7890176,105,2150720,106496,7000064,266240,3920896,7665920,0,7733888,158784
.long 1611776,3646720,16777216,71680,16777216,223232,15,8192,0,16777216,715776,7005184,158976,10240,1304576,1325056,1263616,1284096,1345536,2885632,2865152,2900992,148480,3622912,100736,1597440,7666176,7782016,2171356,8161280,3921664,3922176,7063552,7078400,8079360,276480,301056,7951616,106,2171200,110592,7020544,266240,3921920,7666176,0,7733888,158848
.long 1616896,3647104,16777216,72448,202752,202752,9,8192,0,16777216,716288,7007744,159104,15360,1309696,1330176,1268736,1289216,1350656,2890752,2870272,2903040,150528,3624448,149888,1617920,7666432,7782080,2191836,8166400,3922432,3923456,7104512,7119360,8084480,17053696,17078272,24728832,107,2191680,114688,7041024,266240,3922944,7666432,0,7733888,158912
.long 1867776,3665920,83200,86016,226560,221184,15,0,2048,691456,690176,5115904,158720,0,2113536,2134016,2072576,2093056,2154496,3284992,3264512,3305472,143360,3681280,512,327680,7512064,7743488,246236,8161280,4394880,4395392,5023744,5032448,8069120,256480,265696,8197120,12,246080,102400,5095424,282624,4395008,7512064,0,7733888,158976
.long 1872896,3666304,16777216,87040,118912,118784,15,0,2048,16777216,690688,5118464,158848,5120,2118656,2139136,2077696,2098176,2159616,3290112,3269632,3307520,145408,3682816,49664,348160,7512320,7743552,266716,8166400,4395648,4396672,5064704,5073408,8074240,261600,270816,8197376,13,266560,106496,5115904,282624,4396032,7512320,0,7733888,159040
.long 1970176,3673600,16777216,88064,16777216,223232,15,0,2048,16777216,691200,5121024,158976,10240,2123776,2144256,2082816,2103296,2164736,3295232,3274752,3310592,148480,3684352,98816,368640,7512576,7743616,287196,8151040,4396800,4397312,5105664,5114368,8079360,276960,301536,8258816,14,287040,110592,5136384,282624,4397056,7512576,0,7733888,159104
.long 1975296,3673984,16777216,88832,172032,172032,9,0,2048,16777216,691712,5123584,159104,15360,2128896,2149376,2087936,2108416,2169856,3300352,3279872,3312640,150528,3685888,147968,389120,7512832,7743680,307676,8156160,4397568,4398592,5146624,5155328,8084480,17054176,17078752,25036032,15,307520,114688,5156864,282624,4398080,7512832,0,7733888,159168
.long 2277376,3696640,91392,86016,234752,221184,15,0,2048,699648,698368,5771264,158720,0,2113536,2134016,2072576,2093056,2154496,3284992,3264512,3305472,143360,3681280,1280,819200,7573504,7758848,901596,8161280,4411264,4411776,5679104,5687808,8069120,256800,266016,8401920,44,901440,102400,5750784,282624,4411392,7573504,0,7733888,158976
.long 2282496,3697024,16777216,87040,119424,118784,15,0,2048,16777216,698880,5773824,158848,5120,2118656,2139136,2077696,2098176,2159616,3290112,3269632,3307520,145408,3682816,50432,839680,7573760,7758912,922076,8166400,4412032,4413056,5720064,5728768,8074240,261920,271136,8402176,45,921920,106496,5771264,282624,4412416,7573760,0,7733888,159040
.long 2379776,3704320,16777216,88064,16777216,223232,15,0,2048,16777216,699392,5776384,158976,10240,2123776,2144256,2082816,2103296,2164736,3295232,3274752,3310592,148480,3684352,99584,860160,7574016,7758976,942556,8151040,4413184,4413696,5761024,5769728,8079360,277280,301856,8463616,46,942400,110592,5791744,282624,4413440,7574016,0,7733888,159104
.long 2384896,3704704,16777216,88832,184320,184320,9,0,2048,16777216,699904,5778944,159104,15360,2128896,2149376,2087936,2108416,2169856,3300352,3279872,3312640,150528,3685888,148736,880640,7574272,7759040,963036,8156160,4413952,4414976,5801984,5810688,8084480,17054496,17079072,25240832,47,962880,114688,5812224,282624,4414464,7574272,0,7733888,159168
.long 1918976,3669760,83840,86016,242944,221184,15,0,2048,707840,706560,6426624,158720,0,2113536,2134016,2072576,2093056,2154496,3284992,3264512,3305472,143360,3681280,2048,1310720,7634944,7774208,1556956,8161280,4427648,4428160,6334464,6343168,8069120,257120,266336,8606720,76,1556800,102400,6406144,282624,4427776,7634944,0,7733888,158976
.long 1924096,3670144,16777216,87040,119936,118784,15,0,2048,16777216,707072,6429184,158848,5120,2118656,2139136,2077696,2098176,2159616,3290112,3269632,3307520,145408,3682816,51200,1331200,7635200,7774272,1577436,8166400,4428416,4429440,6375424,6384128,8074240,262240,271456,8606976,77,1577280,106496,6426624,282624,4428800,7635200,0,7733888,159040
.long 2021376,3677440,16777216,88064,16777216,223232,15,0,2048,16777216,707584,6431744,158976,10240,2123776,2144256,2082816,2103296,2164736,3295232,3274752,3310592,148480,3684352,100352,1351680,7635456,7774336,1597916,8151040,4429568,4430080,6416384,6425088,8079360,277600,302176,8668416,78,1597760,110592,6447104,282624,4429824,7635456,0,7733888,159104
.long 2026496,3677824,16777216,88832,196608,196608,9,0,2048,16777216,708096,6434304,159104,15360,2128896,2149376,2087936,2108416,2169856,3300352,3279872,3312640,150528,3685888,149504,1372160,7635712,7774400,1618396,8156160,4430336,4431360,6457344,6466048,8084480,17054816,17079392,25445632,79,1618240,114688,6467584,282624,4430848,7635712,0,7733888,159168
.long 2328576,3700480,92032,86016,218368,221184,15,0,2048,716032,714752,7081984,158720,0,2113536,2134016,2072576,2093056,2154496,3284992,3264512,3305472,143360,3681280,2816,1802240,7696384,7789568,2212316,8161280,4444032,4444544,6989824,6998528,8069120,256160,265376,7992320,108,2212160,102400,7061504,282624,4444160,7696384,0,7733888,158976
.long 2333696,3700864,16777216,87040,120448,118784,15,0,2048,16777216,715264,7084544,158848,5120,2118656,2139136,2077696,2098176,2159616,3290112,3269632,3307520,145408,3682816,51968,1822720,7696640,7789632,2232796,8166400,4444800,4445824,7030784,7039488,8074240,261280,270496,7992576,109,2232640,106496,7081984,282624,4445184,7696640,0,7733888,159040
.long 2430976,3708160,16777216,88064,16777216,223232,15,0,2048,16777216,715776,7087104,158976,10240,2123776,2144256,2082816,2103296,2164736,3295232,3274752,3310592,148480,3684352,101120,1843200,7696896,7789696,2253276,8151040,4445952,4446464,7071744,7080448,8079360,276640,301216,8054016,110,2253120,110592,7102464,282624,4446208,7696896,0,7733888,159104
.long 2436096,3708544,16777216,88832,208896,208896,9,0,2048,16777216,716288,7089664,159104,15360,2128896,2149376,2087936,2108416,2169856,3300352,3279872,3312640,150528,3685888,150272,1863680,7697152,7789760,2273756,8156160,4446720,4447744,7112704,7121408,8084480,17053856,17078432,24831232,111,2273600,114688,7122944,282624,4447232,7697152,0,7733888,159168
.long 1253376,3619840,70912,69632,226688,225280,15,8192,0,690560,690176,5044224,158720,0,1417216,1396736,1376256,1355776,1447936,2936832,2916352,2952192,143360,3627520,196736,82048,7482368,7736064,174556,8253440,3936128,3936640,5016576,5030656,8171520,282080,291296,8197632,8,164320,102400,5013504,268288,3936256,7481344,128,7734208,158720
.long 1258496,3620224,16777216,70656,104576,104448,15,8192,0,16777216,690688,5046784,158848,5120,1422336,1401856,1381376,1360896,1453056,2941952,2921472,2954240,145408,3629056,245888,102528,7482624,7736128,195036,8258560,3936896,3937920,5057536,5071616,8176640,287200,296416,8197888,9,184800,106496,5033984,268288,3937280,7481600,128,7734208,158784
.long 1355776,3627520,16777216,71680,16777216,227328,15,8192,0,16777216,691200,5049344,158976,10240,1427456,1406976,1386496,1366016,1437696,2926592,2906112,2947072,148480,3630592,295040,123008,7482880,7736192,215516,8263680,3938048,3938560,5098496,5112576,8181760,17054176,17078752,25036032,10,205280,110592,5054464,268288,3938304,7481856,128,7734208,158848
.long 1360896,3627904,16777216,72448,166016,165888,9,8192,0,16777216,691712,5051904,159104,15360,1432576,1412096,1391616,1371136,1442816,2931712,2911232,2949120,150528,3632128,344192,143488,7483136,7736256,235996,8268800,3938816,3939840,5139456,5153536,8186880,17054176,17078752,25036032,11,225760,114688,5074944,268288,3939328,7482112,128,7734208,158912
.long 1662976,3650560,79104,69632,234880,225280,15,8192,0,698752,698368,5699584,158720,0,1417216,1396736,1376256,1355776,1447936,2936832,2916352,2952192,143360,3627520,197504,573568,7543808,7751424,829916,8253440,3952512,3953024,5671936,5686016,8171520,282400,291616,8402432,40,819680,102400,5668864,268288,3952640,7542784,128,7734208,158720
.long 1668096,3650944,16777216,70656,105088,104448,15,8192,0,16777216,698880,5702144,158848,5120,1422336,1401856,1381376,1360896,1453056,2941952,2921472,2954240,145408,3629056,246656,594048,7544064,7751488,850396,8258560,3953280,3954304,5712896,5726976,8176640,287520,296736,8402688,41,840160,106496,5689344,268288,3953664,7543040,128,7734208,158784
.long 1765376,3658240,16777216,71680,16777216,227328,15,8192,0,16777216,699392,5704704,158976,10240,1427456,1406976,1386496,1366016,1437696,2926592,2906112,2947072,148480,3630592,295808,614528,7544320,7751552,870876,8263680,3954432,3954944,5753856,5767936,8181760,17054496,17079072,25240832,42,860640,110592,5709824,268288,3954688,7543296,128,7734208,158848
.long 1770496,3658624,16777216,72448,178304,178176,9,8192,0,16777216,699904,5707264,159104,15360,1432576,1412096,1391616,1371136,1442816,2931712,2911232,2949120,150528,3632128,344960,635008,7544576,7751616,891356,8268800,3955200,3956224,5794816,5808896,8186880,17054496,17079072,25240832,43,881120,114688,5730304,268288,3955712,7543552,128,7734208,158912
.long 1304576,3623680,71552,69632,243072,225280,15,8192,0,706944,706560,6354944,158720,0,1417216,1396736,1376256,1355776,1447936,2936832,2916352,2952192,143360,3627520,198272,1065088,7605248,7766784,1485276,8253440,3968896,3969408,6327296,6341376,8171520,282720,291936,8607232,72,1475040,102400,6324224,268288,3969024,7604224,128,7734208,158720
.long 1309696,3624064,16777216,70656,105600,104448,15,8192,0,16777216,707072,6357504,158848,5120,1422336,1401856,1381376,1360896,1453056,2941952,2921472,2954240,145408,3629056,247424,1085568,7605504,7766848,1505756,8258560,3969664,3970688,6368256,6382336,8176640,287840,297056,8607488,73,1495520,106496,6344704,268288,3970048,7604480,128,7734208,158784
.long 1406976,3631360,16777216,71680,16777216,227328,15,8192,0,16777216,707584,6360064,158976,10240,1427456,1406976,1386496,1366016,1437696,2926592,2906112,2947072,148480,3630592,296576,1106048,7605760,7766912,1526236,8263680,3970816,3971328,6409216,6423296,8181760,17054816,17079392,25445632,74,1516000,110592,6365184,268288,3971072,7604736,128,7734208,158848
.long 1412096,3631744,16777216,72448,190592,190464,9,8192,0,16777216,708096,6362624,159104,15360,1432576,1412096,1391616,1371136,1442816,2931712,2911232,2949120,150528,3632128,345728,1126528,7606016,7766976,1546716,8268800,3971584,3972608,6450176,6464256,8186880,17054816,17079392,25445632,75,1536480,114688,6385664,268288,3972096,7604992,128,7734208,158912
.long 1714176,3654400,79744,69632,218496,225280,15,8192,0,715136,714752,7010304,158720,0,1417216,1396736,1376256,1355776,1447936,2936832,2916352,2952192,143360,3627520,199040,1556608,7666688,7782144,2140636,8253440,3985280,3985792,6982656,6996736,8171520,281760,290976,7992832,104,2130400,102400,6979584,268288,3985408,7665664,128,7734208,158720
.long 1719296,3654784,16777216,70656,106112,104448,15,8192,0,16777216,715264,7012864,158848,5120,1422336,1401856,1381376,1360896,1453056,2941952,2921472,2954240,145408,3629056,248192,1577088,7666944,7782208,2161116,8258560,3986048,3987072,7023616,7037696,8176640,286880,296096,7993088,105,2150880,106496,7000064,268288,3986432,7665920,128,7734208,158784
.long 1816576,3662080,16777216,71680,16777216,227328,15,8192,0,16777216,715776,7015424,158976,10240,1427456,1406976,1386496,1366016,1437696,2926592,2906112,2947072,148480,3630592,297344,1597568,7667200,7782272,2181596,8263680,3987200,3987712,7064576,7078656,8181760,17053856,17078432,24831232,106,2171360,110592,7020544,268288,3987456,7666176,128,7734208,158848
.long 1821696,3662464,16777216,72448,202880,202752,9,8192,0,16777216,716288,7017984,159104,15360,1432576,1412096,1391616,1371136,1442816,2931712,2911232,2949120,150528,3632128,346496,1618048,7667456,7782336,2202076,8268800,3987968,3988992,7105536,7119616,8186880,17053856,17078432,24831232,107,2191840,114688,7041024,268288,3988480,7666432,128,7734208,158912
.long 2072576,3681280,87296,86016,230784,225280,15,0,2048,691584,690176,5126144,158720,0,2236416,2215936,2195456,2174976,2267136,3346432,3325952,3361792,143360,3688960,197120,327808,7513088,7743744,256476,8263680,4460416,4460928,5024768,5032704,8171520,282240,291456,8300032,12,246240,102400,5095424,284672,4460544,7512064,128,7734208,158976
.long 2077696,3681664,16777216,87040,120960,120832,15,0,2048,16777216,690688,5128704,158848,5120,2241536,2221056,2200576,2180096,2272256,3351552,3331072,3363840,145408,3690496,246272,348288,7513344,7743808,276956,8268800,4461184,4462208,5065728,5073664,8176640,287360,296576,8300288,13,266720,106496,5115904,284672,4461568,7512320,128,7734208,159040
.long 2174976,3688960,16777216,88064,16777216,227328,15,0,2048,16777216,691200,5131264,158976,10240,2246656,2226176,2205696,2185216,2256896,3336192,3315712,3356672,148480,3692032,295424,368768,7513600,7743872,297436,8253440,4462336,4462848,5106688,5114624,8181760,17054336,17078912,25138432,14,287200,110592,5136384,284672,4462592,7512576,128,7734208,159104
.long 2180096,3689344,16777216,88832,172160,172032,9,0,2048,16777216,691712,5133824,159104,15360,2251776,2231296,2210816,2190336,2262016,3341312,3320832,3358720,150528,3693568,344576,389248,7513856,7743936,317916,8258560,4463104,4464128,5147648,5155584,8186880,17054336,17078912,25138432,15,307680,114688,5156864,284672,4463616,7512832,128,7734208,159168
.long 2482176,3712000,95488,86016,238976,225280,15,0,2048,699776,698368,5781504,158720,0,2236416,2215936,2195456,2174976,2267136,3346432,3325952,3361792,143360,3688960,197888,819328,7574528,7759104,911836,8263680,4476800,4477312,5680128,5688064,8171520,282560,291776,8504832,44,901600,102400,5750784,284672,4476928,7573504,128,7734208,158976
.long 2487296,3712384,16777216,87040,121472,120832,15,0,2048,16777216,698880,5784064,158848,5120,2241536,2221056,2200576,2180096,2272256,3351552,3331072,3363840,145408,3690496,247040,839808,7574784,7759168,932316,8268800,4477568,4478592,5721088,5729024,8176640,287680,296896,8505088,45,922080,106496,5771264,284672,4477952,7573760,128,7734208,159040
.long 2584576,3719680,16777216,88064,16777216,227328,15,0,2048,16777216,699392,5786624,158976,10240,2246656,2226176,2205696,2185216,2256896,3336192,3315712,3356672,148480,3692032,296192,860288,7575040,7759232,952796,8253440,4478720,4479232,5762048,5769984,8181760,17054656,17079232,25343232,46,942560,110592,5791744,284672,4478976,7574016,128,7734208,159104
.long 2589696,3720064,16777216,88832,184448,184320,9,0,2048,16777216,699904,5789184,159104,15360,2251776,2231296,2210816,2190336,2262016,3341312,3320832,3358720,150528,3693568,345344,880768,7575296,7759296,973276,8258560,4479488,4480512,5803008,5810944,8186880,17054656,17079232,25343232,47,963040,114688,5812224,284672,4480000,7574272,128,7734208,159168
.long 2123776,3685120,87936,86016,214400,225280,15,0,2048,707968,706560,6436864,158720,0,2236416,2215936,2195456,2174976,2267136,3346432,3325952,3361792,143360,3688960,198656,1310848,7635968,7774464,1567196,8263680,4493184,4493696,6335488,6343424,8171520,281600,290816,7890432,76,1556960,102400,6406144,284672,4493312,7634944,128,7734208,158976
.long 2128896,3685504,16777216,87040,121984,120832,15,0,2048,16777216,707072,6439424,158848,5120,2241536,2221056,2200576,2180096,2272256,3351552,3331072,3363840,145408,3690496,247808,1331328,7636224,7774528,1587676,8268800,4493952,4494976,6376448,6384384,8176640,286720,295936,7890688,77,1577440,106496,6426624,284672,4494336,7635200,128,7734208,159040
.long 2226176,3692800,16777216,88064,16777216,227328,15,0,2048,16777216,707584,6441984,158976,10240,2246656,2226176,2205696,2185216,2256896,3336192,3315712,3356672,148480,3692032,296960,1351808,7636480,7774592,1608156,8253440,4495104,4495616,6417408,6425344,8181760,17053696,17078272,24728832,78,1597920,110592,6447104,284672,4495360,7635456,128,7734208,159104
.long 2231296,3693184,16777216,88832,196736,196608,9,0,2048,16777216,708096,6444544,159104,15360,2251776,2231296,2210816,2190336,2262016,3341312,3320832,3358720,150528,3693568,346112,1372288,7636736,7774656,1628636,8258560,4495872,4496896,6458368,6466304,8186880,17053696,17078272,24728832,79,1618400,114688,6467584,284672,4496384,7635712,128,7734208,159168
.long 2533376,3715840,96128,86016,222592,225280,15,0,2048,716160,714752,7092224,158720,0,2236416,2215936,2195456,2174976,2267136,3346432,3325952,3361792,143360,3688960,199424,1802368,7697408,7789824,2222556,8263680,4509568,4510080,6990848,6998784,8171520,281920,291136,8095232,108,2212320,102400,7061504,284672,4509696,7696384,128,7734208,158976
.long 2538496,3716224,16777216,87040,122496,120832,15,0,2048,16777216,715264,7094784,158848,5120,2241536,2221056,2200576,2180096,2272256,3351552,3331072,3363840,145408,3690496,248576,1822848,7697664,7789888,2243036,8268800,4510336,4511360,7031808,7039744,8176640,287040,296256,8095488,109,2232800,106496,7081984,284672,4510720,7696640,128,7734208,159040
.long 2635776,3723520,16777216,88064,16777216,227328,15,0,2048,16777216,715776,7097344,158976,10240,2246656,2226176,2205696,2185216,2256896,3336192,3315712,3356672,148480,3692032,297728,1843328,7697920,7789952,2263516,8253440,4511488,4512000,7072768,7080704,8181760,17054016,17078592,24933632,110,2253280,110592,7102464,284672,4511744,7696896,128,7734208,159104
.long 2640896,3723904,16777216,88832,209024,208896,9,0,2048,16777216,716288,7099904,159104,15360,2251776,2231296,2210816,2190336,2262016,3341312,3320832,3358720,150528,3693568,346880,1863808,7698176,7790016,2283996,8258560,4512256,4513280,7113728,7121664,8186880,17054016,17078592,24933632,111,2273760,114688,7122944,284672,4512768,7697152,128,7734208,159168
.long 1058816,3605248,66944,73728,230912,229376,15,8192,0,690688,690176,5054464,158720,0,1458176,1478656,1499136,1519616,1540096,2957312,2977792,2998272,143360,3635200,393344,82176,7483392,7736320,164636,8355840,4001664,4002176,5017600,5030912,8273920,307840,317056,8304640,8,164480,102400,5013504,270336,4001792,7481344,256,7734528,158720
.long 1063936,3605632,16777216,74752,106624,106496,15,8192,0,16777216,690688,5057024,158848,5120,1463296,1483776,1504256,1524736,1545216,2962432,2982912,3000320,145408,3636736,442496,102656,7483648,7736384,185116,8360960,4002432,4003456,5058560,5071872,8279040,312960,322176,8304896,9,184960,106496,5033984,270336,4002816,7481600,256,7734528,158784
.long 1161216,3612928,16777216,75776,16777216,231424,15,8192,0,16777216,691200,5059584,158976,10240,1468416,1488896,1509376,1529856,1550336,2967552,2988032,3003392,148480,3638272,491648,123136,7483904,7736448,205596,8366080,4003584,4004096,5099520,5112832,8284160,328320,352896,8361472,10,205440,110592,5054464,270336,4003840,7481856,256,7734528,158848
.long 1166336,3613312,16777216,76544,166144,165888,9,8192,0,16777216,691712,5062144,159104,15360,1473536,1494016,1514496,1534976,1555456,2972672,2993152,3005440,150528,3639808,540800,143616,7484160,7736512,226076,8371200,4004352,4005376,5140480,5153792,8289280,17105536,17130112,25138688,11,225920,114688,5074944,270336,4004864,7482112,256,7734528,158912
.long 1468416,3635968,75136,73728,239104,229376,15,8192,0,698880,698368,5709824,158720,0,1458176,1478656,1499136,1519616,1540096,2957312,2977792,2998272,143360,3635200,394112,573696,7544832,7751680,819996,8355840,4018048,4018560,5672960,5686272,8273920,308160,317376,8509440,40,819840,102400,5668864,270336,4018176,7542784,256,7734528,158720
.long 1473536,3636352,16777216,74752,107136,106496,15,8192,0,16777216,698880,5712384,158848,5120,1463296,1483776,1504256,1524736,1545216,2962432,2982912,3000320,145408,3636736,443264,594176,7545088,7751744,840476,8360960,4018816,4019840,5713920,5727232,8279040,313280,322496,8509696,41,840320,106496,5689344,270336,4019200,7543040,256,7734528,158784
.long 1570816,3643648,16777216,75776,16777216,231424,15,8192,0,16777216,699392,5714944,158976,10240,1468416,1488896,1509376,1529856,1550336,2967552,2988032,3003392,148480,3638272,492416,614656,7545344,7751808,860956,8366080,4019968,4020480,5754880,5768192,8284160,328640,353216,8566272,42,860800,110592,5709824,270336,4020224,7543296,256,7734528,158848
.long 1575936,3644032,16777216,76544,178432,178176,9,8192,0,16777216,699904,5717504,159104,15360,1473536,1494016,1514496,1534976,1555456,2972672,2993152,3005440,150528,3639808,541568,635136,7545600,7751872,881436,8371200,4020736,4021760,5795840,5809152,8289280,17105856,17130432,25343488,43,881280,114688,5730304,270336,4021248,7543552,256,7734528,158912
.long 1110016,3609088,67584,73728,214528,229376,15,8192,0,707072,706560,6365184,158720,0,1458176,1478656,1499136,1519616,1540096,2957312,2977792,2998272,143360,3635200,394880,1065216,7606272,7767040,1475356,8355840,4034432,4034944,6328320,6341632,8273920,307200,316416,7895040,72,1475200,102400,6324224,270336,4034560,7604224,256,7734528,158720
.long 1115136,3609472,16777216,74752,107648,106496,15,8192,0,16777216,707072,6367744,158848,5120,1463296,1483776,1504256,1524736,1545216,2962432,2982912,3000320,145408,3636736,444032,1085696,7606528,7767104,1495836,8360960,4035200,4036224,6369280,6382592,8279040,312320,321536,7895296,73,1495680,106496,6344704,270336,4035584,7604480,256,7734528,158784
.long 1212416,3616768,16777216,75776,16777216,231424,15,8192,0,16777216,707584,6370304,158976,10240,1468416,1488896,1509376,1529856,1550336,2967552,2988032,3003392,148480,3638272,493184,1106176,7606784,7767168,1516316,8366080,4036352,4036864,6410240,6423552,8284160,327680,352256,7951872,74,1516160,110592,6365184,270336,4036608,7604736,256,7734528,158848
.long 1217536,3617152,16777216,76544,190720,190464,9,8192,0,16777216,708096,6372864,159104,15360,1473536,1494016,1514496,1534976,1555456,2972672,2993152,3005440,150528,3639808,542336,1126656,7607040,7767232,1536796,8371200,4037120,4038144,6451200,6464512,8289280,17104896,17129472,24729088,75,1536640,114688,6385664,270336,4037632,7604992,256,7734528,158912
.long 1519616,3639808,75776,73728,222720,229376,15,8192,0,715264,714752,7020544,158720,0,1458176,1478656,1499136,1519616,1540096,2957312,2977792,2998272,143360,3635200,395648,1556736,7667712,7782400,2130716,8355840,4050816,4051328,6983680,6996992,8273920,307520,316736,8099840,104,2130560,102400,6979584,270336,4050944,7665664,256,7734528,158720
.long 1524736,3640192,16777216,74752,108160,106496,15,8192,0,16777216,715264,7023104,158848,5120,1463296,1483776,1504256,1524736,1545216,2962432,2982912,3000320,145408,3636736,444800,1577216,7667968,7782464,2151196,8360960,4051584,4052608,7024640,7037952,8279040,312640,321856,8100096,105,2151040,106496,7000064,270336,4051968,7665920,256,7734528,158784
.long 1622016,3647488,16777216,75776,16777216,231424,15,8192,0,16777216,715776,7025664,158976,10240,1468416,1488896,1509376,1529856,1550336,2967552,2988032,3003392,148480,3638272,493952,1597696,7668224,7782528,2171676,8366080,4052736,4053248,7065600,7078912,8284160,328000,352576,8156672,106,2171520,110592,7020544,270336,4052992,7666176,256,7734528,158848
.long 1627136,3647872,16777216,76544,203008,202752,9,8192,0,16777216,716288,7028224,159104,15360,1473536,1494016,1514496,1534976,1555456,2972672,2993152,3005440,150528,3639808,543104,1618176,7668480,7782592,2192156,8371200,4053504,4054528,7106560,7119872,8289280,17105216,17129792,24933888,107,2192000,114688,7041024,270336,4054016,7666432,256,7734528,158912
.long 1878016,3666688,83328,90112,235008,229376,15,0,2048,691712,690176,5136384,158720,0,2277376,2297856,2318336,2338816,2359296,3366912,3387392,3407872,143360,3696640,393728,327936,7514112,7744000,246556,8366080,4525952,4526464,5025792,5032960,8273920,308000,317216,8407040,12,246400,102400,5095424,286720,4526080,7512064,256,7734528,158976
.long 1883136,3667072,16777216,91136,123008,122880,15,0,2048,16777216,690688,5138944,158848,5120,2282496,2302976,2323456,2343936,2364416,3372032,3392512,3409920,145408,3698176,442880,348416,7514368,7744064,267036,8371200,4526720,4527744,5066752,5073920,8279040,313120,322336,8407296,13,266880,106496,5115904,286720,4527104,7512320,256,7734528,159040
.long 1980416,3674368,16777216,92160,16777216,231424,15,0,2048,16777216,691200,5141504,158976,10240,2287616,2308096,2328576,2349056,2369536,3377152,3397632,3412992,148480,3699712,492032,368896,7514624,7744128,287516,8355840,4527872,4528384,5107712,5114880,8284160,328480,353056,8463872,14,287360,110592,5136384,286720,4528128,7512576,256,7734528,159104
.long 1985536,3674752,16777216,92928,172288,172032,9,0,2048,16777216,691712,5144064,159104,15360,2292736,2313216,2333696,2354176,2374656,3382272,3402752,3415040,150528,3701248,541184,389376,7514880,7744192,307996,8360960,4528640,4529664,5148672,5155840,8289280,17105696,17130272,25241088,15,307840,114688,5156864,286720,4529152,7512832,256,7734528,159168
.long 2287616,3697408,91520,90112,243200,229376,15,0,2048,699904,698368,5791744,158720,0,2277376,2297856,2318336,2338816,2359296,3366912,3387392,3407872,143360,3696640,394496,819456,7575552,7759360,901916,8366080,4542336,4542848,5681152,5688320,8273920,308320,317536,8611840,44,901760,102400,5750784,286720,4542464,7573504,256,7734528,158976
.long 2292736,3697792,16777216,91136,123520,122880,15,0,2048,16777216,698880,5794304,158848,5120,2282496,2302976,2323456,2343936,2364416,3372032,3392512,3409920,145408,3698176,443648,839936,7575808,7759424,922396,8371200,4543104,4544128,5722112,5729280,8279040,313440,322656,8612096,45,922240,106496,5771264,286720,4543488,7573760,256,7734528,159040
.long 2390016,3705088,16777216,92160,16777216,231424,15,0,2048,16777216,699392,5796864,158976,10240,2287616,2308096,2328576,2349056,2369536,3377152,3397632,3412992,148480,3699712,492800,860416,7576064,7759488,942876,8355840,4544256,4544768,5763072,5770240,8284160,328800,353376,8668672,46,942720,110592,5791744,286720,4544512,7574016,256,7734528,159104
.long 2395136,3705472,16777216,92928,184576,184320,9,0,2048,16777216,699904,5799424,159104,15360,2292736,2313216,2333696,2354176,2374656,3382272,3402752,3415040,150528,3701248,541952,880896,7576320,7759552,963356,8360960,4545024,4546048,5804032,5811200,8289280,17106016,17130592,25445888,47,963200,114688,5812224,286720,4545536,7574272,256,7734528,159168
.long 1929216,3670528,83968,90112,218624,229376,15,0,2048,708096,706560,6447104,158720,0,2277376,2297856,2318336,2338816,2359296,3366912,3387392,3407872,143360,3696640,395264,1310976,7636992,7774720,1557276,8366080,4558720,4559232,6336512,6343680,8273920,307360,316576,7997440,76,1557120,102400,6406144,286720,4558848,7634944,256,7734528,158976
.long 1934336,3670912,16777216,91136,124032,122880,15,0,2048,16777216,707072,6449664,158848,5120,2282496,2302976,2323456,2343936,2364416,3372032,3392512,3409920,145408,3698176,444416,1331456,7637248,7774784,1577756,8371200,4559488,4560512,6377472,6384640,8279040,312480,321696,7997696,77,1577600,106496,6426624,286720,4559872,7635200,256,7734528,159040
.long 2031616,3678208,16777216,92160,16777216,231424,15,0,2048,16777216,707584,6452224,158976,10240,2287616,2308096,2328576,2349056,2369536,3377152,3397632,3412992,148480,3699712,493568,1351936,7637504,7774848,1598236,8355840,4560640,4561152,6418432,6425600,8284160,327840,352416,8054272,78,1598080,110592,6447104,286720,4560896,7635456,256,7734528,159104
.long 2036736,3678592,16777216,92928,196864,196608,9,0,2048,16777216,708096,6454784,159104,15360,2292736,2313216,2333696,2354176,2374656,3382272,3402752,3415040,150528,3701248,542720,1372416,7637760,7774912,1618716,8360960,4561408,4562432,6459392,6466560,8289280,17105056,17129632,24831488,79,1618560,114688,6467584,286720,4561920,7635712,256,7734528,159168
.long 2338816,3701248,92160,90112,226816,229376,15,0,2048,716288,714752,7102464,158720,0,2277376,2297856,2318336,2338816,2359296,3366912,3387392,3407872,143360,3696640,396032,1802496,7698432,7790080,2212636,8366080,4575104,4575616,6991872,6999040,8273920,307680,316896,8202240,108,2212480,102400,7061504,286720,4575232,7696384,256,7734528,158976
.long 2343936,3701632,16777216,91136,124544,122880,15,0,2048,16777216,715264,7105024,158848,5120,2282496,2302976,2323456,2343936,2364416,3372032,3392512,3409920,145408,3698176,445184,1822976,7698688,7790144,2233116,8371200,4575872,4576896,7032832,7040000,8279040,312800,322016,8202496,109,2232960,106496,7081984,286720,4576256,7696640,256,7734528,159040
.long 2441216,3708928,16777216,92160,16777216,231424,15,0,2048,16777216,715776,7107584,158976,10240,2287616,2308096,2328576,2349056,2369536,3377152,3397632,3412992,148480,3699712,494336,1843456,7698944,7790208,2253596,8355840,4577024,4577536,7073792,7080960,8284160,328160,352736,8259072,110,2253440,110592,7102464,286720,4577280,7696896,256,7734528,159104
.long 2446336,3709312,16777216,92928,209152,208896,9,0,2048,16777216,716288,7110144,159104,15360,2292736,2313216,2333696,2354176,2374656,3382272,3402752,3415040,150528,3701248,543488,1863936,7699200,7790272,2274076,8360960,4577792,4578816,7114752,7121920,8289280,17105376,17129952,25036288,111,2273920,114688,7122944,286720,4578304,7697152,256,7734528,159168
.long 1263616,3620608,71040,73728,235136,233472,15,8192,0,690816,690176,5064704,158720,0,1581056,1560576,1622016,1601536,1652736,3018752,3039232,3054592,143360,3642880,589952,82304,7484416,7736576,174876,8458240,4067200,4067712,5018624,5031168,8376320,333600,342816,8407552,8,164640,102400,5013504,272384,4067328,7481344,384,7734848,158720
.long 1268736,3620992,16777216,74752,108672,108544,15,8192,0,16777216,690688,5067264,158848,5120,1586176,1565696,1627136,1606656,1657856,3023872,3044352,3056640,145408,3644416,639104,102784,7484672,7736640,195356,8463360,4067968,4068992,5059584,5072128,8381440,338720,347936,8407808,9,185120,106496,5033984,272384,4068352,7481600,384,7734848,158784
.long 1366016,3628288,16777216,75776,16777216,235520,15,8192,0,16777216,691200,5069824,158976,10240,1591296,1570816,1632256,1611776,1642496,3008512,3028992,3049472,148480,3645952,688256,123264,7484928,7736704,215836,8468480,4069120,4069632,5100544,5113088,8386560,17105696,17130272,25241088,10,205600,110592,5054464,272384,4069376,7481856,384,7734848,158848
.long 1371136,3628672,16777216,76544,166272,165888,9,8192,0,16777216,691712,5072384,159104,15360,1596416,1575936,1637376,1616896,1647616,3013632,3034112,3051520,150528,3647488,737408,143744,7485184,7736768,236316,8473600,4069888,4070912,5141504,5154048,8391680,17105696,17130272,25241088,11,226080,114688,5074944,272384,4070400,7482112,384,7734848,158912
.long 1673216,3651328,79232,73728,243328,233472,15,8192,0,699008,698368,5720064,158720,0,1581056,1560576,1622016,1601536,1652736,3018752,3039232,3054592,143360,3642880,590720,573824,7545856,7751936,830236,8458240,4083584,4084096,5673984,5686528,8376320,333920,343136,8612352,40,820000,102400,5668864,272384,4083712,7542784,384,7734848,158720
.long 1678336,3651712,16777216,74752,109184,108544,15,8192,0,16777216,698880,5722624,158848,5120,1586176,1565696,1627136,1606656,1657856,3023872,3044352,3056640,145408,3644416,639872,594304,7546112,7752000,850716,8463360,4084352,4085376,5714944,5727488,8381440,339040,348256,8612608,41,840480,106496,5689344,272384,4084736,7543040,384,7734848,158784
.long 1775616,3659008,16777216,75776,16777216,235520,15,8192,0,16777216,699392,5725184,158976,10240,1591296,1570816,1632256,1611776,1642496,3008512,3028992,3049472,148480,3645952,689024,614784,7546368,7752064,871196,8468480,4085504,4086016,5755904,5768448,8386560,17106016,17130592,25445888,42,860960,110592,5709824,272384,4085760,7543296,384,7734848,158848
.long 1780736,3659392,16777216,76544,178560,178176,9,8192,0,16777216,699904,5727744,159104,15360,1596416,1575936,1637376,1616896,1647616,3013632,3034112,3051520,150528,3647488,738176,635264,7546624,7752128,891676,8473600,4086272,4087296,5796864,5809408,8391680,17106016,17130592,25445888,43,881440,114688,5730304,272384,4086784,7543552,384,7734848,158912
.long 1314816,3624448,71680,73728,218752,233472,15,8192,0,707200,706560,6375424,158720,0,1581056,1560576,1622016,1601536,1652736,3018752,3039232,3054592,143360,3642880,591488,1065344,7607296,7767296,1485596,8458240,4099968,4100480,6329344,6341888,8376320,332960,342176,7997952,72,1475360,102400,6324224,272384,4100096,7604224,384,7734848,158720
.long 1319936,3624832,16777216,74752,109696,108544,15,8192,0,16777216,707072,6377984,158848,5120,1586176,1565696,1627136,1606656,1657856,3023872,3044352,3056640,145408,3644416,640640,1085824,7607552,7767360,1506076,8463360,4100736,4101760,6370304,6382848,8381440,338080,347296,7998208,73,1495840,106496,6344704,272384,4101120,7604480,384,7734848,158784
.long 1417216,3632128,16777216,75776,16777216,235520,15,8192,0,16777216,707584,6380544,158976,10240,1591296,1570816,1632256,1611776,1642496,3008512,3028992,3049472,148480,3645952,689792,1106304,7607808,7767424,1526556,8468480,4101888,4102400,6411264,6423808,8386560,17105056,17129632,24831488,74,1516320,110592,6365184,272384,4102144,7604736,384,7734848,158848
.long 1422336,3632512,16777216,76544,190848,190464,9,8192,0,16777216,708096,6383104,159104,15360,1596416,1575936,1637376,1616896,1647616,3013632,3034112,3051520,150528,3647488,738944,1126784,7608064,7767488,1547036,8473600,4102656,4103680,6452224,6464768,8391680,17105056,17129632,24831488,75,1536800,114688,6385664,272384,4103168,7604992,384,7734848,158912
.long 1724416,3655168,79872,73728,226944,233472,15,8192,0,715392,714752,7030784,158720,0,1581056,1560576,1622016,1601536,1652736,3018752,3039232,3054592,143360,3642880,592256,1556864,7668736,7782656,2140956,8458240,4116352,4116864,6984704,6997248,8376320,333280,342496,8202752,104,2130720,102400,6979584,272384,4116480,7665664,384,7734848,158720
.long 1729536,3655552,16777216,74752,110208,108544,15,8192,0,16777216,715264,7033344,158848,5120,1586176,1565696,1627136,1606656,1657856,3023872,3044352,3056640,145408,3644416,641408,1577344,7668992,7782720,2161436,8463360,4117120,4118144,7025664,7038208,8381440,338400,347616,8203008,105,2151200,106496,7000064,272384,4117504,7665920,384,7734848,158784
.long 1826816,3662848,16777216,75776,16777216,235520,15,8192,0,16777216,715776,7035904,158976,10240,1591296,1570816,1632256,1611776,1642496,3008512,3028992,3049472,148480,3645952,690560,1597824,7669248,7782784,2181916,8468480,4118272,4118784,7066624,7079168,8386560,17105376,17129952,25036288,106,2171680,110592,7020544,272384,4118528,7666176,384,7734848,158848
.long 1831936,3663232,16777216,76544,203136,202752,9,8192,0,16777216,716288,7038464,159104,15360,1596416,1575936,1637376,1616896,1647616,3013632,3034112,3051520,150528,3647488,739712,1618304,7669504,7782848,2202396,8473600,4119040,4120064,7107584,7120128,8391680,17105376,17129952,25036288,107,2192160,114688,7041024,272384,4119552,7666432,384,7734848,158912
.long 2082816,3682048,87424,90112,239232,233472,15,0,2048,691840,690176,5146624,158720,0,2400256,2379776,2441216,2420736,2471936,3428352,3448832,3464192,143360,3704320,590336,328064,7515136,7744256,256796,8468480,4591488,4592000,5026816,5033216,8376320,333760,342976,8509952,12,246560,102400,5095424,288768,4591616,7512064,384,7734848,158976
.long 2087936,3682432,16777216,91136,125056,124928,15,0,2048,16777216,690688,5149184,158848,5120,2405376,2384896,2446336,2425856,2477056,3433472,3453952,3466240,145408,3705856,639488,348544,7515392,7744320,277276,8473600,4592256,4593280,5067776,5074176,8381440,338880,348096,8510208,13,267040,106496,5115904,288768,4592640,7512320,384,7734848,159040
.long 2185216,3689728,16777216,92160,16777216,235520,15,0,2048,16777216,691200,5151744,158976,10240,2410496,2390016,2451456,2430976,2461696,3418112,3438592,3459072,148480,3707392,688640,369024,7515648,7744384,297756,8458240,4593408,4593920,5108736,5115136,8386560,17105856,17130432,25343488,14,287520,110592,5136384,288768,4593664,7512576,384,7734848,159104
.long 2190336,3690112,16777216,92928,172416,172032,9,0,2048,16777216,691712,5154304,159104,15360,2415616,2395136,2456576,2436096,2466816,3423232,3443712,3461120,150528,3708928,737792,389504,7515904,7744448,318236,8463360,4594176,4595200,5149696,5156096,8391680,17105856,17130432,25343488,15,308000,114688,5156864,288768,4594688,7512832,384,7734848,159168
.long 2492416,3712768,95616,90112,214656,233472,15,0,2048,700032,698368,5801984,158720,0,2400256,2379776,2441216,2420736,2471936,3428352,3448832,3464192,143360,3704320,591104,819584,7576576,7759616,912156,8468480,4607872,4608384,5682176,5688576,8376320,332800,342016,7895552,44,901920,102400,5750784,288768,4608000,7573504,384,7734848,158976
.long 2497536,3713152,16777216,91136,125568,124928,15,0,2048,16777216,698880,5804544,158848,5120,2405376,2384896,2446336,2425856,2477056,3433472,3453952,3466240,145408,3705856,640256,840064,7576832,7759680,932636,8473600,4608640,4609664,5723136,5729536,8381440,337920,347136,7895808,45,922400,106496,5771264,288768,4609024,7573760,384,7734848,159040
.long 2594816,3720448,16777216,92160,16777216,235520,15,0,2048,16777216,699392,5807104,158976,10240,2410496,2390016,2451456,2430976,2461696,3418112,3438592,3459072,148480,3707392,689408,860544,7577088,7759744,953116,8458240,4609792,4610304,5764096,5770496,8386560,17104896,17129472,24729088,46,942880,110592,5791744,288768,4610048,7574016,384,7734848,159104
.long 2599936,3720832,16777216,92928,184704,184320,9,0,2048,16777216,699904,5809664,159104,15360,2415616,2395136,2456576,2436096,2466816,3423232,3443712,3461120,150528,3708928,738560,881024,7577344,7759808,973596,8463360,4610560,4611584,5805056,5811456,8391680,17104896,17129472,24729088,47,963360,114688,5812224,288768,4611072,7574272,384,7734848,159168
.long 2134016,3685888,88064,90112,222848,233472,15,0,2048,708224,706560,6457344,158720,0,2400256,2379776,2441216,2420736,2471936,3428352,3448832,3464192,143360,3704320,591872,1311104,7638016,7774976,1567516,8468480,4624256,4624768,6337536,6343936,8376320,333120,342336,8100352,76,1557280,102400,6406144,288768,4624384,7634944,384,7734848,158976
.long 2139136,3686272,16777216,91136,126080,124928,15,0,2048,16777216,707072,6459904,158848,5120,2405376,2384896,2446336,2425856,2477056,3433472,3453952,3466240,145408,3705856,641024,1331584,7638272,7775040,1587996,8473600,4625024,4626048,6378496,6384896,8381440,338240,347456,8100608,77,1577760,106496,6426624,288768,4625408,7635200,384,7734848,159040
.long 2236416,3693568,16777216,92160,16777216,235520,15,0,2048,16777216,707584,6462464,158976,10240,2410496,2390016,2451456,2430976,2461696,3418112,3438592,3459072,148480,3707392,690176,1352064,7638528,7775104,1608476,8458240,4626176,4626688,6419456,6425856,8386560,17105216,17129792,24933888,78,1598240,110592,6447104,288768,4626432,7635456,384,7734848,159104
.long 2241536,3693952,16777216,92928,196992,196608,9,0,2048,16777216,708096,6465024,159104,15360,2415616,2395136,2456576,2436096,2466816,3423232,3443712,3461120,150528,3708928,739328,1372544,7638784,7775168,1628956,8463360,4626944,4627968,6460416,6466816,8391680,17105216,17129792,24933888,79,1618720,114688,6467584,288768,4627456,7635712,384,7734848,159168
.long 2543616,3716608,96256,90112,231040,233472,15,0,2048,716416,714752,7112704,158720,0,2400256,2379776,2441216,2420736,2471936,3428352,3448832,3464192,143360,3704320,592640,1802624,7699456,7790336,2222876,8468480,4640640,4641152,6992896,6999296,8376320,333440,342656,8305152,108,2212640,102400,7061504,288768,4640768,7696384,384,7734848,158976
.long 2548736,3716992,16777216,91136,126592,124928,15,0,2048,16777216,715264,7115264,158848,5120,2405376,2384896,2446336,2425856,2477056,3433472,3453952,3466240,145408,3705856,641792,1823104,7699712,7790400,2243356,8473600,4641408,4642432,7033856,7040256,8381440,338560,347776,8305408,109,2233120,106496,7081984,288768,4641792,7696640,384,7734848,159040
.long 2646016,3724288,16777216,92160,16777216,235520,15,0,2048,16777216,715776,7117824,158976,10240,2410496,2390016,2451456,2430976,2461696,3418112,3438592,3459072,148480,3707392,690944,1843584,7699968,7790464,2263836,8458240,4642560,4643072,7074816,7081216,8386560,17105536,17130112,25138688,110,2253600,110592,7102464,288768,4642816,7696896,384,7734848,159104
.long 2651136,3724672,16777216,92928,209280,208896,9,0,2048,16777216,716288,7120384,159104,15360,2415616,2395136,2456576,2436096,2466816,3423232,3443712,3461120,150528,3708928,740096,1864064,7700224,7790528,2284316,8463360,4643328,4644352,7115776,7122176,8391680,17105536,17130112,25138688,111,2274080,114688,7122944,288768,4643840,7697152,384,7734848,159168
.long 1069056,3606016,67072,77824,239360,237568,15,8192,0,690944,690176,5074944,158720,0,1703936,1724416,1662976,1683456,1744896,3080192,3059712,3100672,143360,3650560,786560,82432,7485440,7736832,164956,8560640,4132736,4133248,5019648,5031424,8478720,359360,368576,8514560,8,164800,102400,5013504,274432,4132864,7481344,512,7735168,158720
.long 1074176,3606400,16777216,78848,110720,110592,15,8192,0,16777216,690688,5077504,158848,5120,1709056,1729536,1668096,1688576,1750016,3085312,3064832,3102720,145408,3652096,835712,102912,7485696,7736896,185436,8565760,4133504,4134528,5060608,5072384,8483840,364480,373696,8514816,9,185280,106496,5033984,274432,4133888,7481600,512,7735168,158784
.long 1171456,3613696,16777216,79872,16777216,239616,15,8192,0,16777216,691200,5080064,158976,10240,1714176,1734656,1673216,1693696,1755136,3090432,3069952,3105792,148480,3653632,884864,123392,7485952,7736960,205916,8570880,4134656,4135168,5101568,5113344,8488960,379840,404416,8566528,10,205760,110592,5054464,274432,4134912,7481856,512,7735168,158848
.long 1176576,3614080,16777216,80640,166400,165888,9,8192,0,16777216,691712,5082624,159104,15360,1719296,1739776,1678336,1698816,1760256,3095552,3075072,3107840,150528,3655168,934016,143872,7486208,7737024,226396,8576000,4135424,4136448,5142528,5154304,8494080,17157056,17181632,25343744,11,226240,114688,5074944,274432,4135936,7482112,512,7735168,158912
.long 1478656,3636736,75264,77824,214784,237568,15,8192,0,699136,698368,5730304,158720,0,1703936,1724416,1662976,1683456,1744896,3080192,3059712,3100672,143360,3650560,787328,573952,7546880,7752192,820316,8560640,4149120,4149632,5675008,5686784,8478720,358400,367616,7900160,40,820160,102400,5668864,274432,4149248,7542784,512,7735168,158720
.long 1483776,3637120,16777216,78848,111232,110592,15,8192,0,16777216,698880,5732864,158848,5120,1709056,1729536,1668096,1688576,1750016,3085312,3064832,3102720,145408,3652096,836480,594432,7547136,7752256,840796,8565760,4149888,4150912,5715968,5727744,8483840,363520,372736,7900416,41,840640,106496,5689344,274432,4150272,7543040,512,7735168,158784
.long 1581056,3644416,16777216,79872,16777216,239616,15,8192,0,16777216,699392,5735424,158976,10240,1714176,1734656,1673216,1693696,1755136,3090432,3069952,3105792,148480,3653632,885632,614912,7547392,7752320,861276,8570880,4151040,4151552,5756928,5768704,8488960,378880,403456,7952128,42,861120,110592,5709824,274432,4151296,7543296,512,7735168,158848
.long 1586176,3644800,16777216,80640,178688,178176,9,8192,0,16777216,699904,5737984,159104,15360,1719296,1739776,1678336,1698816,1760256,3095552,3075072,3107840,150528,3655168,934784,635392,7547648,7752384,881756,8576000,4151808,4152832,5797888,5809664,8494080,17156096,17180672,24729344,43,881600,114688,5730304,274432,4152320,7543552,512,7735168,158912
.long 1120256,3609856,67712,77824,222976,237568,15,8192,0,707328,706560,6385664,158720,0,1703936,1724416,1662976,1683456,1744896,3080192,3059712,3100672,143360,3650560,788096,1065472,7608320,7767552,1475676,8560640,4165504,4166016,6330368,6342144,8478720,358720,367936,8104960,72,1475520,102400,6324224,274432,4165632,7604224,512,7735168,158720
.long 1125376,3610240,16777216,78848,111744,110592,15,8192,0,16777216,707072,6388224,158848,5120,1709056,1729536,1668096,1688576,1750016,3085312,3064832,3102720,145408,3652096,837248,1085952,7608576,7767616,1496156,8565760,4166272,4167296,6371328,6383104,8483840,363840,373056,8105216,73,1496000,106496,6344704,274432,4166656,7604480,512,7735168,158784
.long 1222656,3617536,16777216,79872,16777216,239616,15,8192,0,16777216,707584,6390784,158976,10240,1714176,1734656,1673216,1693696,1755136,3090432,3069952,3105792,148480,3653632,886400,1106432,7608832,7767680,1516636,8570880,4167424,4167936,6412288,6424064,8488960,379200,403776,8156928,74,1516480,110592,6365184,274432,4167680,7604736,512,7735168,158848
.long 1227776,3617920,16777216,80640,190976,190464,9,8192,0,16777216,708096,6393344,159104,15360,1719296,1739776,1678336,1698816,1760256,3095552,3075072,3107840,150528,3655168,935552,1126912,7609088,7767744,1537116,8576000,4168192,4169216,6453248,6465024,8494080,17156416,17180992,24934144,75,1536960,114688,6385664,274432,4168704,7604992,512,7735168,158912
.long 1529856,3640576,75904,77824,231168,237568,15,8192,0,715520,714752,7041024,158720,0,1703936,1724416,1662976,1683456,1744896,3080192,3059712,3100672,143360,3650560,788864,1556992,7669760,7782912,2131036,8560640,4181888,4182400,6985728,6997504,8478720,359040,368256,8309760,104,2130880,102400,6979584,274432,4182016,7665664,512,7735168,158720
.long 1534976,3640960,16777216,78848,112256,110592,15,8192,0,16777216,715264,7043584,158848,5120,1709056,1729536,1668096,1688576,1750016,3085312,3064832,3102720,145408,3652096,838016,1577472,7670016,7782976,2151516,8565760,4182656,4183680,7026688,7038464,8483840,364160,373376,8310016,105,2151360,106496,7000064,274432,4183040,7665920,512,7735168,158784
.long 1632256,3648256,16777216,79872,16777216,239616,15,8192,0,16777216,715776,7046144,158976,10240,1714176,1734656,1673216,1693696,1755136,3090432,3069952,3105792,148480,3653632,887168,1597952,7670272,7783040,2171996,8570880,4183808,4184320,7067648,7079424,8488960,379520,404096,8361728,106,2171840,110592,7020544,274432,4184064,7666176,512,7735168,158848
.long 1637376,3648640,16777216,80640,203264,202752,9,8192,0,16777216,716288,7048704,159104,15360,1719296,1739776,1678336,1698816,1760256,3095552,3075072,3107840,150528,3655168,936320,1618432,7670528,7783104,2192476,8576000,4184576,4185600,7108608,7120384,8494080,17156736,17181312,25138944,107,2192320,114688,7041024,274432,4185088,7666432,512,7735168,158912
.long 1888256,3667456,83456,94208,243456,237568,15,0,2048,691968,690176,5156864,158720,0,2523136,2543616,2482176,2502656,2564096,3489792,3469312,3510272,143360,3712000,786944,328192,7516160,7744512,246876,8570880,4657024,4657536,5027840,5033472,8478720,359520,368736,8616960,12,246720,102400,5095424,290816,4657152,7512064,512,7735168,158976
.long 1893376,3667840,16777216,95232,127104,126976,15,0,2048,16777216,690688,5159424,158848,5120,2528256,2548736,2487296,2507776,2569216,3494912,3474432,3512320,145408,3713536,836096,348672,7516416,7744576,267356,8576000,4657792,4658816,5068800,5074432,8483840,364640,373856,8617216,13,267200,106496,5115904,290816,4658176,7512320,512,7735168,159040
.long 1990656,3675136,16777216,96256,16777216,239616,15,0,2048,16777216,691200,5161984,158976,10240,2533376,2553856,2492416,2512896,2574336,3500032,3479552,3515392,148480,3715072,885248,369152,7516672,7744640,287836,8560640,4658944,4659456,5109760,5115392,8488960,380000,404576,8668928,14,287680,110592,5136384,290816,4659200,7512576,512,7735168,159104
.long 1995776,3675520,16777216,97024,172544,172032,9,0,2048,16777216,691712,5164544,159104,15360,2538496,2558976,2497536,2518016,2579456,3505152,3484672,3517440,150528,3716608,934400,389632,7516928,7744704,308316,8565760,4659712,4660736,5150720,5156352,8494080,17157216,17181792,25446144,15,308160,114688,5156864,290816,4660224,7512832,512,7735168,159168
.long 2297856,3698176,91648,94208,218880,237568,15,0,2048,700160,698368,5812224,158720,0,2523136,2543616,2482176,2502656,2564096,3489792,3469312,3510272,143360,3712000,787712,819712,7577600,7759872,902236,8570880,4673408,4673920,5683200,5688832,8478720,358560,367776,8002560,44,902080,102400,5750784,290816,4673536,7573504,512,7735168,158976
.long 2302976,3698560,16777216,95232,127616,126976,15,0,2048,16777216,698880,5814784,158848,5120,2528256,2548736,2487296,2507776,2569216,3494912,3474432,3512320,145408,3713536,836864,840192,7577856,7759936,922716,8576000,4674176,4675200,5724160,5729792,8483840,363680,372896,8002816,45,922560,106496,5771264,290816,4674560,7573760,512,7735168,159040
.long 2400256,3705856,16777216,96256,16777216,239616,15,0,2048,16777216,699392,5817344,158976,10240,2533376,2553856,2492416,2512896,2574336,3500032,3479552,3515392,148480,3715072,886016,860672,7578112,7760000,943196,8560640,4675328,4675840,5765120,5770752,8488960,379040,403616,8054528,46,943040,110592,5791744,290816,4675584,7574016,512,7735168,159104
.long 2405376,3706240,16777216,97024,184832,184320,9,0,2048,16777216,699904,5819904,159104,15360,2538496,2558976,2497536,2518016,2579456,3505152,3484672,3517440,150528,3716608,935168,881152,7578368,7760064,963676,8565760,4676096,4677120,5806080,5811712,8494080,17156256,17180832,24831744,47,963520,114688,5812224,290816,4676608,7574272,512,7735168,159168
.long 1939456,3671296,84096,94208,227072,237568,15,0,2048,708352,706560,6467584,158720,0,2523136,2543616,2482176,2502656,2564096,3489792,3469312,3510272,143360,3712000,788480,1311232,7639040,7775232,1557596,8570880,4689792,4690304,6338560,6344192,8478720,358880,368096,8207360,76,1557440,102400,6406144,290816,4689920,7634944,512,7735168,158976
.long 1944576,3671680,16777216,95232,128128,126976,15,0,2048,16777216,707072,6470144,158848,5120,2528256,2548736,2487296,2507776,2569216,3494912,3474432,3512320,145408,3713536,837632,1331712,7639296,7775296,1578076,8576000,4690560,4691584,6379520,6385152,8483840,364000,373216,8207616,77,1577920,106496,6426624,290816,4690944,7635200,512,7735168,159040
.long 2041856,3678976,16777216,96256,16777216,239616,15,0,2048,16777216,707584,6472704,158976,10240,2533376,2553856,2492416,2512896,2574336,3500032,3479552,3515392,148480,3715072,886784,1352192,7639552,7775360,1598556,8560640,4691712,4692224,6420480,6426112,8488960,379360,403936,8259328,78,1598400,110592,6447104,290816,4691968,7635456,512,7735168,159104
.long 2046976,3679360,16777216,97024,197120,196608,9,0,2048,16777216,708096,6475264,159104,15360,2538496,2558976,2497536,2518016,2579456,3505152,3484672,3517440,150528,3716608,935936,1372672,7639808,7775424,1619036,8565760,4692480,4693504,6461440,6467072,8494080,17156576,17181152,25036544,79,1618880,114688,6467584,290816,4692992,7635712,512,7735168,159168
.long 2349056,3702016,92288,94208,235264,237568,15,0,2048,716544,714752,7122944,158720,0,2523136,2543616,2482176,2502656,2564096,3489792,3469312,3510272,143360,3712000,789248,1802752,7700480,7790592,2212956,8570880,4706176,4706688,6993920,6999552,8478720,359200,368416,8412160,108,2212800,102400,7061504,290816,4706304,7696384,512,7735168,158976
.long 2354176,3702400,16777216,95232,128640,126976,15,0,2048,16777216,715264,7125504,158848,5120,2528256,2548736,2487296,2507776,2569216,3494912,3474432,3512320,145408,3713536,838400,1823232,7700736,7790656,2233436,8576000,4706944,4707968,7034880,7040512,8483840,364320,373536,8412416,109,2233280,106496,7081984,290816,4707328,7696640,512,7735168,159040
.long 2451456,3709696,16777216,96256,16777216,239616,15,0,2048,16777216,715776,7128064,158976,10240,2533376,2553856,2492416,2512896,2574336,3500032,3479552,3515392,148480,3715072,887552,1843712,7700992,7790720,2253916,8560640,4708096,4708608,7075840,7081472,8488960,379680,404256,8464128,110,2253760,110592,7102464,290816,4708352,7696896,512,7735168,159104
.long 2456576,3710080,16777216,97024,209408,208896,9,0,2048,16777216,716288,7130624,159104,15360,2538496,2558976,2497536,2518016,2579456,3505152,3484672,3517440,150528,3716608,936704,1864192,7701248,7790784,2274396,8565760,4708864,4709888,7116800,7122432,8494080,17156896,17181472,25241344,111,2274240,114688,7122944,290816,4709376,7697152,512,7735168,159168
.long 1273856,3621376,71168,77824,243584,241664,15,8192,0,691072,690176,5085184,158720,0,1826816,1806336,1785856,1765376,1857536,3141632,3121152,3156992,143360,3658240,983168,82560,7486464,7737088,175196,8663040,4198272,4198784,5020672,5031680,8581120,385120,394336,8617472,8,164960,102400,5013504,276480,4198400,7481344,640,7735488,158720
.long 1278976,3621760,16777216,78848,112768,112640,15,8192,0,16777216,690688,5087744,158848,5120,1831936,1811456,1790976,1770496,1862656,3146752,3126272,3159040,145408,3659776,1032320,103040,7486720,7737152,195676,8668160,4199040,4200064,5061632,5072640,8586240,390240,399456,8617728,9,185440,106496,5033984,276480,4199424,7481600,640,7735488,158784
.long 1376256,3629056,16777216,79872,16777216,243712,15,8192,0,16777216,691200,5090304,158976,10240,1837056,1816576,1796096,1775616,1847296,3131392,3110912,3151872,148480,3661312,1081472,123520,7486976,7737216,216156,8673280,4200192,4200704,5102592,5113600,8591360,17157216,17181792,25446144,10,205920,110592,5054464,276480,4200448,7481856,640,7735488,158848
.long 1381376,3629440,16777216,80640,166528,165888,9,8192,0,16777216,691712,5092864,159104,15360,1842176,1821696,1801216,1780736,1852416,3136512,3116032,3153920,150528,3662848,1130624,144000,7487232,7737280,236636,8678400,4200960,4201984,5143552,5154560,8596480,17157216,17181792,25446144,11,226400,114688,5074944,276480,4201472,7482112,640,7735488,158912
.long 1683456,3652096,79360,77824,219008,241664,15,8192,0,699264,698368,5740544,158720,0,1826816,1806336,1785856,1765376,1857536,3141632,3121152,3156992,143360,3658240,983936,574080,7547904,7752448,830556,8663040,4214656,4215168,5676032,5687040,8581120,384160,393376,8003072,40,820320,102400,5668864,276480,4214784,7542784,640,7735488,158720
.long 1688576,3652480,16777216,78848,113280,112640,15,8192,0,16777216,698880,5743104,158848,5120,1831936,1811456,1790976,1770496,1862656,3146752,3126272,3159040,145408,3659776,1033088,594560,7548160,7752512,851036,8668160,4215424,4216448,5716992,5728000,8586240,389280,398496,8003328,41,840800,106496,5689344,276480,4215808,7543040,640,7735488,158784
.long 1785856,3659776,16777216,79872,16777216,243712,15,8192,0,16777216,699392,5745664,158976,10240,1837056,1816576,1796096,1775616,1847296,3131392,3110912,3151872,148480,3661312,1082240,615040,7548416,7752576,871516,8673280,4216576,4217088,5757952,5768960,8591360,17156256,17180832,24831744,42,861280,110592,5709824,276480,4216832,7543296,640,7735488,158848
.long 1790976,3660160,16777216,80640,178816,178176,9,8192,0,16777216,699904,5748224,159104,15360,1842176,1821696,1801216,1780736,1852416,3136512,3116032,3153920,150528,3662848,1131392,635520,7548672,7752640,891996,8678400,4217344,4218368,5798912,5809920,8596480,17156256,17180832,24831744,43,881760,114688,5730304,276480,4217856,7543552,640,7735488,158912
.long 1325056,3625216,71808,77824,227200,241664,15,8192,0,707456,706560,6395904,158720,0,1826816,1806336,1785856,1765376,1857536,3141632,3121152,3156992,143360,3658240,984704,1065600,7609344,7767808,1485916,8663040,4231040,4231552,6331392,6342400,8581120,384480,393696,8207872,72,1475680,102400,6324224,276480,4231168,7604224,640,7735488,158720
.long 1330176,3625600,16777216,78848,113792,112640,15,8192,0,16777216,707072,6398464,158848,5120,1831936,1811456,1790976,1770496,1862656,3146752,3126272,3159040,145408,3659776,1033856,1086080,7609600,7767872,1506396,8668160,4231808,4232832,6372352,6383360,8586240,389600,398816,8208128,73,1496160,106496,6344704,276480,4232192,7604480,640,7735488,158784
.long 1427456,3632896,16777216,79872,16777216,243712,15,8192,0,16777216,707584,6401024,158976,10240,1837056,1816576,1796096,1775616,1847296,3131392,3110912,3151872,148480,3661312,1083008,1106560,7609856,7767936,1526876,8673280,4232960,4233472,6413312,6424320,8591360,17156576,17181152,25036544,74,1516640,110592,6365184,276480,4233216,7604736,640,7735488,158848
.long 1432576,3633280,16777216,80640,191104,190464,9,8192,0,16777216,708096,6403584,159104,15360,1842176,1821696,1801216,1780736,1852416,3136512,3116032,3153920,150528,3662848,1132160,1127040,7610112,7768000,1547356,8678400,4233728,4234752,6454272,6465280,8596480,17156576,17181152,25036544,75,1537120,114688,6385664,276480,4234240,7604992,640,7735488,158912
.long 1734656,3655936,80000,77824,235392,241664,15,8192,0,715648,714752,7051264,158720,0,1826816,1806336,1785856,1765376,1857536,3141632,3121152,3156992,143360,3658240,985472,1557120,7670784,7783168,2141276,8663040,4247424,4247936,6986752,6997760,8581120,384800,394016,8412672,104,2131040,102400,6979584,276480,4247552,7665664,640,7735488,158720
.long 1739776,3656320,16777216,78848,114304,112640,15,8192,0,16777216,715264,7053824,158848,5120,1831936,1811456,1790976,1770496,1862656,3146752,3126272,3159040,145408,3659776,1034624,1577600,7671040,7783232,2161756,8668160,4248192,4249216,7027712,7038720,8586240,389920,399136,8412928,105,2151520,106496,7000064,276480,4248576,7665920,640,7735488,158784
.long 1837056,3663616,16777216,79872,16777216,243712,15,8192,0,16777216,715776,7056384,158976,10240,1837056,1816576,1796096,1775616,1847296,3131392,3110912,3151872,148480,3661312,1083776,1598080,7671296,7783296,2182236,8673280,4249344,4249856,7068672,7079680,8591360,17156896,17181472,25241344,106,2172000,110592,7020544,276480,4249600,7666176,640,7735488,158848
.long 1842176,3664000,16777216,80640,203392,202752,9,8192,0,16777216,716288,7058944,159104,15360,1842176,1821696,1801216,1780736,1852416,3136512,3116032,3153920,150528,3662848,1132928,1618560,7671552,7783360,2202716,8678400,4250112,4251136,7109632,7120640,8596480,17156896,17181472,25241344,107,2192480,114688,7041024,276480,4250624,7666432,640,7735488,158912
.long 2093056,3682816,87552,94208,214912,241664,15,0,2048,692096,690176,5167104,158720,0,2646016,2625536,2605056,2584576,2676736,3551232,3530752,3566592,143360,3719680,983552,328320,7517184,7744768,257116,8673280,4722560,4723072,5028864,5033728,8581120,384000,393216,7900672,12,246880,102400,5095424,292864,4722688,7512064,640,7735488,158976
.long 2098176,3683200,16777216,95232,129152,129024,15,0,2048,16777216,690688,5169664,158848,5120,2651136,2630656,2610176,2589696,2681856,3556352,3535872,3568640,145408,3721216,1032704,348800,7517440,7744832,277596,8678400,4723328,4724352,5069824,5074688,8586240,389120,398336,7900928,13,267360,106496,5115904,292864,4723712,7512320,640,7735488,159040
.long 2195456,3690496,16777216,96256,16777216,243712,15,0,2048,16777216,691200,5172224,158976,10240,2656256,2635776,2615296,2594816,2666496,3540992,3520512,3561472,148480,3722752,1081856,369280,7517696,7744896,298076,8663040,4724480,4724992,5110784,5115648,8591360,17156096,17180672,24729344,14,287840,110592,5136384,292864,4724736,7512576,640,7735488,159104
.long 2200576,3690880,16777216,97024,172672,172032,9,0,2048,16777216,691712,5174784,159104,15360,2661376,2640896,2620416,2599936,2671616,3546112,3525632,3563520,150528,3724288,1131008,389760,7517952,7744960,318556,8668160,4725248,4726272,5151744,5156608,8596480,17156096,17180672,24729344,15,308320,114688,5156864,292864,4725760,7512832,640,7735488,159168
.long 2502656,3713536,95744,94208,223104,241664,15,0,2048,700288,698368,5822464,158720,0,2646016,2625536,2605056,2584576,2676736,3551232,3530752,3566592,143360,3719680,984320,819840,7578624,7760128,912476,8673280,4738944,4739456,5684224,5689088,8581120,384320,393536,8105472,44,902240,102400,5750784,292864,4739072,7573504,640,7735488,158976
.long 2507776,3713920,16777216,95232,129664,129024,15,0,2048,16777216,698880,5825024,158848,5120,2651136,2630656,2610176,2589696,2681856,3556352,3535872,3568640,145408,3721216,1033472,840320,7578880,7760192,932956,8678400,4739712,4740736,5725184,5730048,8586240,389440,398656,8105728,45,922720,106496,5771264,292864,4740096,7573760,640,7735488,159040
.long 2605056,3721216,16777216,96256,16777216,243712,15,0,2048,16777216,699392,5827584,158976,10240,2656256,2635776,2615296,2594816,2666496,3540992,3520512,3561472,148480,3722752,1082624,860800,7579136,7760256,953436,8663040,4740864,4741376,5766144,5771008,8591360,17156416,17180992,24934144,46,943200,110592,5791744,292864,4741120,7574016,640,7735488,159104
.long 2610176,3721600,16777216,97024,184960,184320,9,0,2048,16777216,699904,5830144,159104,15360,2661376,2640896,2620416,2599936,2671616,3546112,3525632,3563520,150528,3724288,1131776,881280,7579392,7760320,973916,8668160,4741632,4742656,5807104,5811968,8596480,17156416,17180992,24934144,47,963680,114688,5812224,292864,4742144,7574272,640,7735488,159168
.long 2144256,3686656,88192,94208,231296,241664,15,0,2048,708480,706560,6477824,158720,0,2646016,2625536,2605056,2584576,2676736,3551232,3530752,3566592,143360,3719680,985088,1311360,7640064,7775488,1567836,8673280,4755328,4755840,6339584,6344448,8581120,384640,393856,8310272,76,1557600,102400,6406144,292864,4755456,7634944,640,7735488,158976
.long 2149376,3687040,16777216,95232,130176,129024,15,0,2048,16777216,707072,6480384,158848,5120,2651136,2630656,2610176,2589696,2681856,3556352,3535872,3568640,145408,3721216,1034240,1331840,7640320,7775552,1588316,8678400,4756096,4757120,6380544,6385408,8586240,389760,398976,8310528,77,1578080,106496,6426624,292864,4756480,7635200,640,7735488,159040
.long 2246656,3694336,16777216,96256,16777216,243712,15,0,2048,16777216,707584,6482944,158976,10240,2656256,2635776,2615296,2594816,2666496,3540992,3520512,3561472,148480,3722752,1083392,1352320,7640576,7775616,1608796,8663040,4757248,4757760,6421504,6426368,8591360,17156736,17181312,25138944,78,1598560,110592,6447104,292864,4757504,7635456,640,7735488,159104
.long 2251776,3694720,16777216,97024,197248,196608,9,0,2048,16777216,708096,6485504,159104,15360,2661376,2640896,2620416,2599936,2671616,3546112,3525632,3563520,150528,3724288,1132544,1372800,7640832,7775680,1629276,8668160,4758016,4759040,6462464,6467328,8596480,17156736,17181312,25138944,79,1619040,114688,6467584,292864,4758528,7635712,640,7735488,159168
.long 2553856,3717376,96384,94208,239488,241664,15,0,2048,716672,714752,7133184,158720,0,2646016,2625536,2605056,2584576,2676736,3551232,3530752,3566592,143360,3719680,985856,1802880,7701504,7790848,2223196,8673280,4771712,4772224,6994944,6999808,8581120,384960,394176,8515072,108,2212960,102400,7061504,292864,4771840,7696384,640,7735488,158976
.long 2558976,3717760,16777216,95232,130688,129024,15,0,2048,16777216,715264,7135744,158848,5120,2651136,2630656,2610176,2589696,2681856,3556352,3535872,3568640,145408,3721216,1035008,1823360,7701760,7790912,2243676,8678400,4772480,4773504,7035904,7040768,8586240,390080,399296,8515328,109,2233440,106496,7081984,292864,4772864,7696640,640,7735488,159040
.long 2656256,3725056,16777216,96256,16777216,243712,15,0,2048,16777216,715776,7138304,158976,10240,2656256,2635776,2615296,2594816,2666496,3540992,3520512,3561472,148480,3722752,1084160,1843840,7702016,7790976,2264156,8663040,4773632,4774144,7076864,7081728,8591360,17157056,17181632,25343744,110,2253920,110592,7102464,292864,4773888,7696896,640,7735488,159104
.long 2661376,3725440,16777216,97024,209536,208896,9,0,2048,16777216,716288,7140864,159104,15360,2661376,2640896,2620416,2599936,2671616,3546112,3525632,3563520,150528,3724288,1133312,1864320,7702272,7791040,2284636,8668160,4774400,4775424,7117824,7122688,8596480,17157056,17181632,25343744,111,2274400,114688,7122944,292864,4774912,7697152,640,7735488,159168
.long 1079296,3606784,67200,65536,215040,212992,15,8192,0,692224,692224,5177344,158720,0,1048576,1069056,1089536,1110016,1130496,2752512,2772992,2793472,143360,3604480,1179776,82688,7487488,7737344,327836,7946240,3743616,3744128,5177344,5193728,7864320,409600,418816,7905280,16,327680,102400,5177344,262144,3743744,7481344,768,7733248,158720
.long 1084416,3607168,16777216,66560,98560,98304,15,8192,0,16777216,692736,5179904,158848,5120,1053696,1074176,1094656,1115136,1135616,2757632,2778112,2795520,145408,3606016,1228928,103168,7487744,7737408,348316,7951360,3744384,3745408,5218304,5234688,7869440,414720,423936,7905536,17,348160,106496,5197824,262144,3744768,7481600,768,7733248,158784
.long 1181696,3614464,16777216,67584,16777216,215040,15,8192,0,16777216,693248,5182464,158976,10240,1058816,1079296,1099776,1120256,1140736,2762752,2783232,2798592,148480,3607552,1278080,123648,7488000,7737472,368796,7956480,3745536,3746048,5259264,5275648,7874560,430080,454656,7956480,18,368640,110592,5218304,262144,3745792,7481856,768,7733248,158848
.long 1186816,3614848,16777216,68352,166656,165888,9,8192,0,16777216,693760,5185024,159104,15360,1063936,1084416,1104896,1125376,1145856,2767872,2788352,2800640,150528,3609088,1327232,144128,7488256,7737536,389276,7961600,3746304,3747328,5300224,5316608,7879680,17207296,17231872,24733696,19,389120,114688,5238784,262144,3746816,7482112,768,7733248,158912
.long 1488896,3637504,75392,65536,223232,212992,15,8192,0,700416,700416,5832704,158720,0,1048576,1069056,1089536,1110016,1130496,2752512,2772992,2793472,143360,3604480,1180544,574208,7548928,7752704,983196,7946240,3760000,3760512,5832704,5849088,7864320,409920,419136,8110080,48,983040,102400,5832704,262144,3760128,7542784,768,7733248,158720
.long 1494016,3637888,16777216,66560,99072,98304,15,8192,0,16777216,700928,5835264,158848,5120,1053696,1074176,1094656,1115136,1135616,2757632,2778112,2795520,145408,3606016,1229696,594688,7549184,7752768,1003676,7951360,3760768,3761792,5873664,5890048,7869440,415040,424256,8110336,49,1003520,106496,5853184,262144,3761152,7543040,768,7733248,158784
.long 1591296,3645184,16777216,67584,16777216,215040,15,8192,0,16777216,701440,5837824,158976,10240,1058816,1079296,1099776,1120256,1140736,2762752,2783232,2798592,148480,3607552,1278848,615168,7549440,7752832,1024156,7956480,3761920,3762432,5914624,5931008,7874560,430400,454976,8161280,50,1024000,110592,5873664,262144,3762176,7543296,768,7733248,158848
.long 1596416,3645568,16777216,68352,178944,178176,9,8192,0,16777216,701952,5840384,159104,15360,1063936,1084416,1104896,1125376,1145856,2767872,2788352,2800640,150528,3609088,1328000,635648,7549696,7752896,1044636,7961600,3762688,3763712,5955584,5971968,7879680,17207616,17232192,24938496,51,1044480,114688,5894144,262144,3763200,7543552,768,7733248,158912
.long 1130496,3610624,67840,65536,231424,212992,15,8192,0,708608,708608,6488064,158720,0,1048576,1069056,1089536,1110016,1130496,2752512,2772992,2793472,143360,3604480,1181312,1065728,7610368,7768064,1638556,7946240,3776384,3776896,6488064,6504448,7864320,410240,419456,8314880,80,1638400,102400,6488064,262144,3776512,7604224,768,7733248,158720
.long 1135616,3611008,16777216,66560,99584,98304,15,8192,0,16777216,709120,6490624,158848,5120,1053696,1074176,1094656,1115136,1135616,2757632,2778112,2795520,145408,3606016,1230464,1086208,7610624,7768128,1659036,7951360,3777152,3778176,6529024,6545408,7869440,415360,424576,8315136,81,1658880,106496,6508544,262144,3777536,7604480,768,7733248,158784
.long 1232896,3618304,16777216,67584,16777216,215040,15,8192,0,16777216,709632,6493184,158976,10240,1058816,1079296,1099776,1120256,1140736,2762752,2783232,2798592,148480,3607552,1279616,1106688,7610880,7768192,1679516,7956480,3778304,3778816,6569984,6586368,7874560,430720,455296,8366080,82,1679360,110592,6529024,262144,3778560,7604736,768,7733248,158848
.long 1238016,3618688,16777216,68352,191232,190464,9,8192,0,16777216,710144,6495744,159104,15360,1063936,1084416,1104896,1125376,1145856,2767872,2788352,2800640,150528,3609088,1328768,1127168,7611136,7768256,1699996,7961600,3779072,3780096,6610944,6627328,7879680,17207936,17232512,25143296,83,1699840,114688,6549504,262144,3779584,7604992,768,7733248,158912
.long 1540096,3641344,76032,65536,239616,212992,15,8192,0,716800,716800,7143424,158720,0,1048576,1069056,1089536,1110016,1130496,2752512,2772992,2793472,143360,3604480,1182080,1557248,7671808,7783424,2293916,7946240,3792768,3793280,7143424,7159808,7864320,410560,419776,8519680,112,2293760,102400,7143424,262144,3792896,7665664,768,7733248,158720
.long 1545216,3641728,16777216,66560,100096,98304,15,8192,0,16777216,717312,7145984,158848,5120,1053696,1074176,1094656,1115136,1135616,2757632,2778112,2795520,145408,3606016,1231232,1577728,7672064,7783488,2314396,7951360,3793536,3794560,7184384,7200768,7869440,415680,424896,8519936,113,2314240,106496,7163904,262144,3793920,7665920,768,7733248,158784
.long 1642496,3649024,16777216,67584,16777216,215040,15,8192,0,16777216,717824,7148544,158976,10240,1058816,1079296,1099776,1120256,1140736,2762752,2783232,2798592,148480,3607552,1280384,1598208,7672320,7783552,2334876,7956480,3794688,3795200,7225344,7241728,7874560,431040,455616,8570880,114,2334720,110592,7184384,262144,3794944,7666176,768,7733248,158848
.long 1647616,3649408,16777216,68352,203520,202752,9,8192,0,16777216,718336,7151104,159104,15360,1063936,1084416,1104896,1125376,1145856,2767872,2788352,2800640,150528,3609088,1329536,1618688,7672576,7783616,2355356,7961600,3795456,3796480,7266304,7282688,7879680,17208256,17232832,25348096,115,2355200,114688,7204864,262144,3795968,7666432,768,7733248,158912
.long 1898496,3668224,83584,81920,219136,212992,15,0,2048,693248,692224,5259264,158720,0,1867776,1888256,1908736,1929216,1949696,3162112,3182592,3203072,143360,3665920,1180160,328448,7518208,7745024,409756,7956480,4267904,4268416,5185536,5195776,7864320,409760,418976,8007680,20,409600,102400,5259264,278528,4268032,7512064,768,7733248,158976
.long 1903616,3668608,16777216,82944,114944,114688,15,0,2048,16777216,692736,5261824,158848,5120,1872896,1893376,1913856,1934336,1954816,3167232,3187712,3205120,145408,3667456,1229312,348928,7518464,7745088,430236,7961600,4268672,4269696,5226496,5236736,7869440,414880,424096,8007936,21,430080,106496,5279744,278528,4269056,7512320,768,7733248,159040
.long 2000896,3675904,16777216,83968,16777216,215040,15,0,2048,16777216,693248,5264384,158976,10240,1878016,1898496,1918976,1939456,1959936,3172352,3192832,3208192,148480,3668992,1278464,369408,7518720,7745152,450716,7946240,4269824,4270336,5267456,5277696,7874560,430240,454816,8058880,22,450560,110592,5300224,278528,4270080,7512576,768,7733248,159104
.long 2006016,3676288,16777216,84736,172800,172032,9,0,2048,16777216,693760,5266944,159104,15360,1883136,1903616,1924096,1944576,1965056,3177472,3197952,3210240,150528,3670528,1327616,389888,7518976,7745216,471196,7951360,4270592,4271616,5308416,5318656,7879680,17207456,17232032,24836096,23,471040,114688,5320704,278528,4271104,7512832,768,7733248,159168
.long 2308096,3698944,91776,81920,227328,212992,15,0,2048,701440,700416,5914624,158720,0,1867776,1888256,1908736,1929216,1949696,3162112,3182592,3203072,143360,3665920,1180928,819968,7579648,7760384,1065116,7956480,4284288,4284800,5840896,5851136,7864320,410080,419296,8212480,52,1064960,102400,5914624,278528,4284416,7573504,768,7733248,158976
.long 2313216,3699328,16777216,82944,115456,114688,15,0,2048,16777216,700928,5917184,158848,5120,1872896,1893376,1913856,1934336,1954816,3167232,3187712,3205120,145408,3667456,1230080,840448,7579904,7760448,1085596,7961600,4285056,4286080,5881856,5892096,7869440,415200,424416,8212736,53,1085440,106496,5935104,278528,4285440,7573760,768,7733248,159040
.long 2410496,3706624,16777216,83968,16777216,215040,15,0,2048,16777216,701440,5919744,158976,10240,1878016,1898496,1918976,1939456,1959936,3172352,3192832,3208192,148480,3668992,1279232,860928,7580160,7760512,1106076,7946240,4286208,4286720,5922816,5933056,7874560,430560,455136,8263680,54,1105920,110592,5955584,278528,4286464,7574016,768,7733248,159104
.long 2415616,3707008,16777216,84736,185088,184320,9,0,2048,16777216,701952,5922304,159104,15360,1883136,1903616,1924096,1944576,1965056,3177472,3197952,3210240,150528,3670528,1328384,881408,7580416,7760576,1126556,7951360,4286976,4288000,5963776,5974016,7879680,17207776,17232352,25040896,55,1126400,114688,5976064,278528,4287488,7574272,768,7733248,159168
.long 1949696,3672064,84224,81920,235520,212992,15,0,2048,709632,708608,6569984,158720,0,1867776,1888256,1908736,1929216,1949696,3162112,3182592,3203072,143360,3665920,1181696,1311488,7641088,7775744,1720476,7956480,4300672,4301184,6496256,6506496,7864320,410400,419616,8417280,84,1720320,102400,6569984,278528,4300800,7634944,768,7733248,158976
.long 1954816,3672448,16777216,82944,115968,114688,15,0,2048,16777216,709120,6572544,158848,5120,1872896,1893376,1913856,1934336,1954816,3167232,3187712,3205120,145408,3667456,1230848,1331968,7641344,7775808,1740956,7961600,4301440,4302464,6537216,6547456,7869440,415520,424736,8417536,85,1740800,106496,6590464,278528,4301824,7635200,768,7733248,159040
.long 2052096,3679744,16777216,83968,16777216,215040,15,0,2048,16777216,709632,6575104,158976,10240,1878016,1898496,1918976,1939456,1959936,3172352,3192832,3208192,148480,3668992,1280000,1352448,7641600,7775872,1761436,7946240,4302592,4303104,6578176,6588416,7874560,430880,455456,8468480,86,1761280,110592,6610944,278528,4302848,7635456,768,7733248,159104
.long 2057216,3680128,16777216,84736,197376,196608,9,0,2048,16777216,710144,6577664,159104,15360,1883136,1903616,1924096,1944576,1965056,3177472,3197952,3210240,150528,3670528,1329152,1372928,7641856,7775936,1781916,7951360,4303360,4304384,6619136,6629376,7879680,17208096,17232672,25245696,87,1781760,114688,6631424,278528,4303872,7635712,768,7733248,159168
.long 2359296,3702784,92416,81920,243712,212992,15,0,2048,717824,716800,7225344,158720,0,1867776,1888256,1908736,1929216,1949696,3162112,3182592,3203072,143360,3665920,1182464,1803008,7702528,7791104,2375836,7956480,4317056,4317568,7151616,7161856,7864320,410720,419936,8622080,116,2375680,102400,7225344,278528,4317184,7696384,768,7733248,158976
.long 2364416,3703168,16777216,82944,116480,114688,15,0,2048,16777216,717312,7227904,158848,5120,1872896,1893376,1913856,1934336,1954816,3167232,3187712,3205120,145408,3667456,1231616,1823488,7702784,7791168,2396316,7961600,4317824,4318848,7192576,7202816,7869440,415840,425056,8622336,117,2396160,106496,7245824,278528,4318208,7696640,768,7733248,159040
.long 2461696,3710464,16777216,83968,16777216,215040,15,0,2048,16777216,717824,7230464,158976,10240,1878016,1898496,1918976,1939456,1959936,3172352,3192832,3208192,148480,3668992,1280768,1843968,7703040,7791232,2416796,7946240,4318976,4319488,7233536,7243776,7874560,431200,455776,8673280,118,2416640,110592,7266304,278528,4319232,7696896,768,7733248,159104
.long 2466816,3710848,16777216,84736,209664,208896,9,0,2048,16777216,718336,7233024,159104,15360,1883136,1903616,1924096,1944576,1965056,3177472,3197952,3210240,150528,3670528,1329920,1864448,7703296,7791296,2437276,7951360,4319744,4320768,7274496,7284736,7879680,17208416,17232992,25450496,119,2437120,114688,7286784,278528,4320256,7697152,768,7733248,159168
.long 1284096,3622144,71296,65536,219264,217088,15,8192,0,692352,692224,5187584,158720,0,1171456,1150976,1212416,1191936,1243136,2813952,2834432,2849792,143360,3612160,1376384,82816,7488512,7737600,338076,8048640,3809152,3809664,5178368,5193984,7966720,435360,444576,8008192,16,327840,102400,5177344,264192,3809280,7481344,896,7733568,158720
.long 1289216,3622528,16777216,66560,100608,100352,15,8192,0,16777216,692736,5190144,158848,5120,1176576,1156096,1217536,1197056,1248256,2819072,2839552,2851840,145408,3613696,1425536,103296,7488768,7737664,358556,8053760,3809920,3810944,5219328,5234944,7971840,440480,449696,8008448,17,348320,106496,5197824,264192,3810304,7481600,896,7733568,158784
.long 1386496,3629824,16777216,67584,16777216,219136,15,8192,0,16777216,693248,5192704,158976,10240,1181696,1161216,1222656,1202176,1232896,2803712,2824192,2844672,148480,3615232,1474688,123776,7489024,7737728,379036,8058880,3811072,3811584,5260288,5275904,7976960,17207456,17232032,24836096,18,368800,110592,5218304,264192,3811328,7481856,896,7733568,158848
.long 1391616,3630208,16777216,68352,166784,165888,9,8192,0,16777216,693760,5195264,159104,15360,1186816,1166336,1227776,1207296,1238016,2808832,2829312,2846720,150528,3616768,1523840,144256,7489280,7737792,399516,8064000,3811840,3812864,5301248,5316864,7982080,17207456,17232032,24836096,19,389280,114688,5238784,264192,3812352,7482112,896,7733568,158912
.long 1693696,3652864,79488,65536,227456,217088,15,8192,0,700544,700416,5842944,158720,0,1171456,1150976,1212416,1191936,1243136,2813952,2834432,2849792,143360,3612160,1377152,574336,7549952,7752960,993436,8048640,3825536,3826048,5833728,5849344,7966720,435680,444896,8212992,48,983200,102400,5832704,264192,3825664,7542784,896,7733568,158720
.long 1698816,3653248,16777216,66560,101120,100352,15,8192,0,16777216,700928,5845504,158848,5120,1176576,1156096,1217536,1197056,1248256,2819072,2839552,2851840,145408,3613696,1426304,594816,7550208,7753024,1013916,8053760,3826304,3827328,5874688,5890304,7971840,440800,450016,8213248,49,1003680,106496,5853184,264192,3826688,7543040,896,7733568,158784
.long 1796096,3660544,16777216,67584,16777216,219136,15,8192,0,16777216,701440,5848064,158976,10240,1181696,1161216,1222656,1202176,1232896,2803712,2824192,2844672,148480,3615232,1475456,615296,7550464,7753088,1034396,8058880,3827456,3827968,5915648,5931264,7976960,17207776,17232352,25040896,50,1024160,110592,5873664,264192,3827712,7543296,896,7733568,158848
.long 1801216,3660928,16777216,68352,179072,178176,9,8192,0,16777216,701952,5850624,159104,15360,1186816,1166336,1227776,1207296,1238016,2808832,2829312,2846720,150528,3616768,1524608,635776,7550720,7753152,1054876,8064000,3828224,3829248,5956608,5972224,7982080,17207776,17232352,25040896,51,1044640,114688,5894144,264192,3828736,7543552,896,7733568,158912
.long 1335296,3625984,71936,65536,235648,217088,15,8192,0,708736,708608,6498304,158720,0,1171456,1150976,1212416,1191936,1243136,2813952,2834432,2849792,143360,3612160,1377920,1065856,7611392,7768320,1648796,8048640,3841920,3842432,6489088,6504704,7966720,436000,445216,8417792,80,1638560,102400,6488064,264192,3842048,7604224,896,7733568,158720
.long 1340416,3626368,16777216,66560,101632,100352,15,8192,0,16777216,709120,6500864,158848,5120,1176576,1156096,1217536,1197056,1248256,2819072,2839552,2851840,145408,3613696,1427072,1086336,7611648,7768384,1669276,8053760,3842688,3843712,6530048,6545664,7971840,441120,450336,8418048,81,1659040,106496,6508544,264192,3843072,7604480,896,7733568,158784
.long 1437696,3633664,16777216,67584,16777216,219136,15,8192,0,16777216,709632,6503424,158976,10240,1181696,1161216,1222656,1202176,1232896,2803712,2824192,2844672,148480,3615232,1476224,1106816,7611904,7768448,1689756,8058880,3843840,3844352,6571008,6586624,7976960,17208096,17232672,25245696,82,1679520,110592,6529024,264192,3844096,7604736,896,7733568,158848
.long 1442816,3634048,16777216,68352,191360,190464,9,8192,0,16777216,710144,6505984,159104,15360,1186816,1166336,1227776,1207296,1238016,2808832,2829312,2846720,150528,3616768,1525376,1127296,7612160,7768512,1710236,8064000,3844608,3845632,6611968,6627584,7982080,17208096,17232672,25245696,83,1700000,114688,6549504,264192,3845120,7604992,896,7733568,158912
.long 1744896,3656704,80128,65536,243840,217088,15,8192,0,716928,716800,7153664,158720,0,1171456,1150976,1212416,1191936,1243136,2813952,2834432,2849792,143360,3612160,1378688,1557376,7672832,7783680,2304156,8048640,3858304,3858816,7144448,7160064,7966720,436320,445536,8622592,112,2293920,102400,7143424,264192,3858432,7665664,896,7733568,158720
.long 1750016,3657088,16777216,66560,102144,100352,15,8192,0,16777216,717312,7156224,158848,5120,1176576,1156096,1217536,1197056,1248256,2819072,2839552,2851840,145408,3613696,1427840,1577856,7673088,7783744,2324636,8053760,3859072,3860096,7185408,7201024,7971840,441440,450656,8622848,113,2314400,106496,7163904,264192,3859456,7665920,896,7733568,158784
.long 1847296,3664384,16777216,67584,16777216,219136,15,8192,0,16777216,717824,7158784,158976,10240,1181696,1161216,1222656,1202176,1232896,2803712,2824192,2844672,148480,3615232,1476992,1598336,7673344,7783808,2345116,8058880,3860224,3860736,7226368,7241984,7976960,17208416,17232992,25450496,114,2334880,110592,7184384,264192,3860480,7666176,896,7733568,158848
.long 1852416,3664768,16777216,68352,203648,202752,9,8192,0,16777216,718336,7161344,159104,15360,1186816,1166336,1227776,1207296,1238016,2808832,2829312,2846720,150528,3616768,1526144,1618816,7673600,7783872,2365596,8064000,3860992,3862016,7267328,7282944,7982080,17208416,17232992,25450496,115,2355360,114688,7204864,264192,3861504,7666432,896,7733568,158912
.long 2103296,3683584,87680,81920,223360,217088,15,0,2048,693376,692224,5269504,158720,0,1990656,1970176,2031616,2011136,2062336,3223552,3244032,3259392,143360,3673600,1376768,328576,7519232,7745280,419996,8058880,4333440,4333952,5186560,5196032,7966720,435520,444736,8110592,20,409760,102400,5259264,280576,4333568,7512064,896,7733568,158976
.long 2108416,3683968,16777216,82944,116992,116736,15,0,2048,16777216,692736,5272064,158848,5120,1995776,1975296,2036736,2016256,2067456,3228672,3249152,3261440,145408,3675136,1425920,349056,7519488,7745344,440476,8064000,4334208,4335232,5227520,5236992,7971840,440640,449856,8110848,21,430240,106496,5279744,280576,4334592,7512320,896,7733568,159040
.long 2205696,3691264,16777216,83968,16777216,219136,15,0,2048,16777216,693248,5274624,158976,10240,2000896,1980416,2041856,2021376,2052096,3213312,3233792,3254272,148480,3676672,1475072,369536,7519744,7745408,460956,8048640,4335360,4335872,5268480,5277952,7976960,17207616,17232192,24938496,22,450720,110592,5300224,280576,4335616,7512576,896,7733568,159104
.long 2210816,3691648,16777216,84736,172928,172032,9,0,2048,16777216,693760,5277184,159104,15360,2006016,1985536,2046976,2026496,2057216,3218432,3238912,3256320,150528,3678208,1524224,390016,7520000,7745472,481436,8053760,4336128,4337152,5309440,5318912,7982080,17207616,17232192,24938496,23,471200,114688,5320704,280576,4336640,7512832,896,7733568,159168
.long 2512896,3714304,95872,81920,231552,217088,15,0,2048,701568,700416,5924864,158720,0,1990656,1970176,2031616,2011136,2062336,3223552,3244032,3259392,143360,3673600,1377536,820096,7580672,7760640,1075356,8058880,4349824,4350336,5841920,5851392,7966720,435840,445056,8315392,52,1065120,102400,5914624,280576,4349952,7573504,896,7733568,158976
.long 2518016,3714688,16777216,82944,117504,116736,15,0,2048,16777216,700928,5927424,158848,5120,1995776,1975296,2036736,2016256,2067456,3228672,3249152,3261440,145408,3675136,1426688,840576,7580928,7760704,1095836,8064000,4350592,4351616,5882880,5892352,7971840,440960,450176,8315648,53,1085600,106496,5935104,280576,4350976,7573760,896,7733568,159040
.long 2615296,3721984,16777216,83968,16777216,219136,15,0,2048,16777216,701440,5929984,158976,10240,2000896,1980416,2041856,2021376,2052096,3213312,3233792,3254272,148480,3676672,1475840,861056,7581184,7760768,1116316,8048640,4351744,4352256,5923840,5933312,7976960,17207936,17232512,25143296,54,1106080,110592,5955584,280576,4352000,7574016,896,7733568,159104
.long 2620416,3722368,16777216,84736,185216,184320,9,0,2048,16777216,701952,5932544,159104,15360,2006016,1985536,2046976,2026496,2057216,3218432,3238912,3256320,150528,3678208,1524992,881536,7581440,7760832,1136796,8053760,4352512,4353536,5964800,5974272,7982080,17207936,17232512,25143296,55,1126560,114688,5976064,280576,4353024,7574272,896,7733568,159168
.long 2154496,3687424,88320,81920,239744,217088,15,0,2048,709760,708608,6580224,158720,0,1990656,1970176,2031616,2011136,2062336,3223552,3244032,3259392,143360,3673600,1378304,1311616,7642112,7776000,1730716,8058880,4366208,4366720,6497280,6506752,7966720,436160,445376,8520192,84,1720480,102400,6569984,280576,4366336,7634944,896,7733568,158976
.long 2159616,3687808,16777216,82944,118016,116736,15,0,2048,16777216,709120,6582784,158848,5120,1995776,1975296,2036736,2016256,2067456,3228672,3249152,3261440,145408,3675136,1427456,1332096,7642368,7776064,1751196,8064000,4366976,4368000,6538240,6547712,7971840,441280,450496,8520448,85,1740960,106496,6590464,280576,4367360,7635200,896,7733568,159040
.long 2256896,3695104,16777216,83968,16777216,219136,15,0,2048,16777216,709632,6585344,158976,10240,2000896,1980416,2041856,2021376,2052096,3213312,3233792,3254272,148480,3676672,1476608,1352576,7642624,7776128,1771676,8048640,4368128,4368640,6579200,6588672,7976960,17208256,17232832,25348096,86,1761440,110592,6610944,280576,4368384,7635456,896,7733568,159104
.long 2262016,3695488,16777216,84736,197504,196608,9,0,2048,16777216,710144,6587904,159104,15360,2006016,1985536,2046976,2026496,2057216,3218432,3238912,3256320,150528,3678208,1525760,1373056,7642880,7776192,1792156,8053760,4368896,4369920,6620160,6629632,7982080,17208256,17232832,25348096,87,1781920,114688,6631424,280576,4369408,7635712,896,7733568,159168
.long 2564096,3718144,96512,81920,215168,217088,15,0,2048,717952,716800,7235584,158720,0,1990656,1970176,2031616,2011136,2062336,3223552,3244032,3259392,143360,3673600,1379072,1803136,7703552,7791360,2386076,8058880,4382592,4383104,7152640,7162112,7966720,435200,444416,7905792,116,2375840,102400,7225344,280576,4382720,7696384,896,7733568,158976
.long 2569216,3718528,16777216,82944,118528,116736,15,0,2048,16777216,717312,7238144,158848,5120,1995776,1975296,2036736,2016256,2067456,3228672,3249152,3261440,145408,3675136,1428224,1823616,7703808,7791424,2406556,8064000,4383360,4384384,7193600,7203072,7971840,440320,449536,7906048,117,2396320,106496,7245824,280576,4383744,7696640,896,7733568,159040
.long 2666496,3725824,16777216,83968,16777216,219136,15,0,2048,16777216,717824,7240704,158976,10240,2000896,1980416,2041856,2021376,2052096,3213312,3233792,3254272,148480,3676672,1477376,1844096,7704064,7791488,2427036,8048640,4384512,4385024,7234560,7244032,7976960,17207296,17231872,24733696,118,2416800,110592,7266304,280576,4384768,7696896,896,7733568,159104
.long 2671616,3726208,16777216,84736,209792,208896,9,0,2048,16777216,718336,7243264,159104,15360,2006016,1985536,2046976,2026496,2057216,3218432,3238912,3256320,150528,3678208,1526528,1864576,7704320,7791552,2447516,8053760,4385280,4386304,7275520,7284992,7982080,17207296,17231872,24733696,119,2437280,114688,7286784,280576,4385792,7697152,896,7733568,159168
.long 1089536,3607552,67328,69632,223488,221184,15,8192,0,692480,692224,5197824,158720,0,1294336,1314816,1253376,1273856,1335296,2875392,2854912,2895872,143360,3619840,1572992,82944,7489536,7737856,328156,8151040,3874688,3875200,5179392,5194240,8069120,461120,470336,8115200,16,328000,102400,5177344,266240,3874816,7481344,1024,7733888,158720
.long 1094656,3607936,16777216,70656,102656,102400,15,8192,0,16777216,692736,5200384,158848,5120,1299456,1319936,1258496,1278976,1340416,2880512,2860032,2897920,145408,3621376,1622144,103424,7489792,7737920,348636,8156160,3875456,3876480,5220352,5235200,8074240,466240,475456,8115456,17,348480,106496,5197824,266240,3875840,7481600,1024,7733888,158784
.long 1191936,3615232,16777216,71680,16777216,223232,15,8192,0,16777216,693248,5202944,158976,10240,1304576,1325056,1263616,1284096,1345536,2885632,2865152,2900992,148480,3622912,1671296,123904,7490048,7737984,369116,8161280,3876608,3877120,5261312,5276160,8079360,481600,506176,8161536,18,368960,110592,5218304,266240,3876864,7481856,1024,7733888,158848
.long 1197056,3615616,16777216,72448,166912,165888,9,8192,0,16777216,693760,5205504,159104,15360,1309696,1330176,1268736,1289216,1350656,2890752,2870272,2903040,150528,3624448,1720448,144384,7490304,7738048,389596,8166400,3877376,3878400,5302272,5317120,8084480,17258816,17283392,24938752,19,389440,114688,5238784,266240,3877888,7482112,1024,7733888,158912
.long 1499136,3638272,75520,69632,231680,221184,15,8192,0,700672,700416,5853184,158720,0,1294336,1314816,1253376,1273856,1335296,2875392,2854912,2895872,143360,3619840,1573760,574464,7550976,7753216,983516,8151040,3891072,3891584,5834752,5849600,8069120,461440,470656,8320000,48,983360,102400,5832704,266240,3891200,7542784,1024,7733888,158720
.long 1504256,3638656,16777216,70656,103168,102400,15,8192,0,16777216,700928,5855744,158848,5120,1299456,1319936,1258496,1278976,1340416,2880512,2860032,2897920,145408,3621376,1622912,594944,7551232,7753280,1003996,8156160,3891840,3892864,5875712,5890560,8074240,466560,475776,8320256,49,1003840,106496,5853184,266240,3892224,7543040,1024,7733888,158784
.long 1601536,3645952,16777216,71680,16777216,223232,15,8192,0,16777216,701440,5858304,158976,10240,1304576,1325056,1263616,1284096,1345536,2885632,2865152,2900992,148480,3622912,1672064,615424,7551488,7753344,1024476,8161280,3892992,3893504,5916672,5931520,8079360,481920,506496,8366336,50,1024320,110592,5873664,266240,3893248,7543296,1024,7733888,158848
.long 1606656,3646336,16777216,72448,179200,178176,9,8192,0,16777216,701952,5860864,159104,15360,1309696,1330176,1268736,1289216,1350656,2890752,2870272,2903040,150528,3624448,1721216,635904,7551744,7753408,1044956,8166400,3893760,3894784,5957632,5972480,8084480,17259136,17283712,25143552,51,1044800,114688,5894144,266240,3894272,7543552,1024,7733888,158912
.long 1140736,3611392,67968,69632,239872,221184,15,8192,0,708864,708608,6508544,158720,0,1294336,1314816,1253376,1273856,1335296,2875392,2854912,2895872,143360,3619840,1574528,1065984,7612416,7768576,1638876,8151040,3907456,3907968,6490112,6504960,8069120,461760,470976,8524800,80,1638720,102400,6488064,266240,3907584,7604224,1024,7733888,158720
.long 1145856,3611776,16777216,70656,103680,102400,15,8192,0,16777216,709120,6511104,158848,5120,1299456,1319936,1258496,1278976,1340416,2880512,2860032,2897920,145408,3621376,1623680,1086464,7612672,7768640,1659356,8156160,3908224,3909248,6531072,6545920,8074240,466880,476096,8525056,81,1659200,106496,6508544,266240,3908608,7604480,1024,7733888,158784
.long 1243136,3619072,16777216,71680,16777216,223232,15,8192,0,16777216,709632,6513664,158976,10240,1304576,1325056,1263616,1284096,1345536,2885632,2865152,2900992,148480,3622912,1672832,1106944,7612928,7768704,1679836,8161280,3909376,3909888,6572032,6586880,8079360,482240,506816,8571136,82,1679680,110592,6529024,266240,3909632,7604736,1024,7733888,158848
.long 1248256,3619456,16777216,72448,191488,190464,9,8192,0,16777216,710144,6516224,159104,15360,1309696,1330176,1268736,1289216,1350656,2890752,2870272,2903040,150528,3624448,1721984,1127424,7613184,7768768,1700316,8166400,3910144,3911168,6612992,6627840,8084480,17259456,17284032,25348352,83,1700160,114688,6549504,266240,3910656,7604992,1024,7733888,158912
.long 1550336,3642112,76160,69632,215296,221184,15,8192,0,717056,716800,7163904,158720,0,1294336,1314816,1253376,1273856,1335296,2875392,2854912,2895872,143360,3619840,1575296,1557504,7673856,7783936,2294236,8151040,3923840,3924352,7145472,7160320,8069120,460800,470016,7910400,112,2294080,102400,7143424,266240,3923968,7665664,1024,7733888,158720
.long 1555456,3642496,16777216,70656,104192,102400,15,8192,0,16777216,717312,7166464,158848,5120,1299456,1319936,1258496,1278976,1340416,2880512,2860032,2897920,145408,3621376,1624448,1577984,7674112,7784000,2314716,8156160,3924608,3925632,7186432,7201280,8074240,465920,475136,7910656,113,2314560,106496,7163904,266240,3924992,7665920,1024,7733888,158784
.long 1652736,3649792,16777216,71680,16777216,223232,15,8192,0,16777216,717824,7169024,158976,10240,1304576,1325056,1263616,1284096,1345536,2885632,2865152,2900992,148480,3622912,1673600,1598464,7674368,7784064,2335196,8161280,3925760,3926272,7227392,7242240,8079360,481280,505856,7956736,114,2335040,110592,7184384,266240,3926016,7666176,1024,7733888,158848
.long 1657856,3650176,16777216,72448,203776,202752,9,8192,0,16777216,718336,7171584,159104,15360,1309696,1330176,1268736,1289216,1350656,2890752,2870272,2903040,150528,3624448,1722752,1618944,7674624,7784128,2355676,8166400,3926528,3927552,7268352,7283200,8084480,17258496,17283072,24733952,115,2355520,114688,7204864,266240,3927040,7666432,1024,7733888,158912
.long 1908736,3668992,83712,86016,227584,221184,15,0,2048,693504,692224,5279744,158720,0,2113536,2134016,2072576,2093056,2154496,3284992,3264512,3305472,143360,3681280,1573376,328704,7520256,7745536,410076,8161280,4398976,4399488,5187584,5196288,8069120,461280,470496,8217600,20,409920,102400,5259264,282624,4399104,7512064,1024,7733888,158976
.long 1913856,3669376,16777216,87040,119040,118784,15,0,2048,16777216,692736,5282304,158848,5120,2118656,2139136,2077696,2098176,2159616,3290112,3269632,3307520,145408,3682816,1622528,349184,7520512,7745600,430556,8166400,4399744,4400768,5228544,5237248,8074240,466400,475616,8217856,21,430400,106496,5279744,282624,4400128,7512320,1024,7733888,159040
.long 2011136,3676672,16777216,88064,16777216,223232,15,0,2048,16777216,693248,5284864,158976,10240,2123776,2144256,2082816,2103296,2164736,3295232,3274752,3310592,148480,3684352,1671680,369664,7520768,7745664,451036,8151040,4400896,4401408,5269504,5278208,8079360,481760,506336,8263936,22,450880,110592,5300224,282624,4401152,7512576,1024,7733888,159104
.long 2016256,3677056,16777216,88832,173056,172032,9,0,2048,16777216,693760,5287424,159104,15360,2128896,2149376,2087936,2108416,2169856,3300352,3279872,3312640,150528,3685888,1720832,390144,7521024,7745728,471516,8156160,4401664,4402688,5310464,5319168,8084480,17258976,17283552,25041152,23,471360,114688,5320704,282624,4402176,7512832,1024,7733888,159168
.long 2318336,3699712,91904,86016,235776,221184,15,0,2048,701696,700416,5935104,158720,0,2113536,2134016,2072576,2093056,2154496,3284992,3264512,3305472,143360,3681280,1574144,820224,7581696,7760896,1065436,8161280,4415360,4415872,5842944,5851648,8069120,461600,470816,8422400,52,1065280,102400,5914624,282624,4415488,7573504,1024,7733888,158976
.long 2323456,3700096,16777216,87040,119552,118784,15,0,2048,16777216,700928,5937664,158848,5120,2118656,2139136,2077696,2098176,2159616,3290112,3269632,3307520,145408,3682816,1623296,840704,7581952,7760960,1085916,8166400,4416128,4417152,5883904,5892608,8074240,466720,475936,8422656,53,1085760,106496,5935104,282624,4416512,7573760,1024,7733888,159040
.long 2420736,3707392,16777216,88064,16777216,223232,15,0,2048,16777216,701440,5940224,158976,10240,2123776,2144256,2082816,2103296,2164736,3295232,3274752,3310592,148480,3684352,1672448,861184,7582208,7761024,1106396,8151040,4417280,4417792,5924864,5933568,8079360,482080,506656,8468736,54,1106240,110592,5955584,282624,4417536,7574016,1024,7733888,159104
.long 2425856,3707776,16777216,88832,185344,184320,9,0,2048,16777216,701952,5942784,159104,15360,2128896,2149376,2087936,2108416,2169856,3300352,3279872,3312640,150528,3685888,1721600,881664,7582464,7761088,1126876,8156160,4418048,4419072,5965824,5974528,8084480,17259296,17283872,25245952,55,1126720,114688,5976064,282624,4418560,7574272,1024,7733888,159168
.long 1959936,3672832,84352,86016,243968,221184,15,0,2048,709888,708608,6590464,158720,0,2113536,2134016,2072576,2093056,2154496,3284992,3264512,3305472,143360,3681280,1574912,1311744,7643136,7776256,1720796,8161280,4431744,4432256,6498304,6507008,8069120,461920,471136,8627200,84,1720640,102400,6569984,282624,4431872,7634944,1024,7733888,158976
.long 1965056,3673216,16777216,87040,120064,118784,15,0,2048,16777216,709120,6593024,158848,5120,2118656,2139136,2077696,2098176,2159616,3290112,3269632,3307520,145408,3682816,1624064,1332224,7643392,7776320,1741276,8166400,4432512,4433536,6539264,6547968,8074240,467040,476256,8627456,85,1741120,106496,6590464,282624,4432896,7635200,1024,7733888,159040
.long 2062336,3680512,16777216,88064,16777216,223232,15,0,2048,16777216,709632,6595584,158976,10240,2123776,2144256,2082816,2103296,2164736,3295232,3274752,3310592,148480,3684352,1673216,1352704,7643648,7776384,1761756,8151040,4433664,4434176,6580224,6588928,8079360,482400,506976,8673536,86,1761600,110592,6610944,282624,4433920,7635456,1024,7733888,159104
.long 2067456,3680896,16777216,88832,197632,196608,9,0,2048,16777216,710144,6598144,159104,15360,2128896,2149376,2087936,2108416,2169856,3300352,3279872,3312640,150528,3685888,1722368,1373184,7643904,7776448,1782236,8156160,4434432,4435456,6621184,6629888,8084480,17259616,17284192,25450752,87,1782080,114688,6631424,282624,4434944,7635712,1024,7733888,159168
.long 2369536,3703552,92544,86016,219392,221184,15,0,2048,718080,716800,7245824,158720,0,2113536,2134016,2072576,2093056,2154496,3284992,3264512,3305472,143360,3681280,1575680,1803264,7704576,7791616,2376156,8161280,4448128,4448640,7153664,7162368,8069120,460960,470176,8012800,116,2376000,102400,7225344,282624,4448256,7696384,1024,7733888,158976
.long 2374656,3703936,16777216,87040,120576,118784,15,0,2048,16777216,717312,7248384,158848,5120,2118656,2139136,2077696,2098176,2159616,3290112,3269632,3307520,145408,3682816,1624832,1823744,7704832,7791680,2396636,8166400,4448896,4449920,7194624,7203328,8074240,466080,475296,8013056,117,2396480,106496,7245824,282624,4449280,7696640,1024,7733888,159040
.long 2471936,3711232,16777216,88064,16777216,223232,15,0,2048,16777216,717824,7250944,158976,10240,2123776,2144256,2082816,2103296,2164736,3295232,3274752,3310592,148480,3684352,1673984,1844224,7705088,7791744,2417116,8151040,4450048,4450560,7235584,7244288,8079360,481440,506016,8059136,118,2416960,110592,7266304,282624,4450304,7696896,1024,7733888,159104
.long 2477056,3711616,16777216,88832,209920,208896,9,0,2048,16777216,718336,7253504,159104,15360,2128896,2149376,2087936,2108416,2169856,3300352,3279872,3312640,150528,3685888,1723136,1864704,7705344,7791808,2437596,8156160,4450816,4451840,7276544,7285248,8084480,17258656,17283232,24836352,119,2437440,114688,7286784,282624,4451328,7697152,1024,7733888,159168
.long 1294336,3622912,71424,69632,227712,225280,15,8192,0,692608,692224,5208064,158720,0,1417216,1396736,1376256,1355776,1447936,2936832,2916352,2952192,143360,3627520,1769600,83072,7490560,7738112,338396,8253440,3940224,3940736,5180416,5194496,8171520,486880,496096,8218112,16,328160,102400,5177344,268288,3940352,7481344,1152,7734208,158720
.long 1299456,3623296,16777216,70656,104704,104448,15,8192,0,16777216,692736,5210624,158848,5120,1422336,1401856,1381376,1360896,1453056,2941952,2921472,2954240,145408,3629056,1818752,103552,7490816,7738176,358876,8258560,3940992,3942016,5221376,5235456,8176640,492000,501216,8218368,17,348640,106496,5197824,268288,3941376,7481600,1152,7734208,158784
.long 1396736,3630592,16777216,71680,16777216,227328,15,8192,0,16777216,693248,5213184,158976,10240,1427456,1406976,1386496,1366016,1437696,2926592,2906112,2947072,148480,3630592,1867904,124032,7491072,7738240,379356,8263680,3942144,3942656,5262336,5276416,8181760,17258976,17283552,25041152,18,369120,110592,5218304,268288,3942400,7481856,1152,7734208,158848
.long 1401856,3630976,16777216,72448,167040,165888,9,8192,0,16777216,693760,5215744,159104,15360,1432576,1412096,1391616,1371136,1442816,2931712,2911232,2949120,150528,3632128,1917056,144512,7491328,7738304,399836,8268800,3942912,3943936,5303296,5317376,8186880,17258976,17283552,25041152,19,389600,114688,5238784,268288,3943424,7482112,1152,7734208,158912
.long 1703936,3653632,79616,69632,235904,225280,15,8192,0,700800,700416,5863424,158720,0,1417216,1396736,1376256,1355776,1447936,2936832,2916352,2952192,143360,3627520,1770368,574592,7552000,7753472,993756,8253440,3956608,3957120,5835776,5849856,8171520,487200,496416,8422912,48,983520,102400,5832704,268288,3956736,7542784,1152,7734208,158720
.long 1709056,3654016,16777216,70656,105216,104448,15,8192,0,16777216,700928,5865984,158848,5120,1422336,1401856,1381376,1360896,1453056,2941952,2921472,2954240,145408,3629056,1819520,595072,7552256,7753536,1014236,8258560,3957376,3958400,5876736,5890816,8176640,492320,501536,8423168,49,1004000,106496,5853184,268288,3957760,7543040,1152,7734208,158784
.long 1806336,3661312,16777216,71680,16777216,227328,15,8192,0,16777216,701440,5868544,158976,10240,1427456,1406976,1386496,1366016,1437696,2926592,2906112,2947072,148480,3630592,1868672,615552,7552512,7753600,1034716,8263680,3958528,3959040,5917696,5931776,8181760,17259296,17283872,25245952,50,1024480,110592,5873664,268288,3958784,7543296,1152,7734208,158848
.long 1811456,3661696,16777216,72448,179328,178176,9,8192,0,16777216,701952,5871104,159104,15360,1432576,1412096,1391616,1371136,1442816,2931712,2911232,2949120,150528,3632128,1917824,636032,7552768,7753664,1055196,8268800,3959296,3960320,5958656,5972736,8186880,17259296,17283872,25245952,51,1044960,114688,5894144,268288,3959808,7543552,1152,7734208,158912
.long 1345536,3626752,72064,69632,244096,225280,15,8192,0,708992,708608,6518784,158720,0,1417216,1396736,1376256,1355776,1447936,2936832,2916352,2952192,143360,3627520,1771136,1066112,7613440,7768832,1649116,8253440,3972992,3973504,6491136,6505216,8171520,487520,496736,8627712,80,1638880,102400,6488064,268288,3973120,7604224,1152,7734208,158720
.long 1350656,3627136,16777216,70656,105728,104448,15,8192,0,16777216,709120,6521344,158848,5120,1422336,1401856,1381376,1360896,1453056,2941952,2921472,2954240,145408,3629056,1820288,1086592,7613696,7768896,1669596,8258560,3973760,3974784,6532096,6546176,8176640,492640,501856,8627968,81,1659360,106496,6508544,268288,3974144,7604480,1152,7734208,158784
.long 1447936,3634432,16777216,71680,16777216,227328,15,8192,0,16777216,709632,6523904,158976,10240,1427456,1406976,1386496,1366016,1437696,2926592,2906112,2947072,148480,3630592,1869440,1107072,7613952,7768960,1690076,8263680,3974912,3975424,6573056,6587136,8181760,17259616,17284192,25450752,82,1679840,110592,6529024,268288,3975168,7604736,1152,7734208,158848
.long 1453056,3634816,16777216,72448,191616,190464,9,8192,0,16777216,710144,6526464,159104,15360,1432576,1412096,1391616,1371136,1442816,2931712,2911232,2949120,150528,3632128,1918592,1127552,7614208,7769024,1710556,8268800,3975680,3976704,6614016,6628096,8186880,17259616,17284192,25450752,83,1700320,114688,6549504,268288,3976192,7604992,1152,7734208,158912
.long 1755136,3657472,80256,69632,219520,225280,15,8192,0,717184,716800,7174144,158720,0,1417216,1396736,1376256,1355776,1447936,2936832,2916352,2952192,143360,3627520,1771904,1557632,7674880,7784192,2304476,8253440,3989376,3989888,7146496,7160576,8171520,486560,495776,8013312,112,2294240,102400,7143424,268288,3989504,7665664,1152,7734208,158720
.long 1760256,3657856,16777216,70656,106240,104448,15,8192,0,16777216,717312,7176704,158848,5120,1422336,1401856,1381376,1360896,1453056,2941952,2921472,2954240,145408,3629056,1821056,1578112,7675136,7784256,2324956,8258560,3990144,3991168,7187456,7201536,8176640,491680,500896,8013568,113,2314720,106496,7163904,268288,3990528,7665920,1152,7734208,158784
.long 1857536,3665152,16777216,71680,16777216,227328,15,8192,0,16777216,717824,7179264,158976,10240,1427456,1406976,1386496,1366016,1437696,2926592,2906112,2947072,148480,3630592,1870208,1598592,7675392,7784320,2345436,8263680,3991296,3991808,7228416,7242496,8181760,17258656,17283232,24836352,114,2335200,110592,7184384,268288,3991552,7666176,1152,7734208,158848
.long 1862656,3665536,16777216,72448,203904,202752,9,8192,0,16777216,718336,7181824,159104,15360,1432576,1412096,1391616,1371136,1442816,2931712,2911232,2949120,150528,3632128,1919360,1619072,7675648,7784384,2365916,8268800,3992064,3993088,7269376,7283456,8186880,17258656,17283232,24836352,115,2355680,114688,7204864,268288,3992576,7666432,1152,7734208,158912
.long 2113536,3684352,87808,86016,231808,225280,15,0,2048,693632,692224,5289984,158720,0,2236416,2215936,2195456,2174976,2267136,3346432,3325952,3361792,143360,3688960,1769984,328832,7521280,7745792,420316,8263680,4464512,4465024,5188608,5196544,8171520,487040,496256,8320512,20,410080,102400,5259264,284672,4464640,7512064,1152,7734208,158976
.long 2118656,3684736,16777216,87040,121088,120832,15,0,2048,16777216,692736,5292544,158848,5120,2241536,2221056,2200576,2180096,2272256,3351552,3331072,3363840,145408,3690496,1819136,349312,7521536,7745856,440796,8268800,4465280,4466304,5229568,5237504,8176640,492160,501376,8320768,21,430560,106496,5279744,284672,4465664,7512320,1152,7734208,159040
.long 2215936,3692032,16777216,88064,16777216,227328,15,0,2048,16777216,693248,5295104,158976,10240,2246656,2226176,2205696,2185216,2256896,3336192,3315712,3356672,148480,3692032,1868288,369792,7521792,7745920,461276,8253440,4466432,4466944,5270528,5278464,8181760,17259136,17283712,25143552,22,451040,110592,5300224,284672,4466688,7512576,1152,7734208,159104
.long 2221056,3692416,16777216,88832,173184,172032,9,0,2048,16777216,693760,5297664,159104,15360,2251776,2231296,2210816,2190336,2262016,3341312,3320832,3358720,150528,3693568,1917440,390272,7522048,7745984,481756,8258560,4467200,4468224,5311488,5319424,8186880,17259136,17283712,25143552,23,471520,114688,5320704,284672,4467712,7512832,1152,7734208,159168
.long 2523136,3715072,96000,86016,240000,225280,15,0,2048,701824,700416,5945344,158720,0,2236416,2215936,2195456,2174976,2267136,3346432,3325952,3361792,143360,3688960,1770752,820352,7582720,7761152,1075676,8263680,4480896,4481408,5843968,5851904,8171520,487360,496576,8525312,52,1065440,102400,5914624,284672,4481024,7573504,1152,7734208,158976
.long 2528256,3715456,16777216,87040,121600,120832,15,0,2048,16777216,700928,5947904,158848,5120,2241536,2221056,2200576,2180096,2272256,3351552,3331072,3363840,145408,3690496,1819904,840832,7582976,7761216,1096156,8268800,4481664,4482688,5884928,5892864,8176640,492480,501696,8525568,53,1085920,106496,5935104,284672,4482048,7573760,1152,7734208,159040
.long 2625536,3722752,16777216,88064,16777216,227328,15,0,2048,16777216,701440,5950464,158976,10240,2246656,2226176,2205696,2185216,2256896,3336192,3315712,3356672,148480,3692032,1869056,861312,7583232,7761280,1116636,8253440,4482816,4483328,5925888,5933824,8181760,17259456,17284032,25348352,54,1106400,110592,5955584,284672,4483072,7574016,1152,7734208,159104
.long 2630656,3723136,16777216,88832,185472,184320,9,0,2048,16777216,701952,5953024,159104,15360,2251776,2231296,2210816,2190336,2262016,3341312,3320832,3358720,150528,3693568,1918208,881792,7583488,7761344,1137116,8258560,4483584,4484608,5966848,5974784,8186880,17259456,17284032,25348352,55,1126880,114688,5976064,284672,4484096,7574272,1152,7734208,159168
.long 2164736,3688192,88448,86016,215424,225280,15,0,2048,710016,708608,6600704,158720,0,2236416,2215936,2195456,2174976,2267136,3346432,3325952,3361792,143360,3688960,1771520,1311872,7644160,7776512,1731036,8263680,4497280,4497792,6499328,6507264,8171520,486400,495616,7910912,84,1720800,102400,6569984,284672,4497408,7634944,1152,7734208,158976
.long 2169856,3688576,16777216,87040,122112,120832,15,0,2048,16777216,709120,6603264,158848,5120,2241536,2221056,2200576,2180096,2272256,3351552,3331072,3363840,145408,3690496,1820672,1332352,7644416,7776576,1751516,8268800,4498048,4499072,6540288,6548224,8176640,491520,500736,7911168,85,1741280,106496,6590464,284672,4498432,7635200,1152,7734208,159040
.long 2267136,3695872,16777216,88064,16777216,227328,15,0,2048,16777216,709632,6605824,158976,10240,2246656,2226176,2205696,2185216,2256896,3336192,3315712,3356672,148480,3692032,1869824,1352832,7644672,7776640,1771996,8253440,4499200,4499712,6581248,6589184,8181760,17258496,17283072,24733952,86,1761760,110592,6610944,284672,4499456,7635456,1152,7734208,159104
.long 2272256,3696256,16777216,88832,197760,196608,9,0,2048,16777216,710144,6608384,159104,15360,2251776,2231296,2210816,2190336,2262016,3341312,3320832,3358720,150528,3693568,1918976,1373312,7644928,7776704,1792476,8258560,4499968,4500992,6622208,6630144,8186880,17258496,17283072,24733952,87,1782240,114688,6631424,284672,4500480,7635712,1152,7734208,159168
.long 2574336,3718912,96640,86016,223616,225280,15,0,2048,718208,716800,7256064,158720,0,2236416,2215936,2195456,2174976,2267136,3346432,3325952,3361792,143360,3688960,1772288,1803392,7705600,7791872,2386396,8263680,4513664,4514176,7154688,7162624,8171520,486720,495936,8115712,116,2376160,102400,7225344,284672,4513792,7696384,1152,7734208,158976
.long 2579456,3719296,16777216,87040,122624,120832,15,0,2048,16777216,717312,7258624,158848,5120,2241536,2221056,2200576,2180096,2272256,3351552,3331072,3363840,145408,3690496,1821440,1823872,7705856,7791936,2406876,8268800,4514432,4515456,7195648,7203584,8176640,491840,501056,8115968,117,2396640,106496,7245824,284672,4514816,7696640,1152,7734208,159040
.long 2676736,3726592,16777216,88064,16777216,227328,15,0,2048,16777216,717824,7261184,158976,10240,2246656,2226176,2205696,2185216,2256896,3336192,3315712,3356672,148480,3692032,1870592,1844352,7706112,7792000,2427356,8253440,4515584,4516096,7236608,7244544,8181760,17258816,17283392,24938752,118,2417120,110592,7266304,284672,4515840,7696896,1152,7734208,159104
.long 2681856,3726976,16777216,88832,210048,208896,9,0,2048,16777216,718336,7263744,159104,15360,2251776,2231296,2210816,2190336,2262016,3341312,3320832,3358720,150528,3693568,1919744,1864832,7706368,7792064,2447836,8258560,4516352,4517376,7277568,7285504,8186880,17258816,17283392,24938752,119,2437600,114688,7286784,284672,4516864,7697152,1152,7734208,159168
.long 1051136,3604608,68096,73728,231936,229376,15,8192,0,692736,692224,5218304,158720,0,1458176,1478656,1499136,1519616,1540096,2957312,2977792,2998272,143360,3635200,256,163840,7491584,7738368,328476,8355840,4005760,4006272,5181440,5194752,8273920,512640,521856,8325120,16,328320,102400,5177344,270336,4005888,7491584,0,7734528,158720
.long 1056256,3604992,16777216,74752,106752,106496,15,8192,0,16777216,692736,5220864,158848,5120,1463296,1483776,1504256,1524736,1545216,2962432,2982912,3000320,145408,3636736,49408,184320,7491840,7738432,348956,8360960,4006528,4007552,5222400,5235712,8279040,517760,526976,8325376,17,348800,106496,5197824,270336,4006912,7491840,0,7734528,158784
.long 1153536,3612288,16777216,75776,16777216,231424,15,8192,0,16777216,693248,5223424,158976,10240,1468416,1488896,1509376,1529856,1550336,2967552,2988032,3003392,148480,3638272,98560,204800,7492096,7738496,369436,8366080,4007680,4008192,5263360,5276672,8284160,533120,557696,8366592,18,369280,110592,5218304,270336,4007936,7492096,0,7734528,158848
.long 1158656,3612672,16777216,76544,167936,167936,9,8192,0,16777216,693760,5225984,159104,15360,1473536,1494016,1514496,1534976,1555456,2972672,2993152,3005440,150528,3639808,147712,225280,7492352,7738560,389916,8371200,4008448,4009472,5304320,5317632,8289280,17310336,17334912,25143808,19,389760,114688,5238784,270336,4008960,7492352,0,7734528,158912
.long 1460736,3635328,76288,73728,240128,229376,15,8192,0,700928,700416,5873664,158720,0,1458176,1478656,1499136,1519616,1540096,2957312,2977792,2998272,143360,3635200,1024,655360,7553024,7753728,983836,8355840,4022144,4022656,5836800,5850112,8273920,512960,522176,8529920,48,983680,102400,5832704,270336,4022272,7553024,0,7734528,158720
.long 1465856,3635712,16777216,74752,107264,106496,15,8192,0,16777216,700928,5876224,158848,5120,1463296,1483776,1504256,1524736,1545216,2962432,2982912,3000320,145408,3636736,50176,675840,7553280,7753792,1004316,8360960,4022912,4023936,5877760,5891072,8279040,518080,527296,8530176,49,1004160,106496,5853184,270336,4023296,7553280,0,7734528,158784
.long 1563136,3643008,16777216,75776,16777216,231424,15,8192,0,16777216,701440,5878784,158976,10240,1468416,1488896,1509376,1529856,1550336,2967552,2988032,3003392,148480,3638272,99328,696320,7553536,7753856,1024796,8366080,4024064,4024576,5918720,5932032,8284160,533440,558016,8571392,50,1024640,110592,5873664,270336,4024320,7553536,0,7734528,158848
.long 1568256,3643392,16777216,76544,180224,180224,9,8192,0,16777216,701952,5881344,159104,15360,1473536,1494016,1514496,1534976,1555456,2972672,2993152,3005440,150528,3639808,148480,716800,7553792,7753920,1045276,8371200,4024832,4025856,5959680,5972992,8289280,17310656,17335232,25348608,51,1045120,114688,5894144,270336,4025344,7553792,0,7734528,158912
.long 1102336,3608448,68736,73728,215552,229376,15,8192,0,709120,708608,6529024,158720,0,1458176,1478656,1499136,1519616,1540096,2957312,2977792,2998272,143360,3635200,1792,1146880,7614464,7769088,1639196,8355840,4038528,4039040,6492160,6505472,8273920,512000,521216,7915520,80,1639040,102400,6488064,270336,4038656,7614464,0,7734528,158720
.long 1107456,3608832,16777216,74752,107776,106496,15,8192,0,16777216,709120,6531584,158848,5120,1463296,1483776,1504256,1524736,1545216,2962432,2982912,3000320,145408,3636736,50944,1167360,7614720,7769152,1659676,8360960,4039296,4040320,6533120,6546432,8279040,517120,526336,7915776,81,1659520,106496,6508544,270336,4039680,7614720,0,7734528,158784
.long 1204736,3616128,16777216,75776,16777216,231424,15,8192,0,16777216,709632,6534144,158976,10240,1468416,1488896,1509376,1529856,1550336,2967552,2988032,3003392,148480,3638272,100096,1187840,7614976,7769216,1680156,8366080,4040448,4040960,6574080,6587392,8284160,532480,557056,7956992,82,1680000,110592,6529024,270336,4040704,7614976,0,7734528,158848
.long 1209856,3616512,16777216,76544,192512,192512,9,8192,0,16777216,710144,6536704,159104,15360,1473536,1494016,1514496,1534976,1555456,2972672,2993152,3005440,150528,3639808,149248,1208320,7615232,7769280,1700636,8371200,4041216,4042240,6615040,6628352,8289280,17309696,17334272,24734208,83,1700480,114688,6549504,270336,4041728,7615232,0,7734528,158912
.long 1511936,3639168,76928,73728,223744,229376,15,8192,0,717312,716800,7184384,158720,0,1458176,1478656,1499136,1519616,1540096,2957312,2977792,2998272,143360,3635200,2560,1638400,7675904,7784448,2294556,8355840,4054912,4055424,7147520,7160832,8273920,512320,521536,8120320,112,2294400,102400,7143424,270336,4055040,7675904,0,7734528,158720
.long 1517056,3639552,16777216,74752,108288,106496,15,8192,0,16777216,717312,7186944,158848,5120,1463296,1483776,1504256,1524736,1545216,2962432,2982912,3000320,145408,3636736,51712,1658880,7676160,7784512,2315036,8360960,4055680,4056704,7188480,7201792,8279040,517440,526656,8120576,113,2314880,106496,7163904,270336,4056064,7676160,0,7734528,158784
.long 1614336,3646848,16777216,75776,16777216,231424,15,8192,0,16777216,717824,7189504,158976,10240,1468416,1488896,1509376,1529856,1550336,2967552,2988032,3003392,148480,3638272,100864,1679360,7676416,7784576,2335516,8366080,4056832,4057344,7229440,7242752,8284160,532800,557376,8161792,114,2335360,110592,7184384,270336,4057088,7676416,0,7734528,158848
.long 1619456,3647232,16777216,76544,204800,204800,9,8192,0,16777216,718336,7192064,159104,15360,1473536,1494016,1514496,1534976,1555456,2972672,2993152,3005440,150528,3639808,150016,1699840,7676672,7784640,2355996,8371200,4057600,4058624,7270400,7283712,8289280,17310016,17334592,24939008,115,2355840,114688,7204864,270336,4058112,7676672,0,7734528,158912
.long 1870336,3666048,84480,90112,236032,229376,15,0,2048,693760,692224,5300224,158720,0,2277376,2297856,2318336,2338816,2359296,3366912,3387392,3407872,143360,3696640,640,409600,7522304,7746048,410396,8366080,4530048,4530560,5189632,5196800,8273920,512800,522016,8427520,20,410240,102400,5259264,286720,4530176,7522304,0,7734528,158976
.long 1875456,3666432,16777216,91136,123136,122880,15,0,2048,16777216,692736,5302784,158848,5120,2282496,2302976,2323456,2343936,2364416,3372032,3392512,3409920,145408,3698176,49792,430080,7522560,7746112,430876,8371200,4530816,4531840,5230592,5237760,8279040,517920,527136,8427776,21,430720,106496,5279744,286720,4531200,7522560,0,7734528,159040
.long 1972736,3673728,16777216,92160,16777216,231424,15,0,2048,16777216,693248,5305344,158976,10240,2287616,2308096,2328576,2349056,2369536,3377152,3397632,3412992,148480,3699712,98944,450560,7522816,7746176,451356,8355840,4531968,4532480,5271552,5278720,8284160,533280,557856,8468992,22,451200,110592,5300224,286720,4532224,7522816,0,7734528,159104
.long 1977856,3674112,16777216,92928,174080,174080,9,0,2048,16777216,693760,5307904,159104,15360,2292736,2313216,2333696,2354176,2374656,3382272,3402752,3415040,150528,3701248,148096,471040,7523072,7746240,471836,8360960,4532736,4533760,5312512,5319680,8289280,17310496,17335072,25246208,23,471680,114688,5320704,286720,4533248,7523072,0,7734528,159168
.long 2279936,3696768,92672,90112,244224,229376,15,0,2048,701952,700416,5955584,158720,0,2277376,2297856,2318336,2338816,2359296,3366912,3387392,3407872,143360,3696640,1408,901120,7583744,7761408,1065756,8366080,4546432,4546944,5844992,5852160,8273920,513120,522336,8632320,52,1065600,102400,5914624,286720,4546560,7583744,0,7734528,158976
.long 2285056,3697152,16777216,91136,123648,122880,15,0,2048,16777216,700928,5958144,158848,5120,2282496,2302976,2323456,2343936,2364416,3372032,3392512,3409920,145408,3698176,50560,921600,7584000,7761472,1086236,8371200,4547200,4548224,5885952,5893120,8279040,518240,527456,8632576,53,1086080,106496,5935104,286720,4547584,7584000,0,7734528,159040
.long 2382336,3704448,16777216,92160,16777216,231424,15,0,2048,16777216,701440,5960704,158976,10240,2287616,2308096,2328576,2349056,2369536,3377152,3397632,3412992,148480,3699712,99712,942080,7584256,7761536,1106716,8355840,4548352,4548864,5926912,5934080,8284160,533600,558176,8673792,54,1106560,110592,5955584,286720,4548608,7584256,0,7734528,159104
.long 2387456,3704832,16777216,92928,186368,186368,9,0,2048,16777216,701952,5963264,159104,15360,2292736,2313216,2333696,2354176,2374656,3382272,3402752,3415040,150528,3701248,148864,962560,7584512,7761600,1127196,8360960,4549120,4550144,5967872,5975040,8289280,17310816,17335392,25451008,55,1127040,114688,5976064,286720,4549632,7584512,0,7734528,159168
.long 1921536,3669888,85120,90112,219648,229376,15,0,2048,710144,708608,6610944,158720,0,2277376,2297856,2318336,2338816,2359296,3366912,3387392,3407872,143360,3696640,2176,1392640,7645184,7776768,1721116,8366080,4562816,4563328,6500352,6507520,8273920,512160,521376,8017920,84,1720960,102400,6569984,286720,4562944,7645184,0,7734528,158976
.long 1926656,3670272,16777216,91136,124160,122880,15,0,2048,16777216,709120,6613504,158848,5120,2282496,2302976,2323456,2343936,2364416,3372032,3392512,3409920,145408,3698176,51328,1413120,7645440,7776832,1741596,8371200,4563584,4564608,6541312,6548480,8279040,517280,526496,8018176,85,1741440,106496,6590464,286720,4563968,7645440,0,7734528,159040
.long 2023936,3677568,16777216,92160,16777216,231424,15,0,2048,16777216,709632,6616064,158976,10240,2287616,2308096,2328576,2349056,2369536,3377152,3397632,3412992,148480,3699712,100480,1433600,7645696,7776896,1762076,8355840,4564736,4565248,6582272,6589440,8284160,532640,557216,8059392,86,1761920,110592,6610944,286720,4564992,7645696,0,7734528,159104
.long 2029056,3677952,16777216,92928,198656,198656,9,0,2048,16777216,710144,6618624,159104,15360,2292736,2313216,2333696,2354176,2374656,3382272,3402752,3415040,150528,3701248,149632,1454080,7645952,7776960,1782556,8360960,4565504,4566528,6623232,6630400,8289280,17309856,17334432,24836608,87,1782400,114688,6631424,286720,4566016,7645952,0,7734528,159168
.long 2331136,3700608,93312,90112,227840,229376,15,0,2048,718336,716800,7266304,158720,0,2277376,2297856,2318336,2338816,2359296,3366912,3387392,3407872,143360,3696640,2944,1884160,7706624,7792128,2376476,8366080,4579200,4579712,7155712,7162880,8273920,512480,521696,8222720,116,2376320,102400,7225344,286720,4579328,7706624,0,7734528,158976
.long 2336256,3700992,16777216,91136,124672,122880,15,0,2048,16777216,717312,7268864,158848,5120,2282496,2302976,2323456,2343936,2364416,3372032,3392512,3409920,145408,3698176,52096,1904640,7706880,7792192,2396956,8371200,4579968,4580992,7196672,7203840,8279040,517600,526816,8222976,117,2396800,106496,7245824,286720,4580352,7706880,0,7734528,159040
.long 2433536,3708288,16777216,92160,16777216,231424,15,0,2048,16777216,717824,7271424,158976,10240,2287616,2308096,2328576,2349056,2369536,3377152,3397632,3412992,148480,3699712,101248,1925120,7707136,7792256,2417436,8355840,4581120,4581632,7237632,7244800,8284160,532960,557536,8264192,118,2417280,110592,7266304,286720,4581376,7707136,0,7734528,159104
.long 2438656,3708672,16777216,92928,210944,210944,9,0,2048,16777216,718336,7273984,159104,15360,2292736,2313216,2333696,2354176,2374656,3382272,3402752,3415040,150528,3701248,150400,1945600,7707392,7792320,2437916,8360960,4581888,4582912,7278592,7285760,8289280,17310176,17334752,25041408,119,2437760,114688,7286784,286720,4582400,7707392,0,7734528,159168
.long 1255936,3619968,72192,73728,236160,233472,15,8192,0,692864,692224,5228544,158720,0,1581056,1560576,1622016,1601536,1652736,3018752,3039232,3054592,143360,3642880,196864,163968,7492608,7738624,338716,8458240,4071296,4071808,5182464,5195008,8376320,538400,547616,8428032,16,328480,102400,5177344,272384,4071424,7491584,128,7734848,158720
.long 1261056,3620352,16777216,74752,108800,108544,15,8192,0,16777216,692736,5231104,158848,5120,1586176,1565696,1627136,1606656,1657856,3023872,3044352,3056640,145408,3644416,246016,184448,7492864,7738688,359196,8463360,4072064,4073088,5223424,5235968,8381440,543520,552736,8428288,17,348960,106496,5197824,272384,4072448,7491840,128,7734848,158784
.long 1358336,3627648,16777216,75776,16777216,235520,15,8192,0,16777216,693248,5233664,158976,10240,1591296,1570816,1632256,1611776,1642496,3008512,3028992,3049472,148480,3645952,295168,204928,7493120,7738752,379676,8468480,4073216,4073728,5264384,5276928,8386560,17310496,17335072,25246208,18,369440,110592,5218304,272384,4073472,7492096,128,7734848,158848
.long 1363456,3628032,16777216,76544,168064,167936,9,8192,0,16777216,693760,5236224,159104,15360,1596416,1575936,1637376,1616896,1647616,3013632,3034112,3051520,150528,3647488,344320,225408,7493376,7738816,400156,8473600,4073984,4075008,5305344,5317888,8391680,17310496,17335072,25246208,19,389920,114688,5238784,272384,4074496,7492352,128,7734848,158912
.long 1665536,3650688,80384,73728,244352,233472,15,8192,0,701056,700416,5883904,158720,0,1581056,1560576,1622016,1601536,1652736,3018752,3039232,3054592,143360,3642880,197632,655488,7554048,7753984,994076,8458240,4087680,4088192,5837824,5850368,8376320,538720,547936,8632832,48,983840,102400,5832704,272384,4087808,7553024,128,7734848,158720
.long 1670656,3651072,16777216,74752,109312,108544,15,8192,0,16777216,700928,5886464,158848,5120,1586176,1565696,1627136,1606656,1657856,3023872,3044352,3056640,145408,3644416,246784,675968,7554304,7754048,1014556,8463360,4088448,4089472,5878784,5891328,8381440,543840,553056,8633088,49,1004320,106496,5853184,272384,4088832,7553280,128,7734848,158784
.long 1767936,3658368,16777216,75776,16777216,235520,15,8192,0,16777216,701440,5889024,158976,10240,1591296,1570816,1632256,1611776,1642496,3008512,3028992,3049472,148480,3645952,295936,696448,7554560,7754112,1035036,8468480,4089600,4090112,5919744,5932288,8386560,17310816,17335392,25451008,50,1024800,110592,5873664,272384,4089856,7553536,128,7734848,158848
.long 1773056,3658752,16777216,76544,180352,180224,9,8192,0,16777216,701952,5891584,159104,15360,1596416,1575936,1637376,1616896,1647616,3013632,3034112,3051520,150528,3647488,345088,716928,7554816,7754176,1055516,8473600,4090368,4091392,5960704,5973248,8391680,17310816,17335392,25451008,51,1045280,114688,5894144,272384,4090880,7553792,128,7734848,158912
.long 1307136,3623808,72832,73728,219776,233472,15,8192,0,709248,708608,6539264,158720,0,1581056,1560576,1622016,1601536,1652736,3018752,3039232,3054592,143360,3642880,198400,1147008,7615488,7769344,1649436,8458240,4104064,4104576,6493184,6505728,8376320,537760,546976,8018432,80,1639200,102400,6488064,272384,4104192,7614464,128,7734848,158720
.long 1312256,3624192,16777216,74752,109824,108544,15,8192,0,16777216,709120,6541824,158848,5120,1586176,1565696,1627136,1606656,1657856,3023872,3044352,3056640,145408,3644416,247552,1167488,7615744,7769408,1669916,8463360,4104832,4105856,6534144,6546688,8381440,542880,552096,8018688,81,1659680,106496,6508544,272384,4105216,7614720,128,7734848,158784
.long 1409536,3631488,16777216,75776,16777216,235520,15,8192,0,16777216,709632,6544384,158976,10240,1591296,1570816,1632256,1611776,1642496,3008512,3028992,3049472,148480,3645952,296704,1187968,7616000,7769472,1690396,8468480,4105984,4106496,6575104,6587648,8386560,17309856,17334432,24836608,82,1680160,110592,6529024,272384,4106240,7614976,128,7734848,158848
.long 1414656,3631872,16777216,76544,192640,192512,9,8192,0,16777216,710144,6546944,159104,15360,1596416,1575936,1637376,1616896,1647616,3013632,3034112,3051520,150528,3647488,345856,1208448,7616256,7769536,1710876,8473600,4106752,4107776,6616064,6628608,8391680,17309856,17334432,24836608,83,1700640,114688,6549504,272384,4107264,7615232,128,7734848,158912
.long 1716736,3654528,81024,73728,227968,233472,15,8192,0,717440,716800,7194624,158720,0,1581056,1560576,1622016,1601536,1652736,3018752,3039232,3054592,143360,3642880,199168,1638528,7676928,7784704,2304796,8458240,4120448,4120960,7148544,7161088,8376320,538080,547296,8223232,112,2294560,102400,7143424,272384,4120576,7675904,128,7734848,158720
.long 1721856,3654912,16777216,74752,110336,108544,15,8192,0,16777216,717312,7197184,158848,5120,1586176,1565696,1627136,1606656,1657856,3023872,3044352,3056640,145408,3644416,248320,1659008,7677184,7784768,2325276,8463360,4121216,4122240,7189504,7202048,8381440,543200,552416,8223488,113,2315040,106496,7163904,272384,4121600,7676160,128,7734848,158784
.long 1819136,3662208,16777216,75776,16777216,235520,15,8192,0,16777216,717824,7199744,158976,10240,1591296,1570816,1632256,1611776,1642496,3008512,3028992,3049472,148480,3645952,297472,1679488,7677440,7784832,2345756,8468480,4122368,4122880,7230464,7243008,8386560,17310176,17334752,25041408,114,2335520,110592,7184384,272384,4122624,7676416,128,7734848,158848
.long 1824256,3662592,16777216,76544,204928,204800,9,8192,0,16777216,718336,7202304,159104,15360,1596416,1575936,1637376,1616896,1647616,3013632,3034112,3051520,150528,3647488,346624,1699968,7677696,7784896,2366236,8473600,4123136,4124160,7271424,7283968,8391680,17310176,17334752,25041408,115,2356000,114688,7204864,272384,4123648,7676672,128,7734848,158912
.long 2075136,3681408,88576,90112,240256,233472,15,0,2048,693888,692224,5310464,158720,0,2400256,2379776,2441216,2420736,2471936,3428352,3448832,3464192,143360,3704320,197248,409728,7523328,7746304,420636,8468480,4595584,4596096,5190656,5197056,8376320,538560,547776,8530432,20,410400,102400,5259264,288768,4595712,7522304,128,7734848,158976
.long 2080256,3681792,16777216,91136,125184,124928,15,0,2048,16777216,692736,5313024,158848,5120,2405376,2384896,2446336,2425856,2477056,3433472,3453952,3466240,145408,3705856,246400,430208,7523584,7746368,441116,8473600,4596352,4597376,5231616,5238016,8381440,543680,552896,8530688,21,430880,106496,5279744,288768,4596736,7522560,128,7734848,159040
.long 2177536,3689088,16777216,92160,16777216,235520,15,0,2048,16777216,693248,5315584,158976,10240,2410496,2390016,2451456,2430976,2461696,3418112,3438592,3459072,148480,3707392,295552,450688,7523840,7746432,461596,8458240,4597504,4598016,5272576,5278976,8386560,17310656,17335232,25348608,22,451360,110592,5300224,288768,4597760,7522816,128,7734848,159104
.long 2182656,3689472,16777216,92928,174208,174080,9,0,2048,16777216,693760,5318144,159104,15360,2415616,2395136,2456576,2436096,2466816,3423232,3443712,3461120,150528,3708928,344704,471168,7524096,7746496,482076,8463360,4598272,4599296,5313536,5319936,8391680,17310656,17335232,25348608,23,471840,114688,5320704,288768,4598784,7523072,128,7734848,159168
.long 2484736,3712128,96768,90112,215680,233472,15,0,2048,702080,700416,5965824,158720,0,2400256,2379776,2441216,2420736,2471936,3428352,3448832,3464192,143360,3704320,198016,901248,7584768,7761664,1075996,8468480,4611968,4612480,5846016,5852416,8376320,537600,546816,7916032,52,1065760,102400,5914624,288768,4612096,7583744,128,7734848,158976
.long 2489856,3712512,16777216,91136,125696,124928,15,0,2048,16777216,700928,5968384,158848,5120,2405376,2384896,2446336,2425856,2477056,3433472,3453952,3466240,145408,3705856,247168,921728,7585024,7761728,1096476,8473600,4612736,4613760,5886976,5893376,8381440,542720,551936,7916288,53,1086240,106496,5935104,288768,4613120,7584000,128,7734848,159040
.long 2587136,3719808,16777216,92160,16777216,235520,15,0,2048,16777216,701440,5970944,158976,10240,2410496,2390016,2451456,2430976,2461696,3418112,3438592,3459072,148480,3707392,296320,942208,7585280,7761792,1116956,8458240,4613888,4614400,5927936,5934336,8386560,17309696,17334272,24734208,54,1106720,110592,5955584,288768,4614144,7584256,128,7734848,159104
.long 2592256,3720192,16777216,92928,186496,186368,9,0,2048,16777216,701952,5973504,159104,15360,2415616,2395136,2456576,2436096,2466816,3423232,3443712,3461120,150528,3708928,345472,962688,7585536,7761856,1137436,8463360,4614656,4615680,5968896,5975296,8391680,17309696,17334272,24734208,55,1127200,114688,5976064,288768,4615168,7584512,128,7734848,159168
.long 2126336,3685248,89216,90112,223872,233472,15,0,2048,710272,708608,6621184,158720,0,2400256,2379776,2441216,2420736,2471936,3428352,3448832,3464192,143360,3704320,198784,1392768,7646208,7777024,1731356,8468480,4628352,4628864,6501376,6507776,8376320,537920,547136,8120832,84,1721120,102400,6569984,288768,4628480,7645184,128,7734848,158976
.long 2131456,3685632,16777216,91136,126208,124928,15,0,2048,16777216,709120,6623744,158848,5120,2405376,2384896,2446336,2425856,2477056,3433472,3453952,3466240,145408,3705856,247936,1413248,7646464,7777088,1751836,8473600,4629120,4630144,6542336,6548736,8381440,543040,552256,8121088,85,1741600,106496,6590464,288768,4629504,7645440,128,7734848,159040
.long 2228736,3692928,16777216,92160,16777216,235520,15,0,2048,16777216,709632,6626304,158976,10240,2410496,2390016,2451456,2430976,2461696,3418112,3438592,3459072,148480,3707392,297088,1433728,7646720,7777152,1772316,8458240,4630272,4630784,6583296,6589696,8386560,17310016,17334592,24939008,86,1762080,110592,6610944,288768,4630528,7645696,128,7734848,159104
.long 2233856,3693312,16777216,92928,198784,198656,9,0,2048,16777216,710144,6628864,159104,15360,2415616,2395136,2456576,2436096,2466816,3423232,3443712,3461120,150528,3708928,346240,1454208,7646976,7777216,1792796,8463360,4631040,4632064,6624256,6630656,8391680,17310016,17334592,24939008,87,1782560,114688,6631424,288768,4631552,7645952,128,7734848,159168
.long 2535936,3715968,97408,90112,232064,233472,15,0,2048,718464,716800,7276544,158720,0,2400256,2379776,2441216,2420736,2471936,3428352,3448832,3464192,143360,3704320,199552,1884288,7707648,7792384,2386716,8468480,4644736,4645248,7156736,7163136,8376320,538240,547456,8325632,116,2376480,102400,7225344,288768,4644864,7706624,128,7734848,158976
.long 2541056,3716352,16777216,91136,126720,124928,15,0,2048,16777216,717312,7279104,158848,5120,2405376,2384896,2446336,2425856,2477056,3433472,3453952,3466240,145408,3705856,248704,1904768,7707904,7792448,2407196,8473600,4645504,4646528,7197696,7204096,8381440,543360,552576,8325888,117,2396960,106496,7245824,288768,4645888,7706880,128,7734848,159040
.long 2638336,3723648,16777216,92160,16777216,235520,15,0,2048,16777216,717824,7281664,158976,10240,2410496,2390016,2451456,2430976,2461696,3418112,3438592,3459072,148480,3707392,297856,1925248,7708160,7792512,2427676,8458240,4646656,4647168,7238656,7245056,8386560,17310336,17334912,25143808,118,2417440,110592,7266304,288768,4646912,7707136,128,7734848,159104
.long 2643456,3724032,16777216,92928,211072,210944,9,0,2048,16777216,718336,7284224,159104,15360,2415616,2395136,2456576,2436096,2466816,3423232,3443712,3461120,150528,3708928,347008,1945728,7708416,7792576,2448156,8463360,4647424,4648448,7279616,7286016,8391680,17310336,17334912,25143808,119,2437920,114688,7286784,288768,4647936,7707392,128,7734848,159168
.long 1061376,3605376,68224,77824,240384,237568,15,8192,0,692992,692224,5238784,158720,0,1703936,1724416,1662976,1683456,1744896,3080192,3059712,3100672,143360,3650560,393472,164096,7493632,7738880,328796,8560640,4136832,4137344,5183488,5195264,8478720,564160,573376,8535040,16,328640,102400,5177344,274432,4136960,7491584,256,7735168,158720
.long 1066496,3605760,16777216,78848,110848,110592,15,8192,0,16777216,692736,5241344,158848,5120,1709056,1729536,1668096,1688576,1750016,3085312,3064832,3102720,145408,3652096,442624,184576,7493888,7738944,349276,8565760,4137600,4138624,5224448,5236224,8483840,569280,578496,8535296,17,349120,106496,5197824,274432,4137984,7491840,256,7735168,158784
.long 1163776,3613056,16777216,79872,16777216,239616,15,8192,0,16777216,693248,5243904,158976,10240,1714176,1734656,1673216,1693696,1755136,3090432,3069952,3105792,148480,3653632,491776,205056,7494144,7739008,369756,8570880,4138752,4139264,5265408,5277184,8488960,584640,609216,8571648,18,369600,110592,5218304,274432,4139008,7492096,256,7735168,158848
.long 1168896,3613440,16777216,80640,168192,167936,9,8192,0,16777216,693760,5246464,159104,15360,1719296,1739776,1678336,1698816,1760256,3095552,3075072,3107840,150528,3655168,540928,225536,7494400,7739072,390236,8576000,4139520,4140544,5306368,5318144,8494080,17361856,17386432,25348864,19,390080,114688,5238784,274432,4140032,7492352,256,7735168,158912
.long 1470976,3636096,76416,77824,215808,237568,15,8192,0,701184,700416,5894144,158720,0,1703936,1724416,1662976,1683456,1744896,3080192,3059712,3100672,143360,3650560,394240,655616,7555072,7754240,984156,8560640,4153216,4153728,5838848,5850624,8478720,563200,572416,7920640,48,984000,102400,5832704,274432,4153344,7553024,256,7735168,158720
.long 1476096,3636480,16777216,78848,111360,110592,15,8192,0,16777216,700928,5896704,158848,5120,1709056,1729536,1668096,1688576,1750016,3085312,3064832,3102720,145408,3652096,443392,676096,7555328,7754304,1004636,8565760,4153984,4155008,5879808,5891584,8483840,568320,577536,7920896,49,1004480,106496,5853184,274432,4154368,7553280,256,7735168,158784
.long 1573376,3643776,16777216,79872,16777216,239616,15,8192,0,16777216,701440,5899264,158976,10240,1714176,1734656,1673216,1693696,1755136,3090432,3069952,3105792,148480,3653632,492544,696576,7555584,7754368,1025116,8570880,4155136,4155648,5920768,5932544,8488960,583680,608256,7957248,50,1024960,110592,5873664,274432,4155392,7553536,256,7735168,158848
.long 1578496,3644160,16777216,80640,180480,180224,9,8192,0,16777216,701952,5901824,159104,15360,1719296,1739776,1678336,1698816,1760256,3095552,3075072,3107840,150528,3655168,541696,717056,7555840,7754432,1045596,8576000,4155904,4156928,5961728,5973504,8494080,17360896,17385472,24734464,51,1045440,114688,5894144,274432,4156416,7553792,256,7735168,158912
.long 1112576,3609216,68864,77824,224000,237568,15,8192,0,709376,708608,6549504,158720,0,1703936,1724416,1662976,1683456,1744896,3080192,3059712,3100672,143360,3650560,395008,1147136,7616512,7769600,1639516,8560640,4169600,4170112,6494208,6505984,8478720,563520,572736,8125440,80,1639360,102400,6488064,274432,4169728,7614464,256,7735168,158720
.long 1117696,3609600,16777216,78848,111872,110592,15,8192,0,16777216,709120,6552064,158848,5120,1709056,1729536,1668096,1688576,1750016,3085312,3064832,3102720,145408,3652096,444160,1167616,7616768,7769664,1659996,8565760,4170368,4171392,6535168,6546944,8483840,568640,577856,8125696,81,1659840,106496,6508544,274432,4170752,7614720,256,7735168,158784
.long 1214976,3616896,16777216,79872,16777216,239616,15,8192,0,16777216,709632,6554624,158976,10240,1714176,1734656,1673216,1693696,1755136,3090432,3069952,3105792,148480,3653632,493312,1188096,7617024,7769728,1680476,8570880,4171520,4172032,6576128,6587904,8488960,584000,608576,8162048,82,1680320,110592,6529024,274432,4171776,7614976,256,7735168,158848
.long 1220096,3617280,16777216,80640,192768,192512,9,8192,0,16777216,710144,6557184,159104,15360,1719296,1739776,1678336,1698816,1760256,3095552,3075072,3107840,150528,3655168,542464,1208576,7617280,7769792,1700956,8576000,4172288,4173312,6617088,6628864,8494080,17361216,17385792,24939264,83,1700800,114688,6549504,274432,4172800,7615232,256,7735168,158912
.long 1522176,3639936,77056,77824,232192,237568,15,8192,0,717568,716800,7204864,158720,0,1703936,1724416,1662976,1683456,1744896,3080192,3059712,3100672,143360,3650560,395776,1638656,7677952,7784960,2294876,8560640,4185984,4186496,7149568,7161344,8478720,563840,573056,8330240,112,2294720,102400,7143424,274432,4186112,7675904,256,7735168,158720
.long 1527296,3640320,16777216,78848,112384,110592,15,8192,0,16777216,717312,7207424,158848,5120,1709056,1729536,1668096,1688576,1750016,3085312,3064832,3102720,145408,3652096,444928,1659136,7678208,7785024,2315356,8565760,4186752,4187776,7190528,7202304,8483840,568960,578176,8330496,113,2315200,106496,7163904,274432,4187136,7676160,256,7735168,158784
.long 1624576,3647616,16777216,79872,16777216,239616,15,8192,0,16777216,717824,7209984,158976,10240,1714176,1734656,1673216,1693696,1755136,3090432,3069952,3105792,148480,3653632,494080,1679616,7678464,7785088,2335836,8570880,4187904,4188416,7231488,7243264,8488960,584320,608896,8366848,114,2335680,110592,7184384,274432,4188160,7676416,256,7735168,158848
.long 1629696,3648000,16777216,80640,205056,204800,9,8192,0,16777216,718336,7212544,159104,15360,1719296,1739776,1678336,1698816,1760256,3095552,3075072,3107840,150528,3655168,543232,1700096,7678720,7785152,2356316,8576000,4188672,4189696,7272448,7284224,8494080,17361536,17386112,25144064,115,2356160,114688,7204864,274432,4189184,7676672,256,7735168,158912
.long 1880576,3666816,84608,94208,244480,237568,15,0,2048,694016,692224,5320704,158720,0,2523136,2543616,2482176,2502656,2564096,3489792,3469312,3510272,143360,3712000,393856,409856,7524352,7746560,410716,8570880,4661120,4661632,5191680,5197312,8478720,564320,573536,8637440,20,410560,102400,5259264,290816,4661248,7522304,256,7735168,158976
.long 1885696,3667200,16777216,95232,127232,126976,15,0,2048,16777216,692736,5323264,158848,5120,2528256,2548736,2487296,2507776,2569216,3494912,3474432,3512320,145408,3713536,443008,430336,7524608,7746624,431196,8576000,4661888,4662912,5232640,5238272,8483840,569440,578656,8637696,21,431040,106496,5279744,290816,4662272,7522560,256,7735168,159040
.long 1982976,3674496,16777216,96256,16777216,239616,15,0,2048,16777216,693248,5325824,158976,10240,2533376,2553856,2492416,2512896,2574336,3500032,3479552,3515392,148480,3715072,492160,450816,7524864,7746688,451676,8560640,4663040,4663552,5273600,5279232,8488960,584800,609376,8674048,22,451520,110592,5300224,290816,4663296,7522816,256,7735168,159104
.long 1988096,3674880,16777216,97024,174336,174080,9,0,2048,16777216,693760,5328384,159104,15360,2538496,2558976,2497536,2518016,2579456,3505152,3484672,3517440,150528,3716608,541312,471296,7525120,7746752,472156,8565760,4663808,4664832,5314560,5320192,8494080,17362016,17386592,25451264,23,472000,114688,5320704,290816,4664320,7523072,256,7735168,159168
.long 2290176,3697536,92800,94208,219904,237568,15,0,2048,702208,700416,5976064,158720,0,2523136,2543616,2482176,2502656,2564096,3489792,3469312,3510272,143360,3712000,394624,901376,7585792,7761920,1066076,8570880,4677504,4678016,5847040,5852672,8478720,563360,572576,8023040,52,1065920,102400,5914624,290816,4677632,7583744,256,7735168,158976
.long 2295296,3697920,16777216,95232,127744,126976,15,0,2048,16777216,700928,5978624,158848,5120,2528256,2548736,2487296,2507776,2569216,3494912,3474432,3512320,145408,3713536,443776,921856,7586048,7761984,1086556,8576000,4678272,4679296,5888000,5893632,8483840,568480,577696,8023296,53,1086400,106496,5935104,290816,4678656,7584000,256,7735168,159040
.long 2392576,3705216,16777216,96256,16777216,239616,15,0,2048,16777216,701440,5981184,158976,10240,2533376,2553856,2492416,2512896,2574336,3500032,3479552,3515392,148480,3715072,492928,942336,7586304,7762048,1107036,8560640,4679424,4679936,5928960,5934592,8488960,583840,608416,8059648,54,1106880,110592,5955584,290816,4679680,7584256,256,7735168,159104
.long 2397696,3705600,16777216,97024,186624,186368,9,0,2048,16777216,701952,5983744,159104,15360,2538496,2558976,2497536,2518016,2579456,3505152,3484672,3517440,150528,3716608,542080,962816,7586560,7762112,1127516,8565760,4680192,4681216,5969920,5975552,8494080,17361056,17385632,24836864,55,1127360,114688,5976064,290816,4680704,7584512,256,7735168,159168
.long 1931776,3670656,85248,94208,228096,237568,15,0,2048,710400,708608,6631424,158720,0,2523136,2543616,2482176,2502656,2564096,3489792,3469312,3510272,143360,3712000,395392,1392896,7647232,7777280,1721436,8570880,4693888,4694400,6502400,6508032,8478720,563680,572896,8227840,84,1721280,102400,6569984,290816,4694016,7645184,256,7735168,158976
.long 1936896,3671040,16777216,95232,128256,126976,15,0,2048,16777216,709120,6633984,158848,5120,2528256,2548736,2487296,2507776,2569216,3494912,3474432,3512320,145408,3713536,444544,1413376,7647488,7777344,1741916,8576000,4694656,4695680,6543360,6548992,8483840,568800,578016,8228096,85,1741760,106496,6590464,290816,4695040,7645440,256,7735168,159040
.long 2034176,3678336,16777216,96256,16777216,239616,15,0,2048,16777216,709632,6636544,158976,10240,2533376,2553856,2492416,2512896,2574336,3500032,3479552,3515392,148480,3715072,493696,1433856,7647744,7777408,1762396,8560640,4695808,4696320,6584320,6589952,8488960,584160,608736,8264448,86,1762240,110592,6610944,290816,4696064,7645696,256,7735168,159104
.long 2039296,3678720,16777216,97024,198912,198656,9,0,2048,16777216,710144,6639104,159104,15360,2538496,2558976,2497536,2518016,2579456,3505152,3484672,3517440,150528,3716608,542848,1454336,7648000,7777472,1782876,8565760,4696576,4697600,6625280,6630912,8494080,17361376,17385952,25041664,87,1782720,114688,6631424,290816,4697088,7645952,256,7735168,159168
.long 2341376,3701376,93440,94208,236288,237568,15,0,2048,718592,716800,7286784,158720,0,2523136,2543616,2482176,2502656,2564096,3489792,3469312,3510272,143360,3712000,396160,1884416,7708672,7792640,2376796,8570880,4710272,4710784,7157760,7163392,8478720,564000,573216,8432640,116,2376640,102400,7225344,290816,4710400,7706624,256,7735168,158976
.long 2346496,3701760,16777216,95232,128768,126976,15,0,2048,16777216,717312,7289344,158848,5120,2528256,2548736,2487296,2507776,2569216,3494912,3474432,3512320,145408,3713536,445312,1904896,7708928,7792704,2397276,8576000,4711040,4712064,7198720,7204352,8483840,569120,578336,8432896,117,2397120,106496,7245824,290816,4711424,7706880,256,7735168,159040
.long 2443776,3709056,16777216,96256,16777216,239616,15,0,2048,16777216,717824,7291904,158976,10240,2533376,2553856,2492416,2512896,2574336,3500032,3479552,3515392,148480,3715072,494464,1925376,7709184,7792768,2417756,8560640,4712192,4712704,7239680,7245312,8488960,584480,609056,8469248,118,2417600,110592,7266304,290816,4712448,7707136,256,7735168,159104
.long 2448896,3709440,16777216,97024,211200,210944,9,0,2048,16777216,718336,7294464,159104,15360,2538496,2558976,2497536,2518016,2579456,3505152,3484672,3517440,150528,3716608,543616,1945856,7709440,7792832,2438236,8565760,4712960,4713984,7280640,7286272,8494080,17361696,17386272,25246464,119,2438080,114688,7286784,290816,4713472,7707392,256,7735168,159168
.long 1266176,3620736,72320,77824,244608,241664,15,8192,0,693120,692224,5249024,158720,0,1826816,1806336,1785856,1765376,1857536,3141632,3121152,3156992,143360,3658240,590080,164224,7494656,7739136,339036,8663040,4202368,4202880,5184512,5195520,8581120,589920,599136,8637952,16,328800,102400,5177344,276480,4202496,7491584,384,7735488,158720
.long 1271296,3621120,16777216,78848,112896,112640,15,8192,0,16777216,692736,5251584,158848,5120,1831936,1811456,1790976,1770496,1862656,3146752,3126272,3159040,145408,3659776,639232,184704,7494912,7739200,359516,8668160,4203136,4204160,5225472,5236480,8586240,595040,604256,8638208,17,349280,106496,5197824,276480,4203520,7491840,384,7735488,158784
.long 1368576,3628416,16777216,79872,16777216,243712,15,8192,0,16777216,693248,5254144,158976,10240,1837056,1816576,1796096,1775616,1847296,3131392,3110912,3151872,148480,3661312,688384,205184,7495168,7739264,379996,8673280,4204288,4204800,5266432,5277440,8591360,17362016,17386592,25451264,18,369760,110592,5218304,276480,4204544,7492096,384,7735488,158848
.long 1373696,3628800,16777216,80640,168320,167936,9,8192,0,16777216,693760,5256704,159104,15360,1842176,1821696,1801216,1780736,1852416,3136512,3116032,3153920,150528,3662848,737536,225664,7495424,7739328,400476,8678400,4205056,4206080,5307392,5318400,8596480,17362016,17386592,25451264,19,390240,114688,5238784,276480,4205568,7492352,384,7735488,158912
.long 1675776,3651456,80512,77824,220032,241664,15,8192,0,701312,700416,5904384,158720,0,1826816,1806336,1785856,1765376,1857536,3141632,3121152,3156992,143360,3658240,590848,655744,7556096,7754496,994396,8663040,4218752,4219264,5839872,5850880,8581120,588960,598176,8023552,48,984160,102400,5832704,276480,4218880,7553024,384,7735488,158720
.long 1680896,3651840,16777216,78848,113408,112640,15,8192,0,16777216,700928,5906944,158848,5120,1831936,1811456,1790976,1770496,1862656,3146752,3126272,3159040,145408,3659776,640000,676224,7556352,7754560,1014876,8668160,4219520,4220544,5880832,5891840,8586240,594080,603296,8023808,49,1004640,106496,5853184,276480,4219904,7553280,384,7735488,158784
.long 1778176,3659136,16777216,79872,16777216,243712,15,8192,0,16777216,701440,5909504,158976,10240,1837056,1816576,1796096,1775616,1847296,3131392,3110912,3151872,148480,3661312,689152,696704,7556608,7754624,1035356,8673280,4220672,4221184,5921792,5932800,8591360,17361056,17385632,24836864,50,1025120,110592,5873664,276480,4220928,7553536,384,7735488,158848
.long 1783296,3659520,16777216,80640,180608,180224,9,8192,0,16777216,701952,5912064,159104,15360,1842176,1821696,1801216,1780736,1852416,3136512,3116032,3153920,150528,3662848,738304,717184,7556864,7754688,1055836,8678400,4221440,4222464,5962752,5973760,8596480,17361056,17385632,24836864,51,1045600,114688,5894144,276480,4221952,7553792,384,7735488,158912
.long 1317376,3624576,72960,77824,228224,241664,15,8192,0,709504,708608,6559744,158720,0,1826816,1806336,1785856,1765376,1857536,3141632,3121152,3156992,143360,3658240,591616,1147264,7617536,7769856,1649756,8663040,4235136,4235648,6495232,6506240,8581120,589280,598496,8228352,80,1639520,102400,6488064,276480,4235264,7614464,384,7735488,158720
.long 1322496,3624960,16777216,78848,113920,112640,15,8192,0,16777216,709120,6562304,158848,5120,1831936,1811456,1790976,1770496,1862656,3146752,3126272,3159040,145408,3659776,640768,1167744,7617792,7769920,1670236,8668160,4235904,4236928,6536192,6547200,8586240,594400,603616,8228608,81,1660000,106496,6508544,276480,4236288,7614720,384,7735488,158784
.long 1419776,3632256,16777216,79872,16777216,243712,15,8192,0,16777216,709632,6564864,158976,10240,1837056,1816576,1796096,1775616,1847296,3131392,3110912,3151872,148480,3661312,689920,1188224,7618048,7769984,1690716,8673280,4237056,4237568,6577152,6588160,8591360,17361376,17385952,25041664,82,1680480,110592,6529024,276480,4237312,7614976,384,7735488,158848
.long 1424896,3632640,16777216,80640,192896,192512,9,8192,0,16777216,710144,6567424,159104,15360,1842176,1821696,1801216,1780736,1852416,3136512,3116032,3153920,150528,3662848,739072,1208704,7618304,7770048,1711196,8678400,4237824,4238848,6618112,6629120,8596480,17361376,17385952,25041664,83,1700960,114688,6549504,276480,4238336,7615232,384,7735488,158912
.long 1726976,3655296,81152,77824,236416,241664,15,8192,0,717696,716800,7215104,158720,0,1826816,1806336,1785856,1765376,1857536,3141632,3121152,3156992,143360,3658240,592384,1638784,7678976,7785216,2305116,8663040,4251520,4252032,7150592,7161600,8581120,589600,598816,8433152,112,2294880,102400,7143424,276480,4251648,7675904,384,7735488,158720
.long 1732096,3655680,16777216,78848,114432,112640,15,8192,0,16777216,717312,7217664,158848,5120,1831936,1811456,1790976,1770496,1862656,3146752,3126272,3159040,145408,3659776,641536,1659264,7679232,7785280,2325596,8668160,4252288,4253312,7191552,7202560,8586240,594720,603936,8433408,113,2315360,106496,7163904,276480,4252672,7676160,384,7735488,158784
.long 1829376,3662976,16777216,79872,16777216,243712,15,8192,0,16777216,717824,7220224,158976,10240,1837056,1816576,1796096,1775616,1847296,3131392,3110912,3151872,148480,3661312,690688,1679744,7679488,7785344,2346076,8673280,4253440,4253952,7232512,7243520,8591360,17361696,17386272,25246464,114,2335840,110592,7184384,276480,4253696,7676416,384,7735488,158848
.long 1834496,3663360,16777216,80640,205184,204800,9,8192,0,16777216,718336,7222784,159104,15360,1842176,1821696,1801216,1780736,1852416,3136512,3116032,3153920,150528,3662848,739840,1700224,7679744,7785408,2366556,8678400,4254208,4255232,7273472,7284480,8596480,17361696,17386272,25246464,115,2356320,114688,7204864,276480,4254720,7676672,384,7735488,158912
.long 2085376,3682176,88704,94208,215936,241664,15,0,2048,694144,692224,5330944,158720,0,2646016,2625536,2605056,2584576,2676736,3551232,3530752,3566592,143360,3719680,590464,409984,7525376,7746816,420956,8673280,4726656,4727168,5192704,5197568,8581120,588800,598016,7921152,20,410720,102400,5259264,292864,4726784,7522304,384,7735488,158976
.long 2090496,3682560,16777216,95232,129280,129024,15,0,2048,16777216,692736,5333504,158848,5120,2651136,2630656,2610176,2589696,2681856,3556352,3535872,3568640,145408,3721216,639616,430464,7525632,7746880,441436,8678400,4727424,4728448,5233664,5238528,8586240,593920,603136,7921408,21,431200,106496,5279744,292864,4727808,7522560,384,7735488,159040
.long 2187776,3689856,16777216,96256,16777216,243712,15,0,2048,16777216,693248,5336064,158976,10240,2656256,2635776,2615296,2594816,2666496,3540992,3520512,3561472,148480,3722752,688768,450944,7525888,7746944,461916,8663040,4728576,4729088,5274624,5279488,8591360,17360896,17385472,24734464,22,451680,110592,5300224,292864,4728832,7522816,384,7735488,159104
.long 2192896,3690240,16777216,97024,174464,174080,9,0,2048,16777216,693760,5338624,159104,15360,2661376,2640896,2620416,2599936,2671616,3546112,3525632,3563520,150528,3724288,737920,471424,7526144,7747008,482396,8668160,4729344,4730368,5315584,5320448,8596480,17360896,17385472,24734464,23,472160,114688,5320704,292864,4729856,7523072,384,7735488,159168
.long 2494976,3712896,96896,94208,224128,241664,15,0,2048,702336,700416,5986304,158720,0,2646016,2625536,2605056,2584576,2676736,3551232,3530752,3566592,143360,3719680,591232,901504,7586816,7762176,1076316,8673280,4743040,4743552,5848064,5852928,8581120,589120,598336,8125952,52,1066080,102400,5914624,292864,4743168,7583744,384,7735488,158976
.long 2500096,3713280,16777216,95232,129792,129024,15,0,2048,16777216,700928,5988864,158848,5120,2651136,2630656,2610176,2589696,2681856,3556352,3535872,3568640,145408,3721216,640384,921984,7587072,7762240,1096796,8678400,4743808,4744832,5889024,5893888,8586240,594240,603456,8126208,53,1086560,106496,5935104,292864,4744192,7584000,384,7735488,159040
.long 2597376,3720576,16777216,96256,16777216,243712,15,0,2048,16777216,701440,5991424,158976,10240,2656256,2635776,2615296,2594816,2666496,3540992,3520512,3561472,148480,3722752,689536,942464,7587328,7762304,1117276,8663040,4744960,4745472,5929984,5934848,8591360,17361216,17385792,24939264,54,1107040,110592,5955584,292864,4745216,7584256,384,7735488,159104
.long 2602496,3720960,16777216,97024,186752,186368,9,0,2048,16777216,701952,5993984,159104,15360,2661376,2640896,2620416,2599936,2671616,3546112,3525632,3563520,150528,3724288,738688,962944,7587584,7762368,1137756,8668160,4745728,4746752,5970944,5975808,8596480,17361216,17385792,24939264,55,1127520,114688,5976064,292864,4746240,7584512,384,7735488,159168
.long 2136576,3686016,89344,94208,232320,241664,15,0,2048,710528,708608,6641664,158720,0,2646016,2625536,2605056,2584576,2676736,3551232,3530752,3566592,143360,3719680,592000,1393024,7648256,7777536,1731676,8673280,4759424,4759936,6503424,6508288,8581120,589440,598656,8330752,84,1721440,102400,6569984,292864,4759552,7645184,384,7735488,158976
.long 2141696,3686400,16777216,95232,130304,129024,15,0,2048,16777216,709120,6644224,158848,5120,2651136,2630656,2610176,2589696,2681856,3556352,3535872,3568640,145408,3721216,641152,1413504,7648512,7777600,1752156,8678400,4760192,4761216,6544384,6549248,8586240,594560,603776,8331008,85,1741920,106496,6590464,292864,4760576,7645440,384,7735488,159040
.long 2238976,3693696,16777216,96256,16777216,243712,15,0,2048,16777216,709632,6646784,158976,10240,2656256,2635776,2615296,2594816,2666496,3540992,3520512,3561472,148480,3722752,690304,1433984,7648768,7777664,1772636,8663040,4761344,4761856,6585344,6590208,8591360,17361536,17386112,25144064,86,1762400,110592,6610944,292864,4761600,7645696,384,7735488,159104
.long 2244096,3694080,16777216,97024,199040,198656,9,0,2048,16777216,710144,6649344,159104,15360,2661376,2640896,2620416,2599936,2671616,3546112,3525632,3563520,150528,3724288,739456,1454464,7649024,7777728,1793116,8668160,4762112,4763136,6626304,6631168,8596480,17361536,17386112,25144064,87,1782880,114688,6631424,292864,4762624,7645952,384,7735488,159168
.long 2546176,3716736,97536,94208,240512,241664,15,0,2048,718720,716800,7297024,158720,0,2646016,2625536,2605056,2584576,2676736,3551232,3530752,3566592,143360,3719680,592768,1884544,7709696,7792896,2387036,8673280,4775808,4776320,7158784,7163648,8581120,589760,598976,8535552,116,2376800,102400,7225344,292864,4775936,7706624,384,7735488,158976
.long 2551296,3717120,16777216,95232,130816,129024,15,0,2048,16777216,717312,7299584,158848,5120,2651136,2630656,2610176,2589696,2681856,3556352,3535872,3568640,145408,3721216,641920,1905024,7709952,7792960,2407516,8678400,4776576,4777600,7199744,7204608,8586240,594880,604096,8535808,117,2397280,106496,7245824,292864,4776960,7706880,384,7735488,159040
.long 2648576,3724416,16777216,96256,16777216,243712,15,0,2048,16777216,717824,7302144,158976,10240,2656256,2635776,2615296,2594816,2666496,3540992,3520512,3561472,148480,3722752,691072,1925504,7710208,7793024,2427996,8663040,4777728,4778240,7240704,7245568,8591360,17361856,17386432,25348864,118,2417760,110592,7266304,292864,4777984,7707136,384,7735488,159104
.long 2653696,3724800,16777216,97024,211328,210944,9,0,2048,16777216,718336,7304704,159104,15360,2661376,2640896,2620416,2599936,2671616,3546112,3525632,3563520,150528,3724288,740224,1945984,7710464,7793088,2448476,8668160,4778496,4779520,7281664,7286528,8596480,17361856,17386432,25348864,119,2438240,114688,7286784,292864,4779008,7707392,384,7735488,159168
.long 1071616,3606144,68352,65536,216064,212992,15,8192,0,694272,694272,5341184,158720,0,1048576,1069056,1089536,1110016,1130496,2752512,2772992,2793472,143360,3604480,786688,164352,7495680,7739392,491676,7946240,3747712,3748224,5341184,5357568,7864320,614400,623616,7925760,24,491520,102400,5341184,262144,3747840,7491584,512,7733248,158720
.long 1076736,3606528,16777216,66560,98688,98304,15,8192,0,16777216,694784,5343744,158848,5120,1053696,1074176,1094656,1115136,1135616,2757632,2778112,2795520,145408,3606016,835840,184832,7495936,7739456,512156,7951360,3748480,3749504,5382144,5398528,7869440,619520,628736,7926016,25,512000,106496,5361664,262144,3748864,7491840,512,7733248,158784
.long 1174016,3613824,16777216,67584,16777216,215040,15,8192,0,16777216,695296,5346304,158976,10240,1058816,1079296,1099776,1120256,1140736,2762752,2783232,2798592,148480,3607552,884992,205312,7496192,7739520,532636,7956480,3749632,3750144,5423104,5439488,7874560,634880,659456,7961600,26,532480,110592,5382144,262144,3749888,7492096,512,7733248,158848
.long 1179136,3614208,16777216,68352,168448,167936,9,8192,0,16777216,695808,5348864,159104,15360,1063936,1084416,1104896,1125376,1145856,2767872,2788352,2800640,150528,3609088,934144,225792,7496448,7739584,553116,7961600,3750400,3751424,5464064,5480448,7879680,17412096,17436672,24738816,27,552960,114688,5402624,262144,3750912,7492352,512,7733248,158912
.long 1481216,3636864,76544,65536,224256,212992,15,8192,0,702464,702464,5996544,158720,0,1048576,1069056,1089536,1110016,1130496,2752512,2772992,2793472,143360,3604480,787456,655872,7557120,7754752,1147036,7946240,3764096,3764608,5996544,6012928,7864320,614720,623936,8130560,56,1146880,102400,5996544,262144,3764224,7553024,512,7733248,158720
.long 1486336,3637248,16777216,66560,99200,98304,15,8192,0,16777216,702976,5999104,158848,5120,1053696,1074176,1094656,1115136,1135616,2757632,2778112,2795520,145408,3606016,836608,676352,7557376,7754816,1167516,7951360,3764864,3765888,6037504,6053888,7869440,619840,629056,8130816,57,1167360,106496,6017024,262144,3765248,7553280,512,7733248,158784
.long 1583616,3644544,16777216,67584,16777216,215040,15,8192,0,16777216,703488,6001664,158976,10240,1058816,1079296,1099776,1120256,1140736,2762752,2783232,2798592,148480,3607552,885760,696832,7557632,7754880,1187996,7956480,3766016,3766528,6078464,6094848,7874560,635200,659776,8166400,58,1187840,110592,6037504,262144,3766272,7553536,512,7733248,158848
.long 1588736,3644928,16777216,68352,180736,180224,9,8192,0,16777216,704000,6004224,159104,15360,1063936,1084416,1104896,1125376,1145856,2767872,2788352,2800640,150528,3609088,934912,717312,7557888,7754944,1208476,7961600,3766784,3767808,6119424,6135808,7879680,17412416,17436992,24943616,59,1208320,114688,6057984,262144,3767296,7553792,512,7733248,158912
.long 1122816,3609984,68992,65536,232448,212992,15,8192,0,710656,710656,6651904,158720,0,1048576,1069056,1089536,1110016,1130496,2752512,2772992,2793472,143360,3604480,788224,1147392,7618560,7770112,1802396,7946240,3780480,3780992,6651904,6668288,7864320,615040,624256,8335360,88,1802240,102400,6651904,262144,3780608,7614464,512,7733248,158720
.long 1127936,3610368,16777216,66560,99712,98304,15,8192,0,16777216,711168,6654464,158848,5120,1053696,1074176,1094656,1115136,1135616,2757632,2778112,2795520,145408,3606016,837376,1167872,7618816,7770176,1822876,7951360,3781248,3782272,6692864,6709248,7869440,620160,629376,8335616,89,1822720,106496,6672384,262144,3781632,7614720,512,7733248,158784
.long 1225216,3617664,16777216,67584,16777216,215040,15,8192,0,16777216,711680,6657024,158976,10240,1058816,1079296,1099776,1120256,1140736,2762752,2783232,2798592,148480,3607552,886528,1188352,7619072,7770240,1843356,7956480,3782400,3782912,6733824,6750208,7874560,635520,660096,8371200,90,1843200,110592,6692864,262144,3782656,7614976,512,7733248,158848
.long 1230336,3618048,16777216,68352,193024,192512,9,8192,0,16777216,712192,6659584,159104,15360,1063936,1084416,1104896,1125376,1145856,2767872,2788352,2800640,150528,3609088,935680,1208832,7619328,7770304,1863836,7961600,3783168,3784192,6774784,6791168,7879680,17412736,17437312,25148416,91,1863680,114688,6713344,262144,3783680,7615232,512,7733248,158912
.long 1532416,3640704,77184,65536,240640,212992,15,8192,0,718848,718848,7307264,158720,0,1048576,1069056,1089536,1110016,1130496,2752512,2772992,2793472,143360,3604480,788992,1638912,7680000,7785472,2457756,7946240,3796864,3797376,7307264,7323648,7864320,615360,624576,8540160,120,2457600,102400,7307264,262144,3796992,7675904,512,7733248,158720
.long 1537536,3641088,16777216,66560,100224,98304,15,8192,0,16777216,719360,7309824,158848,5120,1053696,1074176,1094656,1115136,1135616,2757632,2778112,2795520,145408,3606016,838144,1659392,7680256,7785536,2478236,7951360,3797632,3798656,7348224,7364608,7869440,620480,629696,8540416,121,2478080,106496,7327744,262144,3798016,7676160,512,7733248,158784
.long 1634816,3648384,16777216,67584,16777216,215040,15,8192,0,16777216,719872,7312384,158976,10240,1058816,1079296,1099776,1120256,1140736,2762752,2783232,2798592,148480,3607552,887296,1679872,7680512,7785600,2498716,7956480,3798784,3799296,7389184,7405568,7874560,635840,660416,8576000,122,2498560,110592,7348224,262144,3799040,7676416,512,7733248,158848
.long 1639936,3648768,16777216,68352,205312,204800,9,8192,0,16777216,720384,7314944,159104,15360,1063936,1084416,1104896,1125376,1145856,2767872,2788352,2800640,150528,3609088,936448,1700352,7680768,7785664,2519196,7961600,3799552,3800576,7430144,7446528,7879680,17413056,17437632,25353216,123,2519040,114688,7368704,262144,3800064,7676672,512,7733248,158912
.long 1890816,3667584,84736,81920,220160,212992,15,0,2048,695296,694272,5423104,158720,0,1867776,1888256,1908736,1929216,1949696,3162112,3182592,3203072,143360,3665920,787072,410112,7526400,7747072,573596,7956480,4272000,4272512,5349376,5359616,7864320,614560,623776,8028160,28,573440,102400,5423104,278528,4272128,7522304,512,7733248,158976
.long 1895936,3667968,16777216,82944,115072,114688,15,0,2048,16777216,694784,5425664,158848,5120,1872896,1893376,1913856,1934336,1954816,3167232,3187712,3205120,145408,3667456,836224,430592,7526656,7747136,594076,7961600,4272768,4273792,5390336,5400576,7869440,619680,628896,8028416,29,593920,106496,5443584,278528,4273152,7522560,512,7733248,159040
.long 1993216,3675264,16777216,83968,16777216,215040,15,0,2048,16777216,695296,5428224,158976,10240,1878016,1898496,1918976,1939456,1959936,3172352,3192832,3208192,148480,3668992,885376,451072,7526912,7747200,614556,7946240,4273920,4274432,5431296,5441536,7874560,635040,659616,8064000,30,614400,110592,5464064,278528,4274176,7522816,512,7733248,159104
.long 1998336,3675648,16777216,84736,174592,174080,9,0,2048,16777216,695808,5430784,159104,15360,1883136,1903616,1924096,1944576,1965056,3177472,3197952,3210240,150528,3670528,934528,471552,7527168,7747264,635036,7951360,4274688,4275712,5472256,5482496,7879680,17412256,17436832,24841216,31,634880,114688,5484544,278528,4275200,7523072,512,7733248,159168
.long 2300416,3698304,92928,81920,228352,212992,15,0,2048,703488,702464,6078464,158720,0,1867776,1888256,1908736,1929216,1949696,3162112,3182592,3203072,143360,3665920,787840,901632,7587840,7762432,1228956,7956480,4288384,4288896,6004736,6014976,7864320,614880,624096,8232960,60,1228800,102400,6078464,278528,4288512,7583744,512,7733248,158976
.long 2305536,3698688,16777216,82944,115584,114688,15,0,2048,16777216,702976,6081024,158848,5120,1872896,1893376,1913856,1934336,1954816,3167232,3187712,3205120,145408,3667456,836992,922112,7588096,7762496,1249436,7961600,4289152,4290176,6045696,6055936,7869440,620000,629216,8233216,61,1249280,106496,6098944,278528,4289536,7584000,512,7733248,159040
.long 2402816,3705984,16777216,83968,16777216,215040,15,0,2048,16777216,703488,6083584,158976,10240,1878016,1898496,1918976,1939456,1959936,3172352,3192832,3208192,148480,3668992,886144,942592,7588352,7762560,1269916,7946240,4290304,4290816,6086656,6096896,7874560,635360,659936,8268800,62,1269760,110592,6119424,278528,4290560,7584256,512,7733248,159104
.long 2407936,3706368,16777216,84736,186880,186368,9,0,2048,16777216,704000,6086144,159104,15360,1883136,1903616,1924096,1944576,1965056,3177472,3197952,3210240,150528,3670528,935296,963072,7588608,7762624,1290396,7951360,4291072,4292096,6127616,6137856,7879680,17412576,17437152,25046016,63,1290240,114688,6139904,278528,4291584,7584512,512,7733248,159168
.long 1942016,3671424,85376,81920,236544,212992,15,0,2048,711680,710656,6733824,158720,0,1867776,1888256,1908736,1929216,1949696,3162112,3182592,3203072,143360,3665920,788608,1393152,7649280,7777792,1884316,7956480,4304768,4305280,6660096,6670336,7864320,615200,624416,8437760,92,1884160,102400,6733824,278528,4304896,7645184,512,7733248,158976
.long 1947136,3671808,16777216,82944,116096,114688,15,0,2048,16777216,711168,6736384,158848,5120,1872896,1893376,1913856,1934336,1954816,3167232,3187712,3205120,145408,3667456,837760,1413632,7649536,7777856,1904796,7961600,4305536,4306560,6701056,6711296,7869440,620320,629536,8438016,93,1904640,106496,6754304,278528,4305920,7645440,512,7733248,159040
.long 2044416,3679104,16777216,83968,16777216,215040,15,0,2048,16777216,711680,6738944,158976,10240,1878016,1898496,1918976,1939456,1959936,3172352,3192832,3208192,148480,3668992,886912,1434112,7649792,7777920,1925276,7946240,4306688,4307200,6742016,6752256,7874560,635680,660256,8473600,94,1925120,110592,6774784,278528,4306944,7645696,512,7733248,159104
.long 2049536,3679488,16777216,84736,199168,198656,9,0,2048,16777216,712192,6741504,159104,15360,1883136,1903616,1924096,1944576,1965056,3177472,3197952,3210240,150528,3670528,936064,1454592,7650048,7777984,1945756,7951360,4307456,4308480,6782976,6793216,7879680,17412896,17437472,25250816,95,1945600,114688,6795264,278528,4307968,7645952,512,7733248,159168
.long 2351616,3702144,93568,81920,244736,212992,15,0,2048,719872,718848,7389184,158720,0,1867776,1888256,1908736,1929216,1949696,3162112,3182592,3203072,143360,3665920,789376,1884672,7710720,7793152,2539676,7956480,4321152,4321664,7315456,7325696,7864320,615520,624736,8642560,124,2539520,102400,7389184,278528,4321280,7706624,512,7733248,158976
.long 2356736,3702528,16777216,82944,116608,114688,15,0,2048,16777216,719360,7391744,158848,5120,1872896,1893376,1913856,1934336,1954816,3167232,3187712,3205120,145408,3667456,838528,1905152,7710976,7793216,2560156,7961600,4321920,4322944,7356416,7366656,7869440,620640,629856,8642816,125,2560000,106496,7409664,278528,4322304,7706880,512,7733248,159040
.long 2454016,3709824,16777216,83968,16777216,215040,15,0,2048,16777216,719872,7394304,158976,10240,1878016,1898496,1918976,1939456,1959936,3172352,3192832,3208192,148480,3668992,887680,1925632,7711232,7793280,2580636,7946240,4323072,4323584,7397376,7407616,7874560,636000,660576,8678400,126,2580480,110592,7430144,278528,4323328,7707136,512,7733248,159104
.long 2459136,3710208,16777216,84736,211456,210944,9,0,2048,16777216,720384,7396864,159104,15360,1883136,1903616,1924096,1944576,1965056,3177472,3197952,3210240,150528,3670528,936832,1946112,7711488,7793344,2601116,7951360,4323840,4324864,7438336,7448576,7879680,17413216,17437792,25455616,127,2600960,114688,7450624,278528,4324352,7707392,512,7733248,159168
.long 1276416,3621504,72448,65536,220288,217088,15,8192,0,694400,694272,5351424,158720,0,1171456,1150976,1212416,1191936,1243136,2813952,2834432,2849792,143360,3612160,983296,164480,7496704,7739648,501916,8048640,3813248,3813760,5342208,5357824,7966720,640160,649376,8028672,24,491680,102400,5341184,264192,3813376,7491584,640,7733568,158720
.long 1281536,3621888,16777216,66560,100736,100352,15,8192,0,16777216,694784,5353984,158848,5120,1176576,1156096,1217536,1197056,1248256,2819072,2839552,2851840,145408,3613696,1032448,184960,7496960,7739712,522396,8053760,3814016,3815040,5383168,5398784,7971840,645280,654496,8028928,25,512160,106496,5361664,264192,3814400,7491840,640,7733568,158784
.long 1378816,3629184,16777216,67584,16777216,219136,15,8192,0,16777216,695296,5356544,158976,10240,1181696,1161216,1222656,1202176,1232896,2803712,2824192,2844672,148480,3615232,1081600,205440,7497216,7739776,542876,8058880,3815168,3815680,5424128,5439744,7976960,17412256,17436832,24841216,26,532640,110592,5382144,264192,3815424,7492096,640,7733568,158848
.long 1383936,3629568,16777216,68352,168576,167936,9,8192,0,16777216,695808,5359104,159104,15360,1186816,1166336,1227776,1207296,1238016,2808832,2829312,2846720,150528,3616768,1130752,225920,7497472,7739840,563356,8064000,3815936,3816960,5465088,5480704,7982080,17412256,17436832,24841216,27,553120,114688,5402624,264192,3816448,7492352,640,7733568,158912
.long 1686016,3652224,80640,65536,228480,217088,15,8192,0,702592,702464,6006784,158720,0,1171456,1150976,1212416,1191936,1243136,2813952,2834432,2849792,143360,3612160,984064,656000,7558144,7755008,1157276,8048640,3829632,3830144,5997568,6013184,7966720,640480,649696,8233472,56,1147040,102400,5996544,264192,3829760,7553024,640,7733568,158720
.long 1691136,3652608,16777216,66560,101248,100352,15,8192,0,16777216,702976,6009344,158848,5120,1176576,1156096,1217536,1197056,1248256,2819072,2839552,2851840,145408,3613696,1033216,676480,7558400,7755072,1177756,8053760,3830400,3831424,6038528,6054144,7971840,645600,654816,8233728,57,1167520,106496,6017024,264192,3830784,7553280,640,7733568,158784
.long 1788416,3659904,16777216,67584,16777216,219136,15,8192,0,16777216,703488,6011904,158976,10240,1181696,1161216,1222656,1202176,1232896,2803712,2824192,2844672,148480,3615232,1082368,696960,7558656,7755136,1198236,8058880,3831552,3832064,6079488,6095104,7976960,17412576,17437152,25046016,58,1188000,110592,6037504,264192,3831808,7553536,640,7733568,158848
.long 1793536,3660288,16777216,68352,180864,180224,9,8192,0,16777216,704000,6014464,159104,15360,1186816,1166336,1227776,1207296,1238016,2808832,2829312,2846720,150528,3616768,1131520,717440,7558912,7755200,1218716,8064000,3832320,3833344,6120448,6136064,7982080,17412576,17437152,25046016,59,1208480,114688,6057984,264192,3832832,7553792,640,7733568,158912
.long 1327616,3625344,73088,65536,236672,217088,15,8192,0,710784,710656,6662144,158720,0,1171456,1150976,1212416,1191936,1243136,2813952,2834432,2849792,143360,3612160,984832,1147520,7619584,7770368,1812636,8048640,3846016,3846528,6652928,6668544,7966720,640800,650016,8438272,88,1802400,102400,6651904,264192,3846144,7614464,640,7733568,158720
.long 1332736,3625728,16777216,66560,101760,100352,15,8192,0,16777216,711168,6664704,158848,5120,1176576,1156096,1217536,1197056,1248256,2819072,2839552,2851840,145408,3613696,1033984,1168000,7619840,7770432,1833116,8053760,3846784,3847808,6693888,6709504,7971840,645920,655136,8438528,89,1822880,106496,6672384,264192,3847168,7614720,640,7733568,158784
.long 1430016,3633024,16777216,67584,16777216,219136,15,8192,0,16777216,711680,6667264,158976,10240,1181696,1161216,1222656,1202176,1232896,2803712,2824192,2844672,148480,3615232,1083136,1188480,7620096,7770496,1853596,8058880,3847936,3848448,6734848,6750464,7976960,17412896,17437472,25250816,90,1843360,110592,6692864,264192,3848192,7614976,640,7733568,158848
.long 1435136,3633408,16777216,68352,193152,192512,9,8192,0,16777216,712192,6669824,159104,15360,1186816,1166336,1227776,1207296,1238016,2808832,2829312,2846720,150528,3616768,1132288,1208960,7620352,7770560,1874076,8064000,3848704,3849728,6775808,6791424,7982080,17412896,17437472,25250816,91,1863840,114688,6713344,264192,3849216,7615232,640,7733568,158912
.long 1737216,3656064,81280,65536,244864,217088,15,8192,0,718976,718848,7317504,158720,0,1171456,1150976,1212416,1191936,1243136,2813952,2834432,2849792,143360,3612160,985600,1639040,7681024,7785728,2467996,8048640,3862400,3862912,7308288,7323904,7966720,641120,650336,8643072,120,2457760,102400,7307264,264192,3862528,7675904,640,7733568,158720
.long 1742336,3656448,16777216,66560,102272,100352,15,8192,0,16777216,719360,7320064,158848,5120,1176576,1156096,1217536,1197056,1248256,2819072,2839552,2851840,145408,3613696,1034752,1659520,7681280,7785792,2488476,8053760,3863168,3864192,7349248,7364864,7971840,646240,655456,8643328,121,2478240,106496,7327744,264192,3863552,7676160,640,7733568,158784
.long 1839616,3663744,16777216,67584,16777216,219136,15,8192,0,16777216,719872,7322624,158976,10240,1181696,1161216,1222656,1202176,1232896,2803712,2824192,2844672,148480,3615232,1083904,1680000,7681536,7785856,2508956,8058880,3864320,3864832,7390208,7405824,7976960,17413216,17437792,25455616,122,2498720,110592,7348224,264192,3864576,7676416,640,7733568,158848
.long 1844736,3664128,16777216,68352,205440,204800,9,8192,0,16777216,720384,7325184,159104,15360,1186816,1166336,1227776,1207296,1238016,2808832,2829312,2846720,150528,3616768,1133056,1700480,7681792,7785920,2529436,8064000,3865088,3866112,7431168,7446784,7982080,17413216,17437792,25455616,123,2519200,114688,7368704,264192,3865600,7676672,640,7733568,158912
.long 2095616,3682944,88832,81920,224384,217088,15,0,2048,695424,694272,5433344,158720,0,1990656,1970176,2031616,2011136,2062336,3223552,3244032,3259392,143360,3673600,983680,410240,7527424,7747328,583836,8058880,4337536,4338048,5350400,5359872,7966720,640320,649536,8131072,28,573600,102400,5423104,280576,4337664,7522304,640,7733568,158976
.long 2100736,3683328,16777216,82944,117120,116736,15,0,2048,16777216,694784,5435904,158848,5120,1995776,1975296,2036736,2016256,2067456,3228672,3249152,3261440,145408,3675136,1032832,430720,7527680,7747392,604316,8064000,4338304,4339328,5391360,5400832,7971840,645440,654656,8131328,29,594080,106496,5443584,280576,4338688,7522560,640,7733568,159040
.long 2198016,3690624,16777216,83968,16777216,219136,15,0,2048,16777216,695296,5438464,158976,10240,2000896,1980416,2041856,2021376,2052096,3213312,3233792,3254272,148480,3676672,1081984,451200,7527936,7747456,624796,8048640,4339456,4339968,5432320,5441792,7976960,17412416,17436992,24943616,30,614560,110592,5464064,280576,4339712,7522816,640,7733568,159104
.long 2203136,3691008,16777216,84736,174720,174080,9,0,2048,16777216,695808,5441024,159104,15360,2006016,1985536,2046976,2026496,2057216,3218432,3238912,3256320,150528,3678208,1131136,471680,7528192,7747520,645276,8053760,4340224,4341248,5473280,5482752,7982080,17412416,17436992,24943616,31,635040,114688,5484544,280576,4340736,7523072,640,7733568,159168
.long 2505216,3713664,97024,81920,232576,217088,15,0,2048,703616,702464,6088704,158720,0,1990656,1970176,2031616,2011136,2062336,3223552,3244032,3259392,143360,3673600,984448,901760,7588864,7762688,1239196,8058880,4353920,4354432,6005760,6015232,7966720,640640,649856,8335872,60,1228960,102400,6078464,280576,4354048,7583744,640,7733568,158976
.long 2510336,3714048,16777216,82944,117632,116736,15,0,2048,16777216,702976,6091264,158848,5120,1995776,1975296,2036736,2016256,2067456,3228672,3249152,3261440,145408,3675136,1033600,922240,7589120,7762752,1259676,8064000,4354688,4355712,6046720,6056192,7971840,645760,654976,8336128,61,1249440,106496,6098944,280576,4355072,7584000,640,7733568,159040
.long 2607616,3721344,16777216,83968,16777216,219136,15,0,2048,16777216,703488,6093824,158976,10240,2000896,1980416,2041856,2021376,2052096,3213312,3233792,3254272,148480,3676672,1082752,942720,7589376,7762816,1280156,8048640,4355840,4356352,6087680,6097152,7976960,17412736,17437312,25148416,62,1269920,110592,6119424,280576,4356096,7584256,640,7733568,159104
.long 2612736,3721728,16777216,84736,187008,186368,9,0,2048,16777216,704000,6096384,159104,15360,2006016,1985536,2046976,2026496,2057216,3218432,3238912,3256320,150528,3678208,1131904,963200,7589632,7762880,1300636,8053760,4356608,4357632,6128640,6138112,7982080,17412736,17437312,25148416,63,1290400,114688,6139904,280576,4357120,7584512,640,7733568,159168
.long 2146816,3686784,89472,81920,240768,217088,15,0,2048,711808,710656,6744064,158720,0,1990656,1970176,2031616,2011136,2062336,3223552,3244032,3259392,143360,3673600,985216,1393280,7650304,7778048,1894556,8058880,4370304,4370816,6661120,6670592,7966720,640960,650176,8540672,92,1884320,102400,6733824,280576,4370432,7645184,640,7733568,158976
.long 2151936,3687168,16777216,82944,118144,116736,15,0,2048,16777216,711168,6746624,158848,5120,1995776,1975296,2036736,2016256,2067456,3228672,3249152,3261440,145408,3675136,1034368,1413760,7650560,7778112,1915036,8064000,4371072,4372096,6702080,6711552,7971840,646080,655296,8540928,93,1904800,106496,6754304,280576,4371456,7645440,640,7733568,159040
.long 2249216,3694464,16777216,83968,16777216,219136,15,0,2048,16777216,711680,6749184,158976,10240,2000896,1980416,2041856,2021376,2052096,3213312,3233792,3254272,148480,3676672,1083520,1434240,7650816,7778176,1935516,8048640,4372224,4372736,6743040,6752512,7976960,17413056,17437632,25353216,94,1925280,110592,6774784,280576,4372480,7645696,640,7733568,159104
.long 2254336,3694848,16777216,84736,199296,198656,9,0,2048,16777216,712192,6751744,159104,15360,2006016,1985536,2046976,2026496,2057216,3218432,3238912,3256320,150528,3678208,1132672,1454720,7651072,7778240,1955996,8053760,4372992,4374016,6784000,6793472,7982080,17413056,17437632,25353216,95,1945760,114688,6795264,280576,4373504,7645952,640,7733568,159168
.long 2556416,3717504,97664,81920,216192,217088,15,0,2048,720000,718848,7399424,158720,0,1990656,1970176,2031616,2011136,2062336,3223552,3244032,3259392,143360,3673600,985984,1884800,7711744,7793408,2549916,8058880,4386688,4387200,7316480,7325952,7966720,640000,649216,7926272,124,2539680,102400,7389184,280576,4386816,7706624,640,7733568,158976
.long 2561536,3717888,16777216,82944,118656,116736,15,0,2048,16777216,719360,7401984,158848,5120,1995776,1975296,2036736,2016256,2067456,3228672,3249152,3261440,145408,3675136,1035136,1905280,7712000,7793472,2570396,8064000,4387456,4388480,7357440,7366912,7971840,645120,654336,7926528,125,2560160,106496,7409664,280576,4387840,7706880,640,7733568,159040
.long 2658816,3725184,16777216,83968,16777216,219136,15,0,2048,16777216,719872,7404544,158976,10240,2000896,1980416,2041856,2021376,2052096,3213312,3233792,3254272,148480,3676672,1084288,1925760,7712256,7793536,2590876,8048640,4388608,4389120,7398400,7407872,7976960,17412096,17436672,24738816,126,2580640,110592,7430144,280576,4388864,7707136,640,7733568,159104
.long 2663936,3725568,16777216,84736,211584,210944,9,0,2048,16777216,720384,7407104,159104,15360,2006016,1985536,2046976,2026496,2057216,3218432,3238912,3256320,150528,3678208,1133440,1946240,7712512,7793600,2611356,8053760,4389376,4390400,7439360,7448832,7982080,17412096,17436672,24738816,127,2601120,114688,7450624,280576,4389888,7707392,640,7733568,159168
.long 1081856,3606912,68480,69632,224512,221184,15,8192,0,694528,694272,5361664,158720,0,1294336,1314816,1253376,1273856,1335296,2875392,2854912,2895872,143360,3619840,1179904,164608,7497728,7739904,491996,8151040,3878784,3879296,5343232,5358080,8069120,665920,675136,8135680,24,491840,102400,5341184,266240,3878912,7491584,768,7733888,158720
.long 1086976,3607296,16777216,70656,102784,102400,15,8192,0,16777216,694784,5364224,158848,5120,1299456,1319936,1258496,1278976,1340416,2880512,2860032,2897920,145408,3621376,1229056,185088,7497984,7739968,512476,8156160,3879552,3880576,5384192,5399040,8074240,671040,680256,8135936,25,512320,106496,5361664,266240,3879936,7491840,768,7733888,158784
.long 1184256,3614592,16777216,71680,16777216,223232,15,8192,0,16777216,695296,5366784,158976,10240,1304576,1325056,1263616,1284096,1345536,2885632,2865152,2900992,148480,3622912,1278208,205568,7498240,7740032,532956,8161280,3880704,3881216,5425152,5440000,8079360,686400,710976,8166656,26,532800,110592,5382144,266240,3880960,7492096,768,7733888,158848
.long 1189376,3614976,16777216,72448,168704,167936,9,8192,0,16777216,695808,5369344,159104,15360,1309696,1330176,1268736,1289216,1350656,2890752,2870272,2903040,150528,3624448,1327360,226048,7498496,7740096,553436,8166400,3881472,3882496,5466112,5480960,8084480,17463616,17488192,24943872,27,553280,114688,5402624,266240,3881984,7492352,768,7733888,158912
.long 1491456,3637632,76672,69632,232704,221184,15,8192,0,702720,702464,6017024,158720,0,1294336,1314816,1253376,1273856,1335296,2875392,2854912,2895872,143360,3619840,1180672,656128,7559168,7755264,1147356,8151040,3895168,3895680,5998592,6013440,8069120,666240,675456,8340480,56,1147200,102400,5996544,266240,3895296,7553024,768,7733888,158720
.long 1496576,3638016,16777216,70656,103296,102400,15,8192,0,16777216,702976,6019584,158848,5120,1299456,1319936,1258496,1278976,1340416,2880512,2860032,2897920,145408,3621376,1229824,676608,7559424,7755328,1167836,8156160,3895936,3896960,6039552,6054400,8074240,671360,680576,8340736,57,1167680,106496,6017024,266240,3896320,7553280,768,7733888,158784
.long 1593856,3645312,16777216,71680,16777216,223232,15,8192,0,16777216,703488,6022144,158976,10240,1304576,1325056,1263616,1284096,1345536,2885632,2865152,2900992,148480,3622912,1278976,697088,7559680,7755392,1188316,8161280,3897088,3897600,6080512,6095360,8079360,686720,711296,8371456,58,1188160,110592,6037504,266240,3897344,7553536,768,7733888,158848
.long 1598976,3645696,16777216,72448,180992,180224,9,8192,0,16777216,704000,6024704,159104,15360,1309696,1330176,1268736,1289216,1350656,2890752,2870272,2903040,150528,3624448,1328128,717568,7559936,7755456,1208796,8166400,3897856,3898880,6121472,6136320,8084480,17463936,17488512,25148672,59,1208640,114688,6057984,266240,3898368,7553792,768,7733888,158912
.long 1133056,3610752,69120,69632,240896,221184,15,8192,0,710912,710656,6672384,158720,0,1294336,1314816,1253376,1273856,1335296,2875392,2854912,2895872,143360,3619840,1181440,1147648,7620608,7770624,1802716,8151040,3911552,3912064,6653952,6668800,8069120,666560,675776,8545280,88,1802560,102400,6651904,266240,3911680,7614464,768,7733888,158720
.long 1138176,3611136,16777216,70656,103808,102400,15,8192,0,16777216,711168,6674944,158848,5120,1299456,1319936,1258496,1278976,1340416,2880512,2860032,2897920,145408,3621376,1230592,1168128,7620864,7770688,1823196,8156160,3912320,3913344,6694912,6709760,8074240,671680,680896,8545536,89,1823040,106496,6672384,266240,3912704,7614720,768,7733888,158784
.long 1235456,3618432,16777216,71680,16777216,223232,15,8192,0,16777216,711680,6677504,158976,10240,1304576,1325056,1263616,1284096,1345536,2885632,2865152,2900992,148480,3622912,1279744,1188608,7621120,7770752,1843676,8161280,3913472,3913984,6735872,6750720,8079360,687040,711616,8576256,90,1843520,110592,6692864,266240,3913728,7614976,768,7733888,158848
.long 1240576,3618816,16777216,72448,193280,192512,9,8192,0,16777216,712192,6680064,159104,15360,1309696,1330176,1268736,1289216,1350656,2890752,2870272,2903040,150528,3624448,1328896,1209088,7621376,7770816,1864156,8166400,3914240,3915264,6776832,6791680,8084480,17464256,17488832,25353472,91,1864000,114688,6713344,266240,3914752,7615232,768,7733888,158912
.long 1542656,3641472,77312,69632,216320,221184,15,8192,0,719104,718848,7327744,158720,0,1294336,1314816,1253376,1273856,1335296,2875392,2854912,2895872,143360,3619840,1182208,1639168,7682048,7785984,2458076,8151040,3927936,3928448,7309312,7324160,8069120,665600,674816,7930880,120,2457920,102400,7307264,266240,3928064,7675904,768,7733888,158720
.long 1547776,3641856,16777216,70656,104320,102400,15,8192,0,16777216,719360,7330304,158848,5120,1299456,1319936,1258496,1278976,1340416,2880512,2860032,2897920,145408,3621376,1231360,1659648,7682304,7786048,2478556,8156160,3928704,3929728,7350272,7365120,8074240,670720,679936,7931136,121,2478400,106496,7327744,266240,3929088,7676160,768,7733888,158784
.long 1645056,3649152,16777216,71680,16777216,223232,15,8192,0,16777216,719872,7332864,158976,10240,1304576,1325056,1263616,1284096,1345536,2885632,2865152,2900992,148480,3622912,1280512,1680128,7682560,7786112,2499036,8161280,3929856,3930368,7391232,7406080,8079360,686080,710656,7961856,122,2498880,110592,7348224,266240,3930112,7676416,768,7733888,158848
.long 1650176,3649536,16777216,72448,205568,204800,9,8192,0,16777216,720384,7335424,159104,15360,1309696,1330176,1268736,1289216,1350656,2890752,2870272,2903040,150528,3624448,1329664,1700608,7682816,7786176,2519516,8166400,3930624,3931648,7432192,7447040,8084480,17463296,17487872,24739072,123,2519360,114688,7368704,266240,3931136,7676672,768,7733888,158912
.long 1901056,3668352,84864,86016,228608,221184,15,0,2048,695552,694272,5443584,158720,0,2113536,2134016,2072576,2093056,2154496,3284992,3264512,3305472,143360,3681280,1180288,410368,7528448,7747584,573916,8161280,4403072,4403584,5351424,5360128,8069120,666080,675296,8238080,28,573760,102400,5423104,282624,4403200,7522304,768,7733888,158976
.long 1906176,3668736,16777216,87040,119168,118784,15,0,2048,16777216,694784,5446144,158848,5120,2118656,2139136,2077696,2098176,2159616,3290112,3269632,3307520,145408,3682816,1229440,430848,7528704,7747648,594396,8166400,4403840,4404864,5392384,5401088,8074240,671200,680416,8238336,29,594240,106496,5443584,282624,4404224,7522560,768,7733888,159040
.long 2003456,3676032,16777216,88064,16777216,223232,15,0,2048,16777216,695296,5448704,158976,10240,2123776,2144256,2082816,2103296,2164736,3295232,3274752,3310592,148480,3684352,1278592,451328,7528960,7747712,614876,8151040,4404992,4405504,5433344,5442048,8079360,686560,711136,8269056,30,614720,110592,5464064,282624,4405248,7522816,768,7733888,159104
.long 2008576,3676416,16777216,88832,174848,174080,9,0,2048,16777216,695808,5451264,159104,15360,2128896,2149376,2087936,2108416,2169856,3300352,3279872,3312640,150528,3685888,1327744,471808,7529216,7747776,635356,8156160,4405760,4406784,5474304,5483008,8084480,17463776,17488352,25046272,31,635200,114688,5484544,282624,4406272,7523072,768,7733888,159168
.long 2310656,3699072,93056,86016,236800,221184,15,0,2048,703744,702464,6098944,158720,0,2113536,2134016,2072576,2093056,2154496,3284992,3264512,3305472,143360,3681280,1181056,901888,7589888,7762944,1229276,8161280,4419456,4419968,6006784,6015488,8069120,666400,675616,8442880,60,1229120,102400,6078464,282624,4419584,7583744,768,7733888,158976
.long 2315776,3699456,16777216,87040,119680,118784,15,0,2048,16777216,702976,6101504,158848,5120,2118656,2139136,2077696,2098176,2159616,3290112,3269632,3307520,145408,3682816,1230208,922368,7590144,7763008,1249756,8166400,4420224,4421248,6047744,6056448,8074240,671520,680736,8443136,61,1249600,106496,6098944,282624,4420608,7584000,768,7733888,159040
.long 2413056,3706752,16777216,88064,16777216,223232,15,0,2048,16777216,703488,6104064,158976,10240,2123776,2144256,2082816,2103296,2164736,3295232,3274752,3310592,148480,3684352,1279360,942848,7590400,7763072,1270236,8151040,4421376,4421888,6088704,6097408,8079360,686880,711456,8473856,62,1270080,110592,6119424,282624,4421632,7584256,768,7733888,159104
.long 2418176,3707136,16777216,88832,187136,186368,9,0,2048,16777216,704000,6106624,159104,15360,2128896,2149376,2087936,2108416,2169856,3300352,3279872,3312640,150528,3685888,1328512,963328,7590656,7763136,1290716,8156160,4422144,4423168,6129664,6138368,8084480,17464096,17488672,25251072,63,1290560,114688,6139904,282624,4422656,7584512,768,7733888,159168
.long 1952256,3672192,85504,86016,244992,221184,15,0,2048,711936,710656,6754304,158720,0,2113536,2134016,2072576,2093056,2154496,3284992,3264512,3305472,143360,3681280,1181824,1393408,7651328,7778304,1884636,8161280,4435840,4436352,6662144,6670848,8069120,666720,675936,8647680,92,1884480,102400,6733824,282624,4435968,7645184,768,7733888,158976
.long 1957376,3672576,16777216,87040,120192,118784,15,0,2048,16777216,711168,6756864,158848,5120,2118656,2139136,2077696,2098176,2159616,3290112,3269632,3307520,145408,3682816,1230976,1413888,7651584,7778368,1905116,8166400,4436608,4437632,6703104,6711808,8074240,671840,681056,8647936,93,1904960,106496,6754304,282624,4436992,7645440,768,7733888,159040
.long 2054656,3679872,16777216,88064,16777216,223232,15,0,2048,16777216,711680,6759424,158976,10240,2123776,2144256,2082816,2103296,2164736,3295232,3274752,3310592,148480,3684352,1280128,1434368,7651840,7778432,1925596,8151040,4437760,4438272,6744064,6752768,8079360,687200,711776,8678656,94,1925440,110592,6774784,282624,4438016,7645696,768,7733888,159104
.long 2059776,3680256,16777216,88832,199424,198656,9,0,2048,16777216,712192,6761984,159104,15360,2128896,2149376,2087936,2108416,2169856,3300352,3279872,3312640,150528,3685888,1329280,1454848,7652096,7778496,1946076,8156160,4438528,4439552,6785024,6793728,8084480,17464416,17488992,25455872,95,1945920,114688,6795264,282624,4439040,7645952,768,7733888,159168
.long 2361856,3702912,93696,86016,220416,221184,15,0,2048,720128,718848,7409664,158720,0,2113536,2134016,2072576,2093056,2154496,3284992,3264512,3305472,143360,3681280,1182592,1884928,7712768,7793664,2539996,8161280,4452224,4452736,7317504,7326208,8069120,665760,674976,8033280,124,2539840,102400,7389184,282624,4452352,7706624,768,7733888,158976
.long 2366976,3703296,16777216,87040,120704,118784,15,0,2048,16777216,719360,7412224,158848,5120,2118656,2139136,2077696,2098176,2159616,3290112,3269632,3307520,145408,3682816,1231744,1905408,7713024,7793728,2560476,8166400,4452992,4454016,7358464,7367168,8074240,670880,680096,8033536,125,2560320,106496,7409664,282624,4453376,7706880,768,7733888,159040
.long 2464256,3710592,16777216,88064,16777216,223232,15,0,2048,16777216,719872,7414784,158976,10240,2123776,2144256,2082816,2103296,2164736,3295232,3274752,3310592,148480,3684352,1280896,1925888,7713280,7793792,2580956,8151040,4454144,4454656,7399424,7408128,8079360,686240,710816,8064256,126,2580800,110592,7430144,282624,4454400,7707136,768,7733888,159104
.long 2469376,3710976,16777216,88832,211712,210944,9,0,2048,16777216,720384,7417344,159104,15360,2128896,2149376,2087936,2108416,2169856,3300352,3279872,3312640,150528,3685888,1330048,1946368,7713536,7793856,2601436,8156160,4454912,4455936,7440384,7449088,8084480,17463456,17488032,24841472,127,2601280,114688,7450624,282624,4455424,7707392,768,7733888,159168
.long 1286656,3622272,72576,69632,228736,225280,15,8192,0,694656,694272,5371904,158720,0,1417216,1396736,1376256,1355776,1447936,2936832,2916352,2952192,143360,3627520,1376512,164736,7498752,7740160,502236,8253440,3944320,3944832,5344256,5358336,8171520,691680,700896,8238592,24,492000,102400,5341184,268288,3944448,7491584,896,7734208,158720
.long 1291776,3622656,16777216,70656,104832,104448,15,8192,0,16777216,694784,5374464,158848,5120,1422336,1401856,1381376,1360896,1453056,2941952,2921472,2954240,145408,3629056,1425664,185216,7499008,7740224,522716,8258560,3945088,3946112,5385216,5399296,8176640,696800,706016,8238848,25,512480,106496,5361664,268288,3945472,7491840,896,7734208,158784
.long 1389056,3629952,16777216,71680,16777216,227328,15,8192,0,16777216,695296,5377024,158976,10240,1427456,1406976,1386496,1366016,1437696,2926592,2906112,2947072,148480,3630592,1474816,205696,7499264,7740288,543196,8263680,3946240,3946752,5426176,5440256,8181760,17463776,17488352,25046272,26,532960,110592,5382144,268288,3946496,7492096,896,7734208,158848
.long 1394176,3630336,16777216,72448,168832,167936,9,8192,0,16777216,695808,5379584,159104,15360,1432576,1412096,1391616,1371136,1442816,2931712,2911232,2949120,150528,3632128,1523968,226176,7499520,7740352,563676,8268800,3947008,3948032,5467136,5481216,8186880,17463776,17488352,25046272,27,553440,114688,5402624,268288,3947520,7492352,896,7734208,158912
.long 1696256,3652992,80768,69632,236928,225280,15,8192,0,702848,702464,6027264,158720,0,1417216,1396736,1376256,1355776,1447936,2936832,2916352,2952192,143360,3627520,1377280,656256,7560192,7755520,1157596,8253440,3960704,3961216,5999616,6013696,8171520,692000,701216,8443392,56,1147360,102400,5996544,268288,3960832,7553024,896,7734208,158720
.long 1701376,3653376,16777216,70656,105344,104448,15,8192,0,16777216,702976,6029824,158848,5120,1422336,1401856,1381376,1360896,1453056,2941952,2921472,2954240,145408,3629056,1426432,676736,7560448,7755584,1178076,8258560,3961472,3962496,6040576,6054656,8176640,697120,706336,8443648,57,1167840,106496,6017024,268288,3961856,7553280,896,7734208,158784
.long 1798656,3660672,16777216,71680,16777216,227328,15,8192,0,16777216,703488,6032384,158976,10240,1427456,1406976,1386496,1366016,1437696,2926592,2906112,2947072,148480,3630592,1475584,697216,7560704,7755648,1198556,8263680,3962624,3963136,6081536,6095616,8181760,17464096,17488672,25251072,58,1188320,110592,6037504,268288,3962880,7553536,896,7734208,158848
.long 1803776,3661056,16777216,72448,181120,180224,9,8192,0,16777216,704000,6034944,159104,15360,1432576,1412096,1391616,1371136,1442816,2931712,2911232,2949120,150528,3632128,1524736,717696,7560960,7755712,1219036,8268800,3963392,3964416,6122496,6136576,8186880,17464096,17488672,25251072,59,1208800,114688,6057984,268288,3963904,7553792,896,7734208,158912
.long 1337856,3626112,73216,69632,245120,225280,15,8192,0,711040,710656,6682624,158720,0,1417216,1396736,1376256,1355776,1447936,2936832,2916352,2952192,143360,3627520,1378048,1147776,7621632,7770880,1812956,8253440,3977088,3977600,6654976,6669056,8171520,692320,701536,8648192,88,1802720,102400,6651904,268288,3977216,7614464,896,7734208,158720
.long 1342976,3626496,16777216,70656,105856,104448,15,8192,0,16777216,711168,6685184,158848,5120,1422336,1401856,1381376,1360896,1453056,2941952,2921472,2954240,145408,3629056,1427200,1168256,7621888,7770944,1833436,8258560,3977856,3978880,6695936,6710016,8176640,697440,706656,8648448,89,1823200,106496,6672384,268288,3978240,7614720,896,7734208,158784
.long 1440256,3633792,16777216,71680,16777216,227328,15,8192,0,16777216,711680,6687744,158976,10240,1427456,1406976,1386496,1366016,1437696,2926592,2906112,2947072,148480,3630592,1476352,1188736,7622144,7771008,1853916,8263680,3979008,3979520,6736896,6750976,8181760,17464416,17488992,25455872,90,1843680,110592,6692864,268288,3979264,7614976,896,7734208,158848
.long 1445376,3634176,16777216,72448,193408,192512,9,8192,0,16777216,712192,6690304,159104,15360,1432576,1412096,1391616,1371136,1442816,2931712,2911232,2949120,150528,3632128,1525504,1209216,7622400,7771072,1874396,8268800,3979776,3980800,6777856,6791936,8186880,17464416,17488992,25455872,91,1864160,114688,6713344,268288,3980288,7615232,896,7734208,158912
.long 1747456,3656832,81408,69632,220544,225280,15,8192,0,719232,718848,7337984,158720,0,1417216,1396736,1376256,1355776,1447936,2936832,2916352,2952192,143360,3627520,1378816,1639296,7683072,7786240,2468316,8253440,3993472,3993984,7310336,7324416,8171520,691360,700576,8033792,120,2458080,102400,7307264,268288,3993600,7675904,896,7734208,158720
.long 1752576,3657216,16777216,70656,106368,104448,15,8192,0,16777216,719360,7340544,158848,5120,1422336,1401856,1381376,1360896,1453056,2941952,2921472,2954240,145408,3629056,1427968,1659776,7683328,7786304,2488796,8258560,3994240,3995264,7351296,7365376,8176640,696480,705696,8034048,121,2478560,106496,7327744,268288,3994624,7676160,896,7734208,158784
.long 1849856,3664512,16777216,71680,16777216,227328,15,8192,0,16777216,719872,7343104,158976,10240,1427456,1406976,1386496,1366016,1437696,2926592,2906112,2947072,148480,3630592,1477120,1680256,7683584,7786368,2509276,8263680,3995392,3995904,7392256,7406336,8181760,17463456,17488032,24841472,122,2499040,110592,7348224,268288,3995648,7676416,896,7734208,158848
.long 1854976,3664896,16777216,72448,205696,204800,9,8192,0,16777216,720384,7345664,159104,15360,1432576,1412096,1391616,1371136,1442816,2931712,2911232,2949120,150528,3632128,1526272,1700736,7683840,7786432,2529756,8268800,3996160,3997184,7433216,7447296,8186880,17463456,17488032,24841472,123,2519520,114688,7368704,268288,3996672,7676672,896,7734208,158912
.long 2105856,3683712,88960,86016,232832,225280,15,0,2048,695680,694272,5453824,158720,0,2236416,2215936,2195456,2174976,2267136,3346432,3325952,3361792,143360,3688960,1376896,410496,7529472,7747840,584156,8263680,4468608,4469120,5352448,5360384,8171520,691840,701056,8340992,28,573920,102400,5423104,284672,4468736,7522304,896,7734208,158976
.long 2110976,3684096,16777216,87040,121216,120832,15,0,2048,16777216,694784,5456384,158848,5120,2241536,2221056,2200576,2180096,2272256,3351552,3331072,3363840,145408,3690496,1426048,430976,7529728,7747904,604636,8268800,4469376,4470400,5393408,5401344,8176640,696960,706176,8341248,29,594400,106496,5443584,284672,4469760,7522560,896,7734208,159040
.long 2208256,3691392,16777216,88064,16777216,227328,15,0,2048,16777216,695296,5458944,158976,10240,2246656,2226176,2205696,2185216,2256896,3336192,3315712,3356672,148480,3692032,1475200,451456,7529984,7747968,625116,8253440,4470528,4471040,5434368,5442304,8181760,17463936,17488512,25148672,30,614880,110592,5464064,284672,4470784,7522816,896,7734208,159104
.long 2213376,3691776,16777216,88832,174976,174080,9,0,2048,16777216,695808,5461504,159104,15360,2251776,2231296,2210816,2190336,2262016,3341312,3320832,3358720,150528,3693568,1524352,471936,7530240,7748032,645596,8258560,4471296,4472320,5475328,5483264,8186880,17463936,17488512,25148672,31,635360,114688,5484544,284672,4471808,7523072,896,7734208,159168
.long 2515456,3714432,97152,86016,241024,225280,15,0,2048,703872,702464,6109184,158720,0,2236416,2215936,2195456,2174976,2267136,3346432,3325952,3361792,143360,3688960,1377664,902016,7590912,7763200,1239516,8263680,4484992,4485504,6007808,6015744,8171520,692160,701376,8545792,60,1229280,102400,6078464,284672,4485120,7583744,896,7734208,158976
.long 2520576,3714816,16777216,87040,121728,120832,15,0,2048,16777216,702976,6111744,158848,5120,2241536,2221056,2200576,2180096,2272256,3351552,3331072,3363840,145408,3690496,1426816,922496,7591168,7763264,1259996,8268800,4485760,4486784,6048768,6056704,8176640,697280,706496,8546048,61,1249760,106496,6098944,284672,4486144,7584000,896,7734208,159040
.long 2617856,3722112,16777216,88064,16777216,227328,15,0,2048,16777216,703488,6114304,158976,10240,2246656,2226176,2205696,2185216,2256896,3336192,3315712,3356672,148480,3692032,1475968,942976,7591424,7763328,1280476,8253440,4486912,4487424,6089728,6097664,8181760,17464256,17488832,25353472,62,1270240,110592,6119424,284672,4487168,7584256,896,7734208,159104
.long 2622976,3722496,16777216,88832,187264,186368,9,0,2048,16777216,704000,6116864,159104,15360,2251776,2231296,2210816,2190336,2262016,3341312,3320832,3358720,150528,3693568,1525120,963456,7591680,7763392,1300956,8258560,4487680,4488704,6130688,6138624,8186880,17464256,17488832,25353472,63,1290720,114688,6139904,284672,4488192,7584512,896,7734208,159168
.long 2157056,3687552,89600,86016,216448,225280,15,0,2048,712064,710656,6764544,158720,0,2236416,2215936,2195456,2174976,2267136,3346432,3325952,3361792,143360,3688960,1378432,1393536,7652352,7778560,1894876,8263680,4501376,4501888,6663168,6671104,8171520,691200,700416,7931392,92,1884640,102400,6733824,284672,4501504,7645184,896,7734208,158976
.long 2162176,3687936,16777216,87040,122240,120832,15,0,2048,16777216,711168,6767104,158848,5120,2241536,2221056,2200576,2180096,2272256,3351552,3331072,3363840,145408,3690496,1427584,1414016,7652608,7778624,1915356,8268800,4502144,4503168,6704128,6712064,8176640,696320,705536,7931648,93,1905120,106496,6754304,284672,4502528,7645440,896,7734208,159040
.long 2259456,3695232,16777216,88064,16777216,227328,15,0,2048,16777216,711680,6769664,158976,10240,2246656,2226176,2205696,2185216,2256896,3336192,3315712,3356672,148480,3692032,1476736,1434496,7652864,7778688,1935836,8253440,4503296,4503808,6745088,6753024,8181760,17463296,17487872,24739072,94,1925600,110592,6774784,284672,4503552,7645696,896,7734208,159104
.long 2264576,3695616,16777216,88832,199552,198656,9,0,2048,16777216,712192,6772224,159104,15360,2251776,2231296,2210816,2190336,2262016,3341312,3320832,3358720,150528,3693568,1525888,1454976,7653120,7778752,1956316,8258560,4504064,4505088,6786048,6793984,8186880,17463296,17487872,24739072,95,1946080,114688,6795264,284672,4504576,7645952,896,7734208,159168
.long 2566656,3718272,97792,86016,224640,225280,15,0,2048,720256,718848,7419904,158720,0,2236416,2215936,2195456,2174976,2267136,3346432,3325952,3361792,143360,3688960,1379200,1885056,7713792,7793920,2550236,8263680,4517760,4518272,7318528,7326464,8171520,691520,700736,8136192,124,2540000,102400,7389184,284672,4517888,7706624,896,7734208,158976
.long 2571776,3718656,16777216,87040,122752,120832,15,0,2048,16777216,719360,7422464,158848,5120,2241536,2221056,2200576,2180096,2272256,3351552,3331072,3363840,145408,3690496,1428352,1905536,7714048,7793984,2570716,8268800,4518528,4519552,7359488,7367424,8176640,696640,705856,8136448,125,2560480,106496,7409664,284672,4518912,7706880,896,7734208,159040
.long 2669056,3725952,16777216,88064,16777216,227328,15,0,2048,16777216,719872,7425024,158976,10240,2246656,2226176,2205696,2185216,2256896,3336192,3315712,3356672,148480,3692032,1477504,1926016,7714304,7794048,2591196,8253440,4519680,4520192,7400448,7408384,8181760,17463616,17488192,24943872,126,2580960,110592,7430144,284672,4519936,7707136,896,7734208,159104
.long 2674176,3726336,16777216,88832,211840,210944,9,0,2048,16777216,720384,7427584,159104,15360,2251776,2231296,2210816,2190336,2262016,3341312,3320832,3358720,150528,3693568,1526656,1946496,7714560,7794112,2611676,8258560,4520448,4521472,7441408,7449344,8186880,17463616,17488192,24943872,127,2601440,114688,7450624,284672,4520960,7707392,896,7734208,159168
.long 1092096,3607680,68608,73728,232960,229376,15,8192,0,694784,694272,5382144,158720,0,1458176,1478656,1499136,1519616,1540096,2957312,2977792,2998272,143360,3635200,1573120,164864,7499776,7740416,492316,8355840,4009856,4010368,5345280,5358592,8273920,717440,726656,8345600,24,492160,102400,5341184,270336,4009984,7491584,1024,7734528,158720
.long 1097216,3608064,16777216,74752,106880,106496,15,8192,0,16777216,694784,5384704,158848,5120,1463296,1483776,1504256,1524736,1545216,2962432,2982912,3000320,145408,3636736,1622272,185344,7500032,7740480,512796,8360960,4010624,4011648,5386240,5399552,8279040,722560,731776,8345856,25,512640,106496,5361664,270336,4011008,7491840,1024,7734528,158784
.long 1194496,3615360,16777216,75776,16777216,231424,15,8192,0,16777216,695296,5387264,158976,10240,1468416,1488896,1509376,1529856,1550336,2967552,2988032,3003392,148480,3638272,1671424,205824,7500288,7740544,533276,8366080,4011776,4012288,5427200,5440512,8284160,737920,762496,8371712,26,533120,110592,5382144,270336,4012032,7492096,1024,7734528,158848
.long 1199616,3615744,16777216,76544,168960,167936,9,8192,0,16777216,695808,5389824,159104,15360,1473536,1494016,1514496,1534976,1555456,2972672,2993152,3005440,150528,3639808,1720576,226304,7500544,7740608,553756,8371200,4012544,4013568,5468160,5481472,8289280,17515136,17539712,25148928,27,553600,114688,5402624,270336,4013056,7492352,1024,7734528,158912
.long 1501696,3638400,76800,73728,241152,229376,15,8192,0,702976,702464,6037504,158720,0,1458176,1478656,1499136,1519616,1540096,2957312,2977792,2998272,143360,3635200,1573888,656384,7561216,7755776,1147676,8355840,4026240,4026752,6000640,6013952,8273920,717760,726976,8550400,56,1147520,102400,5996544,270336,4026368,7553024,1024,7734528,158720
.long 1506816,3638784,16777216,74752,107392,106496,15,8192,0,16777216,702976,6040064,158848,5120,1463296,1483776,1504256,1524736,1545216,2962432,2982912,3000320,145408,3636736,1623040,676864,7561472,7755840,1168156,8360960,4027008,4028032,6041600,6054912,8279040,722880,732096,8550656,57,1168000,106496,6017024,270336,4027392,7553280,1024,7734528,158784
.long 1604096,3646080,16777216,75776,16777216,231424,15,8192,0,16777216,703488,6042624,158976,10240,1468416,1488896,1509376,1529856,1550336,2967552,2988032,3003392,148480,3638272,1672192,697344,7561728,7755904,1188636,8366080,4028160,4028672,6082560,6095872,8284160,738240,762816,8576512,58,1188480,110592,6037504,270336,4028416,7553536,1024,7734528,158848
.long 1609216,3646464,16777216,76544,181248,180224,9,8192,0,16777216,704000,6045184,159104,15360,1473536,1494016,1514496,1534976,1555456,2972672,2993152,3005440,150528,3639808,1721344,717824,7561984,7755968,1209116,8371200,4028928,4029952,6123520,6136832,8289280,17515456,17540032,25353728,59,1208960,114688,6057984,270336,4029440,7553792,1024,7734528,158912
.long 1143296,3611520,69248,73728,216576,229376,15,8192,0,711168,710656,6692864,158720,0,1458176,1478656,1499136,1519616,1540096,2957312,2977792,2998272,143360,3635200,1574656,1147904,7622656,7771136,1803036,8355840,4042624,4043136,6656000,6669312,8273920,716800,726016,7936000,88,1802880,102400,6651904,270336,4042752,7614464,1024,7734528,158720
.long 1148416,3611904,16777216,74752,107904,106496,15,8192,0,16777216,711168,6695424,158848,5120,1463296,1483776,1504256,1524736,1545216,2962432,2982912,3000320,145408,3636736,1623808,1168384,7622912,7771200,1823516,8360960,4043392,4044416,6696960,6710272,8279040,721920,731136,7936256,89,1823360,106496,6672384,270336,4043776,7614720,1024,7734528,158784
.long 1245696,3619200,16777216,75776,16777216,231424,15,8192,0,16777216,711680,6697984,158976,10240,1468416,1488896,1509376,1529856,1550336,2967552,2988032,3003392,148480,3638272,1672960,1188864,7623168,7771264,1843996,8366080,4044544,4045056,6737920,6751232,8284160,737280,761856,7962112,90,1843840,110592,6692864,270336,4044800,7614976,1024,7734528,158848
.long 1250816,3619584,16777216,76544,193536,192512,9,8192,0,16777216,712192,6700544,159104,15360,1473536,1494016,1514496,1534976,1555456,2972672,2993152,3005440,150528,3639808,1722112,1209344,7623424,7771328,1864476,8371200,4045312,4046336,6778880,6792192,8289280,17514496,17539072,24739328,91,1864320,114688,6713344,270336,4045824,7615232,1024,7734528,158912
.long 1552896,3642240,77440,73728,224768,229376,15,8192,0,719360,718848,7348224,158720,0,1458176,1478656,1499136,1519616,1540096,2957312,2977792,2998272,143360,3635200,1575424,1639424,7684096,7786496,2458396,8355840,4059008,4059520,7311360,7324672,8273920,717120,726336,8140800,120,2458240,102400,7307264,270336,4059136,7675904,1024,7734528,158720
.long 1558016,3642624,16777216,74752,108416,106496,15,8192,0,16777216,719360,7350784,158848,5120,1463296,1483776,1504256,1524736,1545216,2962432,2982912,3000320,145408,3636736,1624576,1659904,7684352,7786560,2478876,8360960,4059776,4060800,7352320,7365632,8279040,722240,731456,8141056,121,2478720,106496,7327744,270336,4060160,7676160,1024,7734528,158784
.long 1655296,3649920,16777216,75776,16777216,231424,15,8192,0,16777216,719872,7353344,158976,10240,1468416,1488896,1509376,1529856,1550336,2967552,2988032,3003392,148480,3638272,1673728,1680384,7684608,7786624,2499356,8366080,4060928,4061440,7393280,7406592,8284160,737600,762176,8166912,122,2499200,110592,7348224,270336,4061184,7676416,1024,7734528,158848
.long 1660416,3650304,16777216,76544,205824,204800,9,8192,0,16777216,720384,7355904,159104,15360,1473536,1494016,1514496,1534976,1555456,2972672,2993152,3005440,150528,3639808,1722880,1700864,7684864,7786688,2519836,8371200,4061696,4062720,7434240,7447552,8289280,17514816,17539392,24944128,123,2519680,114688,7368704,270336,4062208,7676672,1024,7734528,158912
.long 1911296,3669120,84992,90112,237056,229376,15,0,2048,695808,694272,5464064,158720,0,2277376,2297856,2318336,2338816,2359296,3366912,3387392,3407872,143360,3696640,1573504,410624,7530496,7748096,574236,8366080,4534144,4534656,5353472,5360640,8273920,717600,726816,8448000,28,574080,102400,5423104,286720,4534272,7522304,1024,7734528,158976
.long 1916416,3669504,16777216,91136,123264,122880,15,0,2048,16777216,694784,5466624,158848,5120,2282496,2302976,2323456,2343936,2364416,3372032,3392512,3409920,145408,3698176,1622656,431104,7530752,7748160,594716,8371200,4534912,4535936,5394432,5401600,8279040,722720,731936,8448256,29,594560,106496,5443584,286720,4535296,7522560,1024,7734528,159040
.long 2013696,3676800,16777216,92160,16777216,231424,15,0,2048,16777216,695296,5469184,158976,10240,2287616,2308096,2328576,2349056,2369536,3377152,3397632,3412992,148480,3699712,1671808,451584,7531008,7748224,615196,8355840,4536064,4536576,5435392,5442560,8284160,738080,762656,8474112,30,615040,110592,5464064,286720,4536320,7522816,1024,7734528,159104
.long 2018816,3677184,16777216,92928,175104,174080,9,0,2048,16777216,695808,5471744,159104,15360,2292736,2313216,2333696,2354176,2374656,3382272,3402752,3415040,150528,3701248,1720960,472064,7531264,7748288,635676,8360960,4536832,4537856,5476352,5483520,8289280,17515296,17539872,25251328,31,635520,114688,5484544,286720,4537344,7523072,1024,7734528,159168
.long 2320896,3699840,93184,90112,245248,229376,15,0,2048,704000,702464,6119424,158720,0,2277376,2297856,2318336,2338816,2359296,3366912,3387392,3407872,143360,3696640,1574272,902144,7591936,7763456,1229596,8366080,4550528,4551040,6008832,6016000,8273920,717920,727136,8652800,60,1229440,102400,6078464,286720,4550656,7583744,1024,7734528,158976
.long 2326016,3700224,16777216,91136,123776,122880,15,0,2048,16777216,702976,6121984,158848,5120,2282496,2302976,2323456,2343936,2364416,3372032,3392512,3409920,145408,3698176,1623424,922624,7592192,7763520,1250076,8371200,4551296,4552320,6049792,6056960,8279040,723040,732256,8653056,61,1249920,106496,6098944,286720,4551680,7584000,1024,7734528,159040
.long 2423296,3707520,16777216,92160,16777216,231424,15,0,2048,16777216,703488,6124544,158976,10240,2287616,2308096,2328576,2349056,2369536,3377152,3397632,3412992,148480,3699712,1672576,943104,7592448,7763584,1270556,8355840,4552448,4552960,6090752,6097920,8284160,738400,762976,8678912,62,1270400,110592,6119424,286720,4552704,7584256,1024,7734528,159104
.long 2428416,3707904,16777216,92928,187392,186368,9,0,2048,16777216,704000,6127104,159104,15360,2292736,2313216,2333696,2354176,2374656,3382272,3402752,3415040,150528,3701248,1721728,963584,7592704,7763648,1291036,8360960,4553216,4554240,6131712,6138880,8289280,17515616,17540192,25456128,63,1290880,114688,6139904,286720,4553728,7584512,1024,7734528,159168
.long 1962496,3672960,85632,90112,220672,229376,15,0,2048,712192,710656,6774784,158720,0,2277376,2297856,2318336,2338816,2359296,3366912,3387392,3407872,143360,3696640,1575040,1393664,7653376,7778816,1884956,8366080,4566912,4567424,6664192,6671360,8273920,716960,726176,8038400,92,1884800,102400,6733824,286720,4567040,7645184,1024,7734528,158976
.long 1967616,3673344,16777216,91136,124288,122880,15,0,2048,16777216,711168,6777344,158848,5120,2282496,2302976,2323456,2343936,2364416,3372032,3392512,3409920,145408,3698176,1624192,1414144,7653632,7778880,1905436,8371200,4567680,4568704,6705152,6712320,8279040,722080,731296,8038656,93,1905280,106496,6754304,286720,4568064,7645440,1024,7734528,159040
.long 2064896,3680640,16777216,92160,16777216,231424,15,0,2048,16777216,711680,6779904,158976,10240,2287616,2308096,2328576,2349056,2369536,3377152,3397632,3412992,148480,3699712,1673344,1434624,7653888,7778944,1925916,8355840,4568832,4569344,6746112,6753280,8284160,737440,762016,8064512,94,1925760,110592,6774784,286720,4569088,7645696,1024,7734528,159104
.long 2070016,3681024,16777216,92928,199680,198656,9,0,2048,16777216,712192,6782464,159104,15360,2292736,2313216,2333696,2354176,2374656,3382272,3402752,3415040,150528,3701248,1722496,1455104,7654144,7779008,1946396,8360960,4569600,4570624,6787072,6794240,8289280,17514656,17539232,24841728,95,1946240,114688,6795264,286720,4570112,7645952,1024,7734528,159168
.long 2372096,3703680,93824,90112,228864,229376,15,0,2048,720384,718848,7430144,158720,0,2277376,2297856,2318336,2338816,2359296,3366912,3387392,3407872,143360,3696640,1575808,1885184,7714816,7794176,2540316,8366080,4583296,4583808,7319552,7326720,8273920,717280,726496,8243200,124,2540160,102400,7389184,286720,4583424,7706624,1024,7734528,158976
.long 2377216,3704064,16777216,91136,124800,122880,15,0,2048,16777216,719360,7432704,158848,5120,2282496,2302976,2323456,2343936,2364416,3372032,3392512,3409920,145408,3698176,1624960,1905664,7715072,7794240,2560796,8371200,4584064,4585088,7360512,7367680,8279040,722400,731616,8243456,125,2560640,106496,7409664,286720,4584448,7706880,1024,7734528,159040
.long 2474496,3711360,16777216,92160,16777216,231424,15,0,2048,16777216,719872,7435264,158976,10240,2287616,2308096,2328576,2349056,2369536,3377152,3397632,3412992,148480,3699712,1674112,1926144,7715328,7794304,2581276,8355840,4585216,4585728,7401472,7408640,8284160,737760,762336,8269312,126,2581120,110592,7430144,286720,4585472,7707136,1024,7734528,159104
.long 2479616,3711744,16777216,92928,211968,210944,9,0,2048,16777216,720384,7437824,159104,15360,2292736,2313216,2333696,2354176,2374656,3382272,3402752,3415040,150528,3701248,1723264,1946624,7715584,7794368,2601756,8360960,4585984,4587008,7442432,7449600,8289280,17514976,17539552,25046528,127,2601600,114688,7450624,286720,4586496,7707392,1024,7734528,159168
.long 1296896,3623040,72704,73728,237184,233472,15,8192,0,694912,694272,5392384,158720,0,1581056,1560576,1622016,1601536,1652736,3018752,3039232,3054592,143360,3642880,1769728,164992,7500800,7740672,502556,8458240,4075392,4075904,5346304,5358848,8376320,743200,752416,8448512,24,492320,102400,5341184,272384,4075520,7491584,1152,7734848,158720
.long 1302016,3623424,16777216,74752,108928,108544,15,8192,0,16777216,694784,5394944,158848,5120,1586176,1565696,1627136,1606656,1657856,3023872,3044352,3056640,145408,3644416,1818880,185472,7501056,7740736,523036,8463360,4076160,4077184,5387264,5399808,8381440,748320,757536,8448768,25,512800,106496,5361664,272384,4076544,7491840,1152,7734848,158784
.long 1399296,3630720,16777216,75776,16777216,235520,15,8192,0,16777216,695296,5397504,158976,10240,1591296,1570816,1632256,1611776,1642496,3008512,3028992,3049472,148480,3645952,1868032,205952,7501312,7740800,543516,8468480,4077312,4077824,5428224,5440768,8386560,17515296,17539872,25251328,26,533280,110592,5382144,272384,4077568,7492096,1152,7734848,158848
.long 1404416,3631104,16777216,76544,169088,167936,9,8192,0,16777216,695808,5400064,159104,15360,1596416,1575936,1637376,1616896,1647616,3013632,3034112,3051520,150528,3647488,1917184,226432,7501568,7740864,563996,8473600,4078080,4079104,5469184,5481728,8391680,17515296,17539872,25251328,27,553760,114688,5402624,272384,4078592,7492352,1152,7734848,158912
.long 1706496,3653760,80896,73728,245376,233472,15,8192,0,703104,702464,6047744,158720,0,1581056,1560576,1622016,1601536,1652736,3018752,3039232,3054592,143360,3642880,1770496,656512,7562240,7756032,1157916,8458240,4091776,4092288,6001664,6014208,8376320,743520,752736,8653312,56,1147680,102400,5996544,272384,4091904,7553024,1152,7734848,158720
.long 1711616,3654144,16777216,74752,109440,108544,15,8192,0,16777216,702976,6050304,158848,5120,1586176,1565696,1627136,1606656,1657856,3023872,3044352,3056640,145408,3644416,1819648,676992,7562496,7756096,1178396,8463360,4092544,4093568,6042624,6055168,8381440,748640,757856,8653568,57,1168160,106496,6017024,272384,4092928,7553280,1152,7734848,158784
.long 1808896,3661440,16777216,75776,16777216,235520,15,8192,0,16777216,703488,6052864,158976,10240,1591296,1570816,1632256,1611776,1642496,3008512,3028992,3049472,148480,3645952,1868800,697472,7562752,7756160,1198876,8468480,4093696,4094208,6083584,6096128,8386560,17515616,17540192,25456128,58,1188640,110592,6037504,272384,4093952,7553536,1152,7734848,158848
.long 1814016,3661824,16777216,76544,181376,180224,9,8192,0,16777216,704000,6055424,159104,15360,1596416,1575936,1637376,1616896,1647616,3013632,3034112,3051520,150528,3647488,1917952,717952,7563008,7756224,1219356,8473600,4094464,4095488,6124544,6137088,8391680,17515616,17540192,25456128,59,1209120,114688,6057984,272384,4094976,7553792,1152,7734848,158912
.long 1348096,3626880,73344,73728,220800,233472,15,8192,0,711296,710656,6703104,158720,0,1581056,1560576,1622016,1601536,1652736,3018752,3039232,3054592,143360,3642880,1771264,1148032,7623680,7771392,1813276,8458240,4108160,4108672,6657024,6669568,8376320,742560,751776,8038912,88,1803040,102400,6651904,272384,4108288,7614464,1152,7734848,158720
.long 1353216,3627264,16777216,74752,109952,108544,15,8192,0,16777216,711168,6705664,158848,5120,1586176,1565696,1627136,1606656,1657856,3023872,3044352,3056640,145408,3644416,1820416,1168512,7623936,7771456,1833756,8463360,4108928,4109952,6697984,6710528,8381440,747680,756896,8039168,89,1823520,106496,6672384,272384,4109312,7614720,1152,7734848,158784
.long 1450496,3634560,16777216,75776,16777216,235520,15,8192,0,16777216,711680,6708224,158976,10240,1591296,1570816,1632256,1611776,1642496,3008512,3028992,3049472,148480,3645952,1869568,1188992,7624192,7771520,1854236,8468480,4110080,4110592,6738944,6751488,8386560,17514656,17539232,24841728,90,1844000,110592,6692864,272384,4110336,7614976,1152,7734848,158848
.long 1455616,3634944,16777216,76544,193664,192512,9,8192,0,16777216,712192,6710784,159104,15360,1596416,1575936,1637376,1616896,1647616,3013632,3034112,3051520,150528,3647488,1918720,1209472,7624448,7771584,1874716,8473600,4110848,4111872,6779904,6792448,8391680,17514656,17539232,24841728,91,1864480,114688,6713344,272384,4111360,7615232,1152,7734848,158912
.long 1757696,3657600,81536,73728,228992,233472,15,8192,0,719488,718848,7358464,158720,0,1581056,1560576,1622016,1601536,1652736,3018752,3039232,3054592,143360,3642880,1772032,1639552,7685120,7786752,2468636,8458240,4124544,4125056,7312384,7324928,8376320,742880,752096,8243712,120,2458400,102400,7307264,272384,4124672,7675904,1152,7734848,158720
.long 1762816,3657984,16777216,74752,110464,108544,15,8192,0,16777216,719360,7361024,158848,5120,1586176,1565696,1627136,1606656,1657856,3023872,3044352,3056640,145408,3644416,1821184,1660032,7685376,7786816,2489116,8463360,4125312,4126336,7353344,7365888,8381440,748000,757216,8243968,121,2478880,106496,7327744,272384,4125696,7676160,1152,7734848,158784
.long 1860096,3665280,16777216,75776,16777216,235520,15,8192,0,16777216,719872,7363584,158976,10240,1591296,1570816,1632256,1611776,1642496,3008512,3028992,3049472,148480,3645952,1870336,1680512,7685632,7786880,2509596,8468480,4126464,4126976,7394304,7406848,8386560,17514976,17539552,25046528,122,2499360,110592,7348224,272384,4126720,7676416,1152,7734848,158848
.long 1865216,3665664,16777216,76544,205952,204800,9,8192,0,16777216,720384,7366144,159104,15360,1596416,1575936,1637376,1616896,1647616,3013632,3034112,3051520,150528,3647488,1919488,1700992,7685888,7786944,2530076,8473600,4127232,4128256,7435264,7447808,8391680,17514976,17539552,25046528,123,2519840,114688,7368704,272384,4127744,7676672,1152,7734848,158912
.long 2116096,3684480,89088,90112,241280,233472,15,0,2048,695936,694272,5474304,158720,0,2400256,2379776,2441216,2420736,2471936,3428352,3448832,3464192,143360,3704320,1770112,410752,7531520,7748352,584476,8468480,4599680,4600192,5354496,5360896,8376320,743360,752576,8550912,28,574240,102400,5423104,288768,4599808,7522304,1152,7734848,158976
.long 2121216,3684864,16777216,91136,125312,124928,15,0,2048,16777216,694784,5476864,158848,5120,2405376,2384896,2446336,2425856,2477056,3433472,3453952,3466240,145408,3705856,1819264,431232,7531776,7748416,604956,8473600,4600448,4601472,5395456,5401856,8381440,748480,757696,8551168,29,594720,106496,5443584,288768,4600832,7522560,1152,7734848,159040
.long 2218496,3692160,16777216,92160,16777216,235520,15,0,2048,16777216,695296,5479424,158976,10240,2410496,2390016,2451456,2430976,2461696,3418112,3438592,3459072,148480,3707392,1868416,451712,7532032,7748480,625436,8458240,4601600,4602112,5436416,5442816,8386560,17515456,17540032,25353728,30,615200,110592,5464064,288768,4601856,7522816,1152,7734848,159104
.long 2223616,3692544,16777216,92928,175232,174080,9,0,2048,16777216,695808,5481984,159104,15360,2415616,2395136,2456576,2436096,2466816,3423232,3443712,3461120,150528,3708928,1917568,472192,7532288,7748544,645916,8463360,4602368,4603392,5477376,5483776,8391680,17515456,17540032,25353728,31,635680,114688,5484544,288768,4602880,7523072,1152,7734848,159168
.long 2525696,3715200,97280,90112,216704,233472,15,0,2048,704128,702464,6129664,158720,0,2400256,2379776,2441216,2420736,2471936,3428352,3448832,3464192,143360,3704320,1770880,902272,7592960,7763712,1239836,8468480,4616064,4616576,6009856,6016256,8376320,742400,751616,7936512,60,1229600,102400,6078464,288768,4616192,7583744,1152,7734848,158976
.long 2530816,3715584,16777216,91136,125824,124928,15,0,2048,16777216,702976,6132224,158848,5120,2405376,2384896,2446336,2425856,2477056,3433472,3453952,3466240,145408,3705856,1820032,922752,7593216,7763776,1260316,8473600,4616832,4617856,6050816,6057216,8381440,747520,756736,7936768,61,1250080,106496,6098944,288768,4617216,7584000,1152,7734848,159040
.long 2628096,3722880,16777216,92160,16777216,235520,15,0,2048,16777216,703488,6134784,158976,10240,2410496,2390016,2451456,2430976,2461696,3418112,3438592,3459072,148480,3707392,1869184,943232,7593472,7763840,1280796,8458240,4617984,4618496,6091776,6098176,8386560,17514496,17539072,24739328,62,1270560,110592,6119424,288768,4618240,7584256,1152,7734848,159104
.long 2633216,3723264,16777216,92928,187520,186368,9,0,2048,16777216,704000,6137344,159104,15360,2415616,2395136,2456576,2436096,2466816,3423232,3443712,3461120,150528,3708928,1918336,963712,7593728,7763904,1301276,8463360,4618752,4619776,6132736,6139136,8391680,17514496,17539072,24739328,63,1291040,114688,6139904,288768,4619264,7584512,1152,7734848,159168
.long 2167296,3688320,89728,90112,224896,233472,15,0,2048,712320,710656,6785024,158720,0,2400256,2379776,2441216,2420736,2471936,3428352,3448832,3464192,143360,3704320,1771648,1393792,7654400,7779072,1895196,8468480,4632448,4632960,6665216,6671616,8376320,742720,751936,8141312,92,1884960,102400,6733824,288768,4632576,7645184,1152,7734848,158976
.long 2172416,3688704,16777216,91136,126336,124928,15,0,2048,16777216,711168,6787584,158848,5120,2405376,2384896,2446336,2425856,2477056,3433472,3453952,3466240,145408,3705856,1820800,1414272,7654656,7779136,1915676,8473600,4633216,4634240,6706176,6712576,8381440,747840,757056,8141568,93,1905440,106496,6754304,288768,4633600,7645440,1152,7734848,159040
.long 2269696,3696000,16777216,92160,16777216,235520,15,0,2048,16777216,711680,6790144,158976,10240,2410496,2390016,2451456,2430976,2461696,3418112,3438592,3459072,148480,3707392,1869952,1434752,7654912,7779200,1936156,8458240,4634368,4634880,6747136,6753536,8386560,17514816,17539392,24944128,94,1925920,110592,6774784,288768,4634624,7645696,1152,7734848,159104
.long 2274816,3696384,16777216,92928,199808,198656,9,0,2048,16777216,712192,6792704,159104,15360,2415616,2395136,2456576,2436096,2466816,3423232,3443712,3461120,150528,3708928,1919104,1455232,7655168,7779264,1956636,8463360,4635136,4636160,6788096,6794496,8391680,17514816,17539392,24944128,95,1946400,114688,6795264,288768,4635648,7645952,1152,7734848,159168
.long 2576896,3719040,97920,90112,233088,233472,15,0,2048,720512,718848,7440384,158720,0,2400256,2379776,2441216,2420736,2471936,3428352,3448832,3464192,143360,3704320,1772416,1885312,7715840,7794432,2550556,8468480,4648832,4649344,7320576,7326976,8376320,743040,752256,8346112,124,2540320,102400,7389184,288768,4648960,7706624,1152,7734848,158976
.long 2582016,3719424,16777216,91136,126848,124928,15,0,2048,16777216,719360,7442944,158848,5120,2405376,2384896,2446336,2425856,2477056,3433472,3453952,3466240,145408,3705856,1821568,1905792,7716096,7794496,2571036,8473600,4649600,4650624,7361536,7367936,8381440,748160,757376,8346368,125,2560800,106496,7409664,288768,4649984,7706880,1152,7734848,159040
.long 2679296,3726720,16777216,92160,16777216,235520,15,0,2048,16777216,719872,7445504,158976,10240,2410496,2390016,2451456,2430976,2461696,3418112,3438592,3459072,148480,3707392,1870720,1926272,7716352,7794560,2591516,8458240,4650752,4651264,7402496,7408896,8386560,17515136,17539712,25148928,126,2581280,110592,7430144,288768,4651008,7707136,1152,7734848,159104
.long 2684416,3727104,16777216,92928,212096,210944,9,0,2048,16777216,720384,7448064,159104,15360,2415616,2395136,2456576,2436096,2466816,3423232,3443712,3461120,150528,3708928,1919872,1946752,7716608,7794624,2611996,8463360,4651520,4652544,7443456,7449856,8391680,17515136,17539712,25148928,127,2601760,114688,7450624,288768,4652032,7707392,1152,7734848,159168
.long 18074112,20400256,16849920,77824,241408,237568,15,8192,0,695040,694272,5402624,158720,0,1703936,1724416,1662976,1683456,1744896,3080192,3059712,3100672,143360,3650560,1769728,164992,24278016,24517888,492636,8560640,4140928,4141440,5347328,5359104,8478720,768960,778176,8555520,24,492480,102400,5341184,274432,4141056,7491584,1152,7735168,158720
.long 18079232,20400640,16777216,78848,110976,110592,15,8192,0,16777216,694784,5405184,158848,5120,1709056,1729536,1668096,1688576,1750016,3085312,3064832,3102720,145408,3652096,1818880,185472,24278272,24517952,513116,8565760,4141696,4142720,5388288,5400064,8483840,774080,783296,8555776,25,512960,106496,5361664,274432,4142080,7491840,1152,7735168,158784
.long 18176512,20407936,16777216,79872,16777216,239616,15,8192,0,16777216,695296,5407744,158976,10240,1714176,1734656,1673216,1693696,1755136,3090432,3069952,3105792,148480,3653632,1868032,205952,24278528,24518016,533596,8570880,4142848,4143360,5429248,5441024,8488960,789440,814016,8576768,26,533440,110592,5382144,274432,4143104,7492096,1152,7735168,158848
.long 18181632,20408320,16777216,80640,16946304,167936,9,8192,0,16777216,695808,5410304,159104,15360,1719296,1739776,1678336,1698816,1760256,3095552,3075072,3107840,150528,3655168,1917184,226432,24278784,24518080,554076,8576000,4143616,4144640,5470208,5481984,8494080,17566656,17591232,25353984,27,553920,114688,5402624,274432,4144128,7492352,1152,7735168,158912
.long 18483712,20430976,16858112,77824,216832,237568,15,8192,0,703232,702464,6057984,158720,0,1703936,1724416,1662976,1683456,1744896,3080192,3059712,3100672,143360,3650560,1770496,656512,24339456,24533248,1147996,8560640,4157312,4157824,6002688,6014464,8478720,768000,777216,7941120,56,1147840,102400,5996544,274432,4157440,7553024,1152,7735168,158720
.long 18488832,20431360,16777216,78848,111488,110592,15,8192,0,16777216,702976,6060544,158848,5120,1709056,1729536,1668096,1688576,1750016,3085312,3064832,3102720,145408,3652096,1819648,676992,24339712,24533312,1168476,8565760,4158080,4159104,6043648,6055424,8483840,773120,782336,7941376,57,1168320,106496,6017024,274432,4158464,7553280,1152,7735168,158784
.long 18586112,20438656,16777216,79872,16777216,239616,15,8192,0,16777216,703488,6063104,158976,10240,1714176,1734656,1673216,1693696,1755136,3090432,3069952,3105792,148480,3653632,1868800,697472,24339968,24533376,1188956,8570880,4159232,4159744,6084608,6096384,8488960,788480,813056,7962368,58,1188800,110592,6037504,274432,4159488,7553536,1152,7735168,158848
.long 18591232,20439040,16777216,80640,16958592,180224,9,8192,0,16777216,704000,6065664,159104,15360,1719296,1739776,1678336,1698816,1760256,3095552,3075072,3107840,150528,3655168,1917952,717952,24340224,24533440,1209436,8576000,4160000,4161024,6125568,6137344,8494080,17565696,17590272,24739584,59,1209280,114688,6057984,274432,4160512,7553792,1152,7735168,158912
.long 18125312,20404096,16850560,77824,225024,237568,15,8192,0,711424,710656,6713344,158720,0,1703936,1724416,1662976,1683456,1744896,3080192,3059712,3100672,143360,3650560,1771264,1148032,24400896,24548608,1803356,8560640,4173696,4174208,6658048,6669824,8478720,768320,777536,8145920,88,1803200,102400,6651904,274432,4173824,7614464,1152,7735168,158720
.long 18130432,20404480,16777216,78848,112000,110592,15,8192,0,16777216,711168,6715904,158848,5120,1709056,1729536,1668096,1688576,1750016,3085312,3064832,3102720,145408,3652096,1820416,1168512,24401152,24548672,1823836,8565760,4174464,4175488,6699008,6710784,8483840,773440,782656,8146176,89,1823680,106496,6672384,274432,4174848,7614720,1152,7735168,158784
.long 18227712,20411776,16777216,79872,16777216,239616,15,8192,0,16777216,711680,6718464,158976,10240,1714176,1734656,1673216,1693696,1755136,3090432,3069952,3105792,148480,3653632,1869568,1188992,24401408,24548736,1844316,8570880,4175616,4176128,6739968,6751744,8488960,788800,813376,8167168,90,1844160,110592,6692864,274432,4175872,7614976,1152,7735168,158848
.long 18232832,20412160,16777216,80640,16970880,192512,9,8192,0,16777216,712192,6721024,159104,15360,1719296,1739776,1678336,1698816,1760256,3095552,3075072,3107840,150528,3655168,1918720,1209472,24401664,24548800,1864796,8576000,4176384,4177408,6780928,6792704,8494080,17566016,17590592,24944384,91,1864640,114688,6713344,274432,4176896,7615232,1152,7735168,158912
.long 18534912,20434816,16858752,77824,233216,237568,15,8192,0,719616,718848,7368704,158720,0,1703936,1724416,1662976,1683456,1744896,3080192,3059712,3100672,143360,3650560,1772032,1639552,24462336,24563968,2458716,8560640,4190080,4190592,7313408,7325184,8478720,768640,777856,8350720,120,2458560,102400,7307264,274432,4190208,7675904,1152,7735168,158720
.long 18540032,20435200,16777216,78848,112512,110592,15,8192,0,16777216,719360,7371264,158848,5120,1709056,1729536,1668096,1688576,1750016,3085312,3064832,3102720,145408,3652096,1821184,1660032,24462592,24564032,2479196,8565760,4190848,4191872,7354368,7366144,8483840,773760,782976,8350976,121,2479040,106496,7327744,274432,4191232,7676160,1152,7735168,158784
.long 18637312,20442496,16777216,79872,16777216,239616,15,8192,0,16777216,719872,7373824,158976,10240,1714176,1734656,1673216,1693696,1755136,3090432,3069952,3105792,148480,3653632,1870336,1680512,24462848,24564096,2499676,8570880,4192000,4192512,7395328,7407104,8488960,789120,813696,8371968,122,2499520,110592,7348224,274432,4192256,7676416,1152,7735168,158848
.long 18642432,20442880,16777216,80640,16983168,204800,9,8192,0,16777216,720384,7376384,159104,15360,1719296,1739776,1678336,1698816,1760256,3095552,3075072,3107840,150528,3655168,1919488,1700992,24463104,24564160,2520156,8576000,4192768,4193792,7436288,7448064,8494080,17566336,17590912,25149184,123,2520000,114688,7368704,274432,4193280,7676672,1152,7735168,158912
.long 18893312,20461696,16866304,94208,245504,237568,15,0,2048,696064,694272,5484544,158720,0,2523136,2543616,2482176,2502656,2564096,3489792,3469312,3510272,143360,3712000,1770112,410752,24308736,24525568,574556,8570880,4665216,4665728,5355520,5361152,8478720,769120,778336,8657920,28,574400,102400,5423104,290816,4665344,7522304,1152,7735168,158976
.long 18898432,20462080,16777216,95232,127360,126976,15,0,2048,16777216,694784,5487104,158848,5120,2528256,2548736,2487296,2507776,2569216,3494912,3474432,3512320,145408,3713536,1819264,431232,24308992,24525632,595036,8576000,4665984,4667008,5396480,5402112,8483840,774240,783456,8658176,29,594880,106496,5443584,290816,4666368,7522560,1152,7735168,159040
.long 18995712,20469376,16777216,96256,16777216,239616,15,0,2048,16777216,695296,5489664,158976,10240,2533376,2553856,2492416,2512896,2574336,3500032,3479552,3515392,148480,3715072,1868416,451712,24309248,24525696,615516,8560640,4667136,4667648,5437440,5443072,8488960,789600,814176,8679168,30,615360,110592,5464064,290816,4667392,7522816,1152,7735168,159104
.long 19000832,20469760,16777216,97024,16952448,174080,9,0,2048,16777216,695808,5492224,159104,15360,2538496,2558976,2497536,2518016,2579456,3505152,3484672,3517440,150528,3716608,1917568,472192,24309504,24525760,635996,8565760,4667904,4668928,5478400,5484032,8494080,17566816,17591392,25456384,31,635840,114688,5484544,290816,4668416,7523072,1152,7735168,159168
.long 19302912,20492416,16874496,94208,220928,237568,15,0,2048,704256,702464,6139904,158720,0,2523136,2543616,2482176,2502656,2564096,3489792,3469312,3510272,143360,3712000,1770880,902272,24370176,24540928,1229916,8570880,4681600,4682112,6010880,6016512,8478720,768160,777376,8043520,60,1229760,102400,6078464,290816,4681728,7583744,1152,7735168,158976
.long 19308032,20492800,16777216,95232,127872,126976,15,0,2048,16777216,702976,6142464,158848,5120,2528256,2548736,2487296,2507776,2569216,3494912,3474432,3512320,145408,3713536,1820032,922752,24370432,24540992,1250396,8576000,4682368,4683392,6051840,6057472,8483840,773280,782496,8043776,61,1250240,106496,6098944,290816,4682752,7584000,1152,7735168,159040
.long 19405312,20500096,16777216,96256,16777216,239616,15,0,2048,16777216,703488,6145024,158976,10240,2533376,2553856,2492416,2512896,2574336,3500032,3479552,3515392,148480,3715072,1869184,943232,24370688,24541056,1270876,8560640,4683520,4684032,6092800,6098432,8488960,788640,813216,8064768,62,1270720,110592,6119424,290816,4683776,7584256,1152,7735168,159104
.long 19410432,20500480,16777216,97024,16964736,186368,9,0,2048,16777216,704000,6147584,159104,15360,2538496,2558976,2497536,2518016,2579456,3505152,3484672,3517440,150528,3716608,1918336,963712,24370944,24541120,1291356,8565760,4684288,4685312,6133760,6139392,8494080,17565856,17590432,24841984,63,1291200,114688,6139904,290816,4684800,7584512,1152,7735168,159168
.long 18944512,20465536,16866944,94208,229120,237568,15,0,2048,712448,710656,6795264,158720,0,2523136,2543616,2482176,2502656,2564096,3489792,3469312,3510272,143360,3712000,1771648,1393792,24431616,24556288,1885276,8570880,4697984,4698496,6666240,6671872,8478720,768480,777696,8248320,92,1885120,102400,6733824,290816,4698112,7645184,1152,7735168,158976
.long 18949632,20465920,16777216,95232,128384,126976,15,0,2048,16777216,711168,6797824,158848,5120,2528256,2548736,2487296,2507776,2569216,3494912,3474432,3512320,145408,3713536,1820800,1414272,24431872,24556352,1905756,8576000,4698752,4699776,6707200,6712832,8483840,773600,782816,8248576,93,1905600,106496,6754304,290816,4699136,7645440,1152,7735168,159040
.long 19046912,20473216,16777216,96256,16777216,239616,15,0,2048,16777216,711680,6800384,158976,10240,2533376,2553856,2492416,2512896,2574336,3500032,3479552,3515392,148480,3715072,1869952,1434752,24432128,24556416,1926236,8560640,4699904,4700416,6748160,6753792,8488960,788960,813536,8269568,94,1926080,110592,6774784,290816,4700160,7645696,1152,7735168,159104
.long 19052032,20473600,16777216,97024,16977024,198656,9,0,2048,16777216,712192,6802944,159104,15360,2538496,2558976,2497536,2518016,2579456,3505152,3484672,3517440,150528,3716608,1919104,1455232,24432384,24556480,1946716,8565760,4700672,4701696,6789120,6794752,8494080,17566176,17590752,25046784,95,1946560,114688,6795264,290816,4701184,7645952,1152,7735168,159168
.long 19354112,20496256,16875136,94208,237312,237568,15,0,2048,720640,718848,7450624,158720,0,2523136,2543616,2482176,2502656,2564096,3489792,3469312,3510272,143360,3712000,1772416,1885312,24493056,24571648,2540636,8570880,4714368,4714880,7321600,7327232,8478720,768800,778016,8453120,124,2540480,102400,7389184,290816,4714496,7706624,1152,7735168,158976
.long 19359232,20496640,16777216,95232,128896,126976,15,0,2048,16777216,719360,7453184,158848,5120,2528256,2548736,2487296,2507776,2569216,3494912,3474432,3512320,145408,3713536,1821568,1905792,24493312,24571712,2561116,8576000,4715136,4716160,7362560,7368192,8483840,773920,783136,8453376,125,2560960,106496,7409664,290816,4715520,7706880,1152,7735168,159040
.long 19456512,20503936,16777216,96256,16777216,239616,15,0,2048,16777216,719872,7455744,158976,10240,2533376,2553856,2492416,2512896,2574336,3500032,3479552,3515392,148480,3715072,1870720,1926272,24493568,24571776,2581596,8560640,4716288,4716800,7403520,7409152,8488960,789280,813856,8474368,126,2581440,110592,7430144,290816,4716544,7707136,1152,7735168,159104
.long 19461632,20504320,16777216,97024,16989312,210944,9,0,2048,16777216,720384,7458304,159104,15360,2538496,2558976,2497536,2518016,2579456,3505152,3484672,3517440,150528,3716608,1919872,1946752,24493824,24571840,2602076,8565760,4717056,4718080,7444480,7450112,8494080,17566496,17591072,25251584,127,2601920,114688,7450624,290816,4717568,7707392,1152,7735168,159168
.long 18074112,20400256,16849920,77824,245632,241664,15,8192,0,695168,694272,5412864,158720,0,1826816,1806336,1785856,1765376,1857536,3141632,3121152,3156992,143360,3658240,1769728,164992,24278016,24517888,502876,8663040,4206464,4206976,5348352,5359360,8581120,794720,803936,8658432,24,492640,102400,5341184,276480,4206592,7491584,1152,7735488,158720
.long 18079232,20400640,16777216,78848,113024,112640,15,8192,0,16777216,694784,5415424,158848,5120,1831936,1811456,1790976,1770496,1862656,3146752,3126272,3159040,145408,3659776,1818880,185472,24278272,24517952,523356,8668160,4207232,4208256,5389312,5400320,8586240,799840,809056,8658688,25,513120,106496,5361664,276480,4207616,7491840,1152,7735488,158784
.long 18176512,20407936,16777216,79872,16777216,243712,15,8192,0,16777216,695296,5417984,158976,10240,1837056,1816576,1796096,1775616,1847296,3131392,3110912,3151872,148480,3661312,1868032,205952,24278528,24518016,543836,8673280,4208384,4208896,5430272,5441280,8591360,17566816,17591392,25456384,26,533600,110592,5382144,276480,4208640,7492096,1152,7735488,158848
.long 18181632,20408320,16777216,80640,16946304,167936,9,8192,0,16777216,695808,5420544,159104,15360,1842176,1821696,1801216,1780736,1852416,3136512,3116032,3153920,150528,3662848,1917184,226432,24278784,24518080,564316,8678400,4209152,4210176,5471232,5482240,8596480,17566816,17591392,25456384,27,554080,114688,5402624,276480,4209664,7492352,1152,7735488,158912
.long 18483712,20430976,16858112,77824,221056,241664,15,8192,0,703360,702464,6068224,158720,0,1826816,1806336,1785856,1765376,1857536,3141632,3121152,3156992,143360,3658240,1770496,656512,24339456,24533248,1158236,8663040,4222848,4223360,6003712,6014720,8581120,793760,802976,8044032,56,1148000,102400,5996544,276480,4222976,7553024,1152,7735488,158720
.long 18488832,20431360,16777216,78848,113536,112640,15,8192,0,16777216,702976,6070784,158848,5120,1831936,1811456,1790976,1770496,1862656,3146752,3126272,3159040,145408,3659776,1819648,676992,24339712,24533312,1178716,8668160,4223616,4224640,6044672,6055680,8586240,798880,808096,8044288,57,1168480,106496,6017024,276480,4224000,7553280,1152,7735488,158784
.long 18586112,20438656,16777216,79872,16777216,243712,15,8192,0,16777216,703488,6073344,158976,10240,1837056,1816576,1796096,1775616,1847296,3131392,3110912,3151872,148480,3661312,1868800,697472,24339968,24533376,1199196,8673280,4224768,4225280,6085632,6096640,8591360,17565856,17590432,24841984,58,1188960,110592,6037504,276480,4225024,7553536,1152,7735488,158848
.long 18591232,20439040,16777216,80640,16958592,180224,9,8192,0,16777216,704000,6075904,159104,15360,1842176,1821696,1801216,1780736,1852416,3136512,3116032,3153920,150528,3662848,1917952,717952,24340224,24533440,1219676,8678400,4225536,4226560,6126592,6137600,8596480,17565856,17590432,24841984,59,1209440,114688,6057984,276480,4226048,7553792,1152,7735488,158912
.long 18125312,20404096,16850560,77824,229248,241664,15,8192,0,711552,710656,6723584,158720,0,1826816,1806336,1785856,1765376,1857536,3141632,3121152,3156992,143360,3658240,1771264,1148032,24400896,24548608,1813596,8663040,4239232,4239744,6659072,6670080,8581120,794080,803296,8248832,88,1803360,102400,6651904,276480,4239360,7614464,1152,7735488,158720
.long 18130432,20404480,16777216,78848,114048,112640,15,8192,0,16777216,711168,6726144,158848,5120,1831936,1811456,1790976,1770496,1862656,3146752,3126272,3159040,145408,3659776,1820416,1168512,24401152,24548672,1834076,8668160,4240000,4241024,6700032,6711040,8586240,799200,808416,8249088,89,1823840,106496,6672384,276480,4240384,7614720,1152,7735488,158784
.long 18227712,20411776,16777216,79872,16777216,243712,15,8192,0,16777216,711680,6728704,158976,10240,1837056,1816576,1796096,1775616,1847296,3131392,3110912,3151872,148480,3661312,1869568,1188992,24401408,24548736,1854556,8673280,4241152,4241664,6740992,6752000,8591360,17566176,17590752,25046784,90,1844320,110592,6692864,276480,4241408,7614976,1152,7735488,158848
.long 18232832,20412160,16777216,80640,16970880,192512,9,8192,0,16777216,712192,6731264,159104,15360,1842176,1821696,1801216,1780736,1852416,3136512,3116032,3153920,150528,3662848,1918720,1209472,24401664,24548800,1875036,8678400,4241920,4242944,6781952,6792960,8596480,17566176,17590752,25046784,91,1864800,114688,6713344,276480,4242432,7615232,1152,7735488,158912
.long 18534912,20434816,16858752,77824,237440,241664,15,8192,0,719744,718848,7378944,158720,0,1826816,1806336,1785856,1765376,1857536,3141632,3121152,3156992,143360,3658240,1772032,1639552,24462336,24563968,2468956,8663040,4255616,4256128,7314432,7325440,8581120,794400,803616,8453632,120,2458720,102400,7307264,276480,4255744,7675904,1152,7735488,158720
.long 18540032,20435200,16777216,78848,114560,112640,15,8192,0,16777216,719360,7381504,158848,5120,1831936,1811456,1790976,1770496,1862656,3146752,3126272,3159040,145408,3659776,1821184,1660032,24462592,24564032,2489436,8668160,4256384,4257408,7355392,7366400,8586240,799520,808736,8453888,121,2479200,106496,7327744,276480,4256768,7676160,1152,7735488,158784
.long 18637312,20442496,16777216,79872,16777216,243712,15,8192,0,16777216,719872,7384064,158976,10240,1837056,1816576,1796096,1775616,1847296,3131392,3110912,3151872,148480,3661312,1870336,1680512,24462848,24564096,2509916,8673280,4257536,4258048,7396352,7407360,8591360,17566496,17591072,25251584,122,2499680,110592,7348224,276480,4257792,7676416,1152,7735488,158848
.long 18642432,20442880,16777216,80640,16983168,204800,9,8192,0,16777216,720384,7386624,159104,15360,1842176,1821696,1801216,1780736,1852416,3136512,3116032,3153920,150528,3662848,1919488,1700992,24463104,24564160,2530396,8678400,4258304,4259328,7437312,7448320,8596480,17566496,17591072,25251584,123,2520160,114688,7368704,276480,4258816,7676672,1152,7735488,158912
.long 18893312,20461696,16866304,94208,216960,241664,15,0,2048,696192,694272,5494784,158720,0,2646016,2625536,2605056,2584576,2676736,3551232,3530752,3566592,143360,3719680,1770112,410752,24308736,24525568,584796,8673280,4730752,4731264,5356544,5361408,8581120,793600,802816,7941632,28,574560,102400,5423104,292864,4730880,7522304,1152,7735488,158976
.long 18898432,20462080,16777216,95232,129408,129024,15,0,2048,16777216,694784,5497344,158848,5120,2651136,2630656,2610176,2589696,2681856,3556352,3535872,3568640,145408,3721216,1819264,431232,24308992,24525632,605276,8678400,4731520,4732544,5397504,5402368,8586240,798720,807936,7941888,29,595040,106496,5443584,292864,4731904,7522560,1152,7735488,159040
.long 18995712,20469376,16777216,96256,16777216,243712,15,0,2048,16777216,695296,5499904,158976,10240,2656256,2635776,2615296,2594816,2666496,3540992,3520512,3561472,148480,3722752,1868416,451712,24309248,24525696,625756,8663040,4732672,4733184,5438464,5443328,8591360,17565696,17590272,24739584,30,615520,110592,5464064,292864,4732928,7522816,1152,7735488,159104
.long 19000832,20469760,16777216,97024,16952448,174080,9,0,2048,16777216,695808,5502464,159104,15360,2661376,2640896,2620416,2599936,2671616,3546112,3525632,3563520,150528,3724288,1917568,472192,24309504,24525760,646236,8668160,4733440,4734464,5479424,5484288,8596480,17565696,17590272,24739584,31,636000,114688,5484544,292864,4733952,7523072,1152,7735488,159168
.long 19302912,20492416,16874496,94208,225152,241664,15,0,2048,704384,702464,6150144,158720,0,2646016,2625536,2605056,2584576,2676736,3551232,3530752,3566592,143360,3719680,1770880,902272,24370176,24540928,1240156,8673280,4747136,4747648,6011904,6016768,8581120,793920,803136,8146432,60,1229920,102400,6078464,292864,4747264,7583744,1152,7735488,158976
.long 19308032,20492800,16777216,95232,129920,129024,15,0,2048,16777216,702976,6152704,158848,5120,2651136,2630656,2610176,2589696,2681856,3556352,3535872,3568640,145408,3721216,1820032,922752,24370432,24540992,1260636,8678400,4747904,4748928,6052864,6057728,8586240,799040,808256,8146688,61,1250400,106496,6098944,292864,4748288,7584000,1152,7735488,159040
.long 19405312,20500096,16777216,96256,16777216,243712,15,0,2048,16777216,703488,6155264,158976,10240,2656256,2635776,2615296,2594816,2666496,3540992,3520512,3561472,148480,3722752,1869184,943232,24370688,24541056,1281116,8663040,4749056,4749568,6093824,6098688,8591360,17566016,17590592,24944384,62,1270880,110592,6119424,292864,4749312,7584256,1152,7735488,159104
.long 19410432,20500480,16777216,97024,16964736,186368,9,0,2048,16777216,704000,6157824,159104,15360,2661376,2640896,2620416,2599936,2671616,3546112,3525632,3563520,150528,3724288,1918336,963712,24370944,24541120,1301596,8668160,4749824,4750848,6134784,6139648,8596480,17566016,17590592,24944384,63,1291360,114688,6139904,292864,4750336,7584512,1152,7735488,159168
.long 18944512,20465536,16866944,94208,233344,241664,15,0,2048,712576,710656,6805504,158720,0,2646016,2625536,2605056,2584576,2676736,3551232,3530752,3566592,143360,3719680,1771648,1393792,24431616,24556288,1895516,8673280,4763520,4764032,6667264,6672128,8581120,794240,803456,8351232,92,1885280,102400,6733824,292864,4763648,7645184,1152,7735488,158976
.long 18949632,20465920,16777216,95232,130432,129024,15,0,2048,16777216,711168,6808064,158848,5120,2651136,2630656,2610176,2589696,2681856,3556352,3535872,3568640,145408,3721216,1820800,1414272,24431872,24556352,1915996,8678400,4764288,4765312,6708224,6713088,8586240,799360,808576,8351488,93,1905760,106496,6754304,292864,4764672,7645440,1152,7735488,159040
.long 19046912,20473216,16777216,96256,16777216,243712,15,0,2048,16777216,711680,6810624,158976,10240,2656256,2635776,2615296,2594816,2666496,3540992,3520512,3561472,148480,3722752,1869952,1434752,24432128,24556416,1936476,8663040,4765440,4765952,6749184,6754048,8591360,17566336,17590912,25149184,94,1926240,110592,6774784,292864,4765696,7645696,1152,7735488,159104
.long 19052032,20473600,16777216,97024,16977024,198656,9,0,2048,16777216,712192,6813184,159104,15360,2661376,2640896,2620416,2599936,2671616,3546112,3525632,3563520,150528,3724288,1919104,1455232,24432384,24556480,1956956,8668160,4766208,4767232,6790144,6795008,8596480,17566336,17590912,25149184,95,1946720,114688,6795264,292864,4766720,7645952,1152,7735488,159168
.long 19354112,20496256,16875136,94208,241536,241664,15,0,2048,720768,718848,7460864,158720,0,2646016,2625536,2605056,2584576,2676736,3551232,3530752,3566592,143360,3719680,1772416,1885312,24493056,24571648,2550876,8673280,4779904,4780416,7322624,7327488,8581120,794560,803776,8556032,124,2540640,102400,7389184,292864,4780032,7706624,1152,7735488,158976
.long 19359232,20496640,16777216,95232,130944,129024,15,0,2048,16777216,719360,7463424,158848,5120,2651136,2630656,2610176,2589696,2681856,3556352,3535872,3568640,145408,3721216,1821568,1905792,24493312,24571712,2571356,8678400,4780672,4781696,7363584,7368448,8586240,799680,808896,8556288,125,2561120,106496,7409664,292864,4781056,7706880,1152,7735488,159040
.long 19456512,20503936,16777216,96256,16777216,243712,15,0,2048,16777216,719872,7465984,158976,10240,2656256,2635776,2615296,2594816,2666496,3540992,3520512,3561472,148480,3722752,1870720,1926272,24493568,24571776,2591836,8663040,4781824,4782336,7404544,7409408,8591360,17566656,17591232,25353984,126,2581600,110592,7430144,292864,4782080,7707136,1152,7735488,159104
.long 19461632,20504320,16777216,97024,16989312,210944,9,0,2048,16777216,720384,7468544,159104,15360,2661376,2640896,2620416,2599936,2671616,3546112,3525632,3563520,150528,3724288,1919872,1946752,24493824,24571840,2612316,8668160,4782592,4783616,7445504,7450368,8596480,17566656,17591232,25353984,127,2602080,114688,7450624,292864,4783104,7707392,1152,7735488,159168
.size L_table, .-L_table
.section .rodata,"a"
.p2align 6
.amdhsa_kernel parallel_sum__linear_kernel_hedgehog__moe_arch_mod__prompt_kernel
  .amdhsa_next_free_vgpr 512
  .amdhsa_next_free_sgpr 102
  .amdhsa_accum_offset 256
  .amdhsa_group_segment_fixed_size 0
  .amdhsa_kernarg_size 96
  .amdhsa_user_sgpr_count 2
  .amdhsa_user_sgpr_kernarg_segment_ptr 1
  .amdhsa_system_sgpr_workgroup_id_x 1
  .amdhsa_float_denorm_mode_32 3
.end_amdhsa_kernel
```
